```python
import torch

def _softmax(x, axis=-1):
    return torch.softmax(x, dim=axis)
def _gelu(x):
    return torch.nn.functional.gelu(x, approximate="tanh")
def _silu(x):
    return torch.nn.functional.silu(x)
def _sigmoid(x):
    return torch.sigmoid(x)
def _layernorm(x, axis=-1, eps=1e-5):
    m = x.mean(dim=axis, keepdim=True)
    v = x.var(dim=axis, keepdim=True, unbiased=False)
    return (x - m) / torch.sqrt(v + eps)
def _scatter_add(tgt, idx, src, axis=0):
    return tgt.clone().index_add_(axis, idx, src)
def _segment_sum(src, seg, n):
    out = torch.zeros((n,) + src.shape[1:], dtype=src.dtype)
    return out.index_add_(0, seg, src)
def _pad(x, pw):
    flat = tuple(v for pair in reversed(pw) for v in pair)
    return torch.nn.functional.pad(x, flat)

kernel_name = 'standalone__mha_block_cached__near_ridge'

def setup_inputs():

    _w = (lambda a: (lambda t: t.to(torch.bfloat16) if t.is_floating_point() else t)(torch.as_tensor(a)))
    B, Sq, D = 8, 256, 512
    H, Sk, Dh = 32, 1024, 128
    return {
        "x": _w((lambda *s: torch.randn(*s, dtype=torch.bfloat16) * 0.8)(B, Sq, D)),
        "k_cache": _w((lambda *s: torch.randn(*s, dtype=torch.bfloat16) * 0.8)(B, H, Sk, Dh)),
        "v_cache": _w((lambda *s: torch.randn(*s, dtype=torch.bfloat16) * 0.05)(B, H, Sk, Dh)),
        "wq": _w((lambda *s: torch.randn(*s, dtype=torch.bfloat16) * 0.8)(D, H * Dh) * (D ** -0.5)),
        "wo": _w((lambda *s: torch.randn(*s, dtype=torch.bfloat16) * 0.05)(H * Dh, D) * ((H * Dh) ** -0.5)),
    }

def reference(x, k_cache, v_cache, wq, wo):
    B, Sq, D = x.shape
    H, Dh = 32, 128
    q = (lambda x, *d: x.permute(*d))((x @ wq).reshape(B, Sq, H, Dh), 0, 2, 1, 3)
    scores = torch.einsum("bhqd,bhkd->bhqk", q, k_cache) * (Dh ** -0.5)
    p = _softmax(scores, axis=-1)
    o = torch.einsum("bhqk,bhkd->bhqd", p, v_cache)
    return (lambda x, *d: x.permute(*d))(o, 0, 2, 1, 3).reshape(B, Sq, H * Dh) @ wo
```

```asm
; @launch grid=(256,1,1) block=(256,1,1) lds=163840
.amdgcn_target "amdgcn-amd-amdhsa--gfx950"
.text
.globl standalone__mha_block_cached__near_ridge_kernel
.p2align 8
.type standalone__mha_block_cached__near_ridge_kernel,@function
standalone__mha_block_cached__near_ridge_kernel:
s_cmp_ge_u32 s2, 256
s_cbranch_scc1 L_end
s_load_dwordx16 s[56:71], s[0:1], 0
s_getpc_b64 s[52:53]
L_pc:
s_bfe_u32 s54, s2, 0x30003
v_lshrrev_b32 v128, 6, v0
v_and_b32 v129, 15, v0
v_lshl_add_u32 v128, v128, 4, v129
v_lshlrev_b32 v128, 10, v128
s_lshl_b32 s54, s54, 7
v_add_u32 v128, s54, v128
v_min_u32 v128, L_end-L_pc, v128
global_load_dword v22, v128, s[52:53]
s_and_b32 s29, s2, 7
s_lshr_b32 s55, s2, 3
s_and_b32 s30, s55, 3
s_lshr_b32 s31, s55, 2
s_and_b32 s25, s29, 1
s_lshl_b32 s25, s25, 2
s_add_u32 s25, s25, s30
s_lshr_b32 s26, s29, 1
s_lshl_b32 s26, s26, 3
s_add_u32 s26, s26, s31
s_mov_b32 s93, s29
v_lshrrev_b32 v128, 6, v0
v_and_b32 v134, 63, v0
v_readfirstlane_b32 s24, v128
v_lshrrev_b32 v129, 4, v134
v_and_b32 v130, 15, v134
v_lshl_add_u32 v132, v128, 4, v129
v_lshlrev_b32 v131, 1, v129
v_xor_b32 v131, v131, v130
v_lshlrev_b32 v133, 4, v131
v_lshl_add_u32 v78, v132, 13, v133
v_xor_b32 v79, 0x80, v78
v_lshlrev_b32 v131, 2, v129
v_xor_b32 v131, v131, v130
v_lshlrev_b32 v131, 4, v131
v_lshl_add_u32 v78, v132, 13, v131
v_mov_b32 v79, v78
v_lshrrev_b32 v131, 3, v134
v_lshl_add_u32 v128, v128, 6, v131
v_and_b32 v131, 7, v134
v_xor_b32 v131, v129, v131
v_lshlrev_b32 v131, 4, v131
v_lshl_add_u32 v76, v128, 10, v131
v_xor_b32 v77, 64, v76
s_lshl_b32 s27, s24, 12
s_lshl_b32 s28, s24, 13
s_lshl_b32 s52, s25, 18
s_lshl_b32 s53, s26, 8
s_waitcnt lgkmcnt(0)
s_add_u32 s8, s62, s53
s_addc_u32 s9, s63, 0
s_and_b32 s9, s9, 0xffff
s_mov_b32 s10, 4186368
s_mov_b32 s11, 0x20000
s_add_u32 s4, s56, s52
s_addc_u32 s5, s57, 0
s_and_b32 s5, s5, 0xffff
s_mov_b32 s6, 262144
s_mov_b32 s7, 0x20000
s_add_u32 s94, s93, 0
s_and_b32 s94, s94, 7
s_lshl_b32 s95, s94, 19
s_lshl_b32 s94, s94, 7
s_add_u32 m0, s27, 32768
s_add_u32 s97, s95, 0
buffer_load_dwordx4 v78, s[8:11], s97 offen offset:0 lds
s_add_u32 s97, s95, 31744
buffer_load_dwordx4 v78, s[8:11], s97 offen offset:1024 lds
s_add_u32 s97, s95, 63488
buffer_load_dwordx4 v79, s[8:11], s97 offen offset:2048 lds
s_add_u32 s97, s95, 95232
buffer_load_dwordx4 v79, s[8:11], s97 offen offset:3072 lds
s_add_u32 m0, s28, 81920
s_add_u32 s97, s94, 0
buffer_load_dwordx4 v76, s[4:7], s97 offen offset:0 lds
s_add_u32 s97, s94, 7168
buffer_load_dwordx4 v77, s[4:7], s97 offen offset:1024 lds
s_add_u32 s97, s94, 14336
buffer_load_dwordx4 v76, s[4:7], s97 offen offset:2048 lds
s_add_u32 s97, s94, 21504
buffer_load_dwordx4 v77, s[4:7], s97 offen offset:3072 lds
s_add_u32 m0, s28, 86016
s_add_u32 s97, s94, 32768
buffer_load_dwordx4 v76, s[4:7], s97 offen offset:0 lds
s_add_u32 s97, s94, 39936
buffer_load_dwordx4 v77, s[4:7], s97 offen offset:1024 lds
s_add_u32 s97, s94, 47104
buffer_load_dwordx4 v76, s[4:7], s97 offen offset:2048 lds
s_add_u32 s97, s94, 54272
buffer_load_dwordx4 v77, s[4:7], s97 offen offset:3072 lds
v_lshrrev_b32 v131, 6, v0
v_and_b32 v130, 15, v0
v_lshl_add_u32 v131, v131, 4, v130
v_and_b32 v129, 1, v131
v_add_u32 v129, s93, v129
v_add_u32 v129, 1, v129
v_and_b32 v129, 7, v129
v_lshrrev_b32 v130, 1, v131
v_lshlrev_b32 v128, 7, v129
v_lshl_add_u32 v128, v130, 10, v128
s_and_b32 s52, s26, 7
s_lshl_b32 s52, s52, 15
buffer_load_dword v26, v128, s[4:7], s52 offen
v_lshlrev_b32 v128, 19, v129
v_lshrrev_b32 v131, 1, v130
v_lshl_add_u32 v128, v131, 13, v128
v_and_b32 v131, 1, v130
v_lshl_add_u32 v128, v131, 7, v128
s_and_b32 s52, s25, 3
s_lshl_b32 s52, s52, 17
buffer_load_dword v27, v128, s[8:11], s52 offen
s_lshl_b32 s54, s25, 5
s_add_u32 s54, s54, s26
s_lshl_b32 s52, s54, 18
s_add_u32 s12, s58, s52
s_addc_u32 s13, s59, 0
s_and_b32 s13, s13, 0xffff
s_mov_b32 s14, 262144
s_mov_b32 s15, 0x20000
s_add_u32 s16, s60, s52
s_addc_u32 s17, s61, 0
s_and_b32 s17, s17, 0xffff
s_mov_b32 s18, 262144
s_mov_b32 s19, 0x20000
s_lshl_b32 s53, s54, 7
s_add_u32 s53, s53, 20971520
s_add_u32 s72, s70, s53
s_addc_u32 s73, s71, 0
s_and_b32 s73, s73, 0xffff
s_mov_b32 s74, 32
s_mov_b32 s75, 0x20000
s_add_u32 s76, s68, 0
s_addc_u32 s77, s69, 0
s_and_b32 s77, s77, 0xffff
s_mov_b32 s78, 256
s_mov_b32 s79, 0x20000
s_and_b32 s53, s54, 3
s_lshl_b32 s53, s53, 6
s_add_u32 s88, s68, s53
s_addc_u32 s89, s69, 0
s_and_b32 s89, s89, 0xffff
s_mov_b32 s90, 4
s_mov_b32 s91, 0x20000
s_lshr_b32 s52, s54, 1
s_and_b32 s54, s54, 1
s_lshl_b32 s53, s52, 15
s_lshl_b32 s55, s54, 9
s_add_u32 s53, s53, s55
s_add_u32 s84, s64, s53
s_addc_u32 s85, s65, 0
s_and_b32 s85, s85, 0xffff
s_mov_b32 s86, 32256
s_mov_b32 s87, 0x20000
s_lshl_b32 s54, s54, 2
s_add_u32 s54, s54, s24
s_lshl_b32 s54, s54, 19
s_lshl_b32 s52, s52, 11
s_add_u32 s52, s52, s54
s_add_u32 s52, s52, 16777216
s_add_u32 s80, s70, s52
s_addc_u32 s81, s71, 0
s_and_b32 s81, s81, 0xffff
s_mov_b32 s82, 264192
s_mov_b32 s83, 0x20000
s_lshl_b32 s52, s25, 2
s_add_u32 s52, s52, s24
s_lshl_b32 s52, s52, 19
s_lshl_b32 s53, s26, 13
s_add_u32 s52, s52, s53
s_add_u32 s20, s70, s52
s_addc_u32 s21, s71, 0
s_and_b32 s21, s21, 0xffff
s_mov_b32 s22, 270336
s_mov_b32 s23, 0x20000
s_lshl_b32 s92, s25, 2
s_lshr_b32 s52, s26, 3
s_add_u32 s92, s92, s52
s_mov_b32 s49, 0
s_bfe_u32 s52, s92, 0x10000
s_lshl_b32 s52, s52, 11
s_or_b32 s49, s49, s52
s_bfe_u32 s52, s92, 0x10001
s_lshl_b32 s52, s52, 12
s_or_b32 s49, s49, s52
s_bfe_u32 s52, s92, 0x10002
s_lshl_b32 s52, s52, 13
s_or_b32 s49, s49, s52
s_bfe_u32 s52, s92, 0x10003
s_lshl_b32 s52, s52, 14
s_or_b32 s49, s49, s52
s_mov_b32 s44, s49
s_mov_b32 s46, 0x41000000
s_mov_b32 s47, 0x3e0293ee
v_mov_b32 v132, 0
v_bfe_u32 v131, v0, 4, 1
v_lshl_add_u32 v132, v131, 0, v132
v_bfe_u32 v131, v0, 5, 1
v_lshl_add_u32 v132, v131, 1, v132
v_bfe_u32 v131, v0, 6, 1
v_lshl_add_u32 v132, v131, 7, v132
v_bfe_u32 v131, v0, 7, 1
v_lshl_add_u32 v132, v131, 8, v132
v_lshl_add_u32 v17, v132, 8, v133
v_xor_b32 v18, 0x80, v17
v_lshrrev_b32 v129, 4, v134
v_and_b32 v130, 15, v134
v_xor_b32 v131, v129, v130
v_lshlrev_b32 v131, 4, v131
v_lshl_add_u32 v13, v132, 8, v131
v_xor_b32 v14, 64, v13
v_xor_b32 v15, 128, v13
v_xor_b32 v16, 192, v13
v_add_u32 v15, 129024, v15
v_add_u32 v16, 129024, v16
v_lshl_add_u32 v1, v130, 8, v131
v_xor_b32 v2, 64, v1
v_xor_b32 v3, 128, v1
v_xor_b32 v4, 192, v1
v_lshrrev_b32 v131, 1, v130
v_xor_b32 v131, v129, v131
v_lshlrev_b32 v131, 4, v131
v_lshl_add_u32 v131, v130, 7, v131
v_add_u32 v131, s28, v131
v_add_u32 v72, 81920, v131
v_xor_b32 v73, 64, v72
v_add_u32 v74, 131072, v131
v_xor_b32 v75, 64, v74
v_cmp_eq_u32 vcc, 0, v130
v_mov_b32 v131, 0x3f803f80
v_bfe_u32 v128, v134, 2, 2
v_cndmask_b32 v28, 0, v131, vcc
v_cndmask_b32 v29, 0, v131, vcc
v_cndmask_b32 v30, 0, v131, vcc
v_cndmask_b32 v31, 0, v131, vcc
v_bfe_u32 v132, v134, 2, 3
v_and_b32 v133, 3, v134
v_lshlrev_b32 v133, 3, v133
v_lshrrev_b32 v131, 2, v134
v_lshlrev_b32 v19, 9, v131
v_lshl_add_u32 v19, v133, 1, v19
s_lshl_b32 s52, s24, 7
s_add_u32 s52, s52, 114688
v_add_u32 v19, s52, v19
v_lshl_add_u32 v133, v132, 5, v133
v_lshl_add_u32 v131, v131, 8, v133
v_add_u32 v5, 65536, v131
v_xor_b32 v6, 32, v5
v_xor_b32 v7, 64, v5
v_xor_b32 v8, 96, v5
v_xor_b32 v9, 128, v5
v_xor_b32 v10, 160, v5
v_xor_b32 v11, 192, v5
v_xor_b32 v12, 224, v5
v_lshl_add_u32 v131, v129, 3, v128
v_lshl_add_u32 v131, v131, 8, v133
v_and_b32 v131, 0xff00, v131
v_lshl_add_u32 v131, v128, 6, v131
v_and_b32 v133, 3, v134
v_lshl_add_u32 v131, v133, 4, v131
v_add_u32 v64, 32768, v131
v_xor_b32 v65, 64, v64
v_xor_b32 v66, 128, v64
v_xor_b32 v67, 192, v64
v_lshlrev_b32 v20, 4, v134
v_add_u32 v21, s27, v20
v_lshrrev_b32 v128, 5, v0
v_and_b32 v129, 0x1e, v128
v_and_b32 v128, 1, v128
v_lshl_add_u32 v128, v129, 2, v128
v_and_b32 v129, 31, v0
v_lshlrev_b32 v129, 4, v129
v_lshl_add_u32 v25, v128, 10, v129
s_lshr_b32 s29, s26, 3
s_and_b32 s52, s25, 3
s_lshl_b32 s52, s52, 14
s_add_u32 s52, s52, 8192
s_and_b32 s56, s26, 7
s_lshl_b32 s56, s56, 13
s_add_u32 s57, s56, s52
s_and_b32 s57, s57, 0xffff
s_add_u32 s58, s57, s52
s_and_b32 s58, s58, 0xffff
s_add_u32 s59, s58, s52
s_and_b32 s59, s59, 0xffff
s_add_u32 s60, s59, s52
s_and_b32 s60, s60, 0xffff
s_add_u32 s61, s60, s52
s_and_b32 s61, s61, 0xffff
s_add_u32 s62, s61, s52
s_and_b32 s62, s62, 0xffff
s_add_u32 s63, s62, s52
s_and_b32 s63, s63, 0xffff
s_lshl_b32 s96, s24, 11
s_and_b32 s52, s26, 6
s_lshl_b32 s52, s52, 1
s_add_u32 s52, s52, s24
s_lshl_b32 s52, s52, 18
s_lshl_b32 s54, s29, 16
s_add_u32 s52, s52, s54
s_add_u32 s52, s52, 16777216
s_sub_u32 s52, s52, s27
s_mov_b32 s64, s52
s_and_b32 s52, s26, 1
s_lshl_b32 s53, s25, 1
s_add_u32 s52, s52, s53
s_lshl_b32 s53, s52, 20
s_add_u32 s53, s53, s54
s_mov_b32 s65, s53
s_lshl_b32 s52, s52, 17
s_lshl_b32 s53, s29, 15
s_add_u32 s52, s52, s53
s_and_b32 s53, s26, 6
s_lshl_b32 s53, s53, 7
s_add_u32 s52, s52, s53
s_add_u32 s32, s66, s52
s_addc_u32 s33, s67, 0
s_and_b32 s33, s33, 0xffff
s_mov_b32 s34, 32000
s_mov_b32 s35, 0x20000
s_lshl_b32 s52, s25, 12
s_lshl_b32 s53, s29, 10
s_add_u32 s52, s52, s53
s_add_u32 s52, s52, 20971520
s_add_u32 s36, s70, s52
s_addc_u32 s37, s71, 0
s_and_b32 s37, s37, 0xffff
s_mov_b32 s38, 4
s_mov_b32 s39, 0x20000
s_and_b32 s52, s26, 7
s_lshl_b32 s53, s25, 5
s_add_u32 s52, s52, s53
s_lshl_b32 s53, s52, 16
s_lshl_b32 s54, s29, 14
s_add_u32 s53, s53, s54
s_add_u32 s53, s53, 25165824
s_mov_b32 s3, s53
s_lshl_b32 s53, s52, 7
s_lshl_b32 s54, s29, 2
s_add_u32 s53, s53, s54
s_add_u32 s53, s53, 20971536
s_mov_b32 s31, s53
s_lshl_b32 s53, s25, 5
s_add_u32 s53, s53, s26
s_lshl_b32 s53, s53, 16
s_add_u32 s53, s53, 25165824
s_mov_b32 s98, s53
s_waitcnt vmcnt(2)
s_barrier
ds_read_b128 v[96:99], v72 offset:0
ds_read_b128 v[100:103], v73 offset:0
ds_read_b128 v[104:107], v72 offset:2048
ds_read_b128 v[108:111], v73 offset:2048
ds_read_b128 v[112:115], v72 offset:4096
ds_read_b128 v[116:119], v73 offset:4096
ds_read_b128 v[120:123], v72 offset:6144
ds_read_b128 v[124:127], v73 offset:6144
ds_read_b64_tr_b16 a[128:129], v64 offset:0
ds_read_b64_tr_b16 a[130:131], v64 offset:1024
ds_read_b64_tr_b16 a[132:133], v64 offset:8192
ds_read_b64_tr_b16 a[134:135], v64 offset:9216
ds_read_b64_tr_b16 a[136:137], v64 offset:8
ds_read_b64_tr_b16 a[138:139], v64 offset:1032
ds_read_b64_tr_b16 a[140:141], v64 offset:8200
ds_read_b64_tr_b16 a[142:143], v64 offset:9224
s_add_u32 s94, s93, 1
s_and_b32 s94, s94, 7
s_lshl_b32 s95, s94, 19
s_lshl_b32 s94, s94, 7
s_add_u32 m0, s27, 49152
s_add_u32 s97, s95, 0
buffer_load_dwordx4 v78, s[8:11], s97 offen offset:0 lds
s_add_u32 s97, s95, 31744
buffer_load_dwordx4 v78, s[8:11], s97 offen offset:1024 lds
s_add_u32 s97, s95, 63488
buffer_load_dwordx4 v79, s[8:11], s97 offen offset:2048 lds
s_add_u32 s97, s95, 95232
buffer_load_dwordx4 v79, s[8:11], s97 offen offset:3072 lds
s_add_u32 m0, s28, 131072
s_add_u32 s97, s94, 0
buffer_load_dwordx4 v76, s[4:7], s97 offen offset:0 lds
s_add_u32 s97, s94, 7168
buffer_load_dwordx4 v77, s[4:7], s97 offen offset:1024 lds
s_waitcnt lgkmcnt(14)
s_waitcnt lgkmcnt(4)
v_mfma_f32_16x16x32_bf16 v[128:131], a[128:131], v[96:99], 0
ds_read_b64_tr_b16 a[144:145], v65 offset:0
v_accvgpr_write_b32 a2, 0
v_mfma_f32_16x16x32_bf16 v[128:131], a[132:135], v[100:103], v[128:131]
s_add_u32 s97, s94, 14336
buffer_load_dwordx4 v76, s[4:7], s97 offen offset:2048 lds
v_mfma_f32_16x16x32_bf16 v[136:139], a[132:135], v[108:111], 0
ds_read_b64_tr_b16 a[146:147], v65 offset:1024
ds_read_b64_tr_b16 a[148:149], v65 offset:8192
v_mfma_f32_16x16x32_bf16 v[136:139], a[128:131], v[104:107], v[136:139]
v_accvgpr_write_b32 a3, 0
v_accvgpr_write_b32 a4, 0
v_mfma_f32_16x16x32_bf16 v[144:147], a[128:131], v[112:115], 0
s_add_u32 s97, s94, 21504
buffer_load_dwordx4 v77, s[4:7], s97 offen offset:3072 lds
v_mfma_f32_16x16x32_bf16 v[144:147], a[132:135], v[116:119], v[144:147]
ds_read_b64_tr_b16 a[150:151], v65 offset:9216
ds_read_b64_tr_b16 a[152:153], v65 offset:8
v_mfma_f32_16x16x32_bf16 v[152:155], a[132:135], v[124:127], 0
s_add_u32 m0, s28, 135168
ds_read_b64_tr_b16 a[154:155], v65 offset:1032
v_accvgpr_write_b32 a5, 0
v_mfma_f32_16x16x32_bf16 v[152:155], a[128:131], v[120:123], v[152:155]
s_add_u32 s97, s94, 32768
s_waitcnt lgkmcnt(6)
buffer_load_dwordx4 v76, s[4:7], s97 offen offset:0 lds
v_mfma_f32_16x16x32_bf16 v[132:135], a[136:139], v[96:99], 0
ds_read_b64_tr_b16 a[156:157], v65 offset:8200
v_accvgpr_write_b32 a6, 0
v_mfma_f32_16x16x32_bf16 v[132:135], a[140:143], v[100:103], v[132:135]
ds_read_b64_tr_b16 a[158:159], v65 offset:9224
v_accvgpr_write_b32 a7, 0
v_mfma_f32_16x16x32_bf16 v[140:143], a[140:143], v[108:111], 0
s_add_u32 s97, s94, 39936
buffer_load_dwordx4 v77, s[4:7], s97 offen offset:1024 lds
v_mfma_f32_16x16x32_bf16 v[140:143], a[136:139], v[104:107], v[140:143]
ds_read_b64_tr_b16 a[160:161], v66 offset:0
ds_read_b64_tr_b16 a[162:163], v66 offset:1024
v_mfma_f32_16x16x32_bf16 v[148:151], a[136:139], v[112:115], 0
v_accvgpr_write_b32 a8, 0
v_accvgpr_write_b32 a9, 0
v_mfma_f32_16x16x32_bf16 v[148:151], a[140:143], v[116:119], v[148:151]
s_add_u32 s97, s94, 47104
buffer_load_dwordx4 v76, s[4:7], s97 offen offset:2048 lds
v_mfma_f32_16x16x32_bf16 v[156:159], a[140:143], v[124:127], 0
ds_read_b64_tr_b16 a[164:165], v66 offset:8192
ds_read_b64_tr_b16 a[166:167], v66 offset:9216
v_mfma_f32_16x16x32_bf16 v[156:159], a[136:139], v[120:123], v[156:159]
s_waitcnt lgkmcnt(8)
ds_read_b64_tr_b16 a[168:169], v66 offset:8
v_accvgpr_write_b32 a10, 0
v_mfma_f32_16x16x32_bf16 v[160:163], a[144:147], v[96:99], 0
s_add_u32 s97, s94, 54272
buffer_load_dwordx4 v77, s[4:7], s97 offen offset:3072 lds
v_mfma_f32_16x16x32_bf16 v[160:163], a[148:151], v[100:103], v[160:163]
s_add_u32 s94, s93, 2
s_and_b32 s94, s94, 7
s_lshl_b32 s95, s94, 19
ds_read_b64_tr_b16 a[170:171], v66 offset:1032
v_accvgpr_write_b32 a11, 0
v_mfma_f32_16x16x32_bf16 v[168:171], a[148:151], v[108:111], 0
s_lshl_b32 s94, s94, 7
ds_read_b64_tr_b16 a[172:173], v66 offset:8200
v_accvgpr_write_b32 a12, 0
v_mfma_f32_16x16x32_bf16 v[168:171], a[144:147], v[104:107], v[168:171]
s_add_u32 m0, s27, 65536
ds_read_b64_tr_b16 a[174:175], v66 offset:9224
v_accvgpr_write_b32 a13, 0
v_mfma_f32_16x16x32_bf16 v[176:179], a[144:147], v[112:115], 0
s_add_u32 s97, s95, 0
buffer_load_dwordx4 v78, s[8:11], s97 offen offset:0 lds
v_mfma_f32_16x16x32_bf16 v[176:179], a[148:151], v[116:119], v[176:179]
ds_read_b64_tr_b16 a[176:177], v67 offset:0
v_accvgpr_write_b32 a14, 0
v_mfma_f32_16x16x32_bf16 v[184:187], a[148:151], v[124:127], 0
ds_read_b64_tr_b16 a[178:179], v67 offset:1024
v_accvgpr_write_b32 a15, 0
v_mfma_f32_16x16x32_bf16 v[184:187], a[144:147], v[120:123], v[184:187]
s_waitcnt lgkmcnt(10)
ds_read_b64_tr_b16 a[180:181], v67 offset:8192
v_accvgpr_write_b32 a16, 0
v_mfma_f32_16x16x32_bf16 v[164:167], a[152:155], v[96:99], 0
s_add_u32 s97, s95, 31744
buffer_load_dwordx4 v78, s[8:11], s97 offen offset:1024 lds
v_mfma_f32_16x16x32_bf16 v[164:167], a[156:159], v[100:103], v[164:167]
ds_read_b64_tr_b16 a[182:183], v67 offset:9216
v_accvgpr_write_b32 a17, 0
v_mfma_f32_16x16x32_bf16 v[172:175], a[156:159], v[108:111], 0
ds_read_b64_tr_b16 a[184:185], v67 offset:8
v_accvgpr_write_b32 a18, 0
v_mfma_f32_16x16x32_bf16 v[172:175], a[152:155], v[104:107], v[172:175]
ds_read_b64_tr_b16 a[186:187], v67 offset:1032
v_accvgpr_write_b32 a19, 0
v_mfma_f32_16x16x32_bf16 v[180:183], a[152:155], v[112:115], 0
s_add_u32 s97, s95, 63488
buffer_load_dwordx4 v79, s[8:11], s97 offen offset:2048 lds
v_mfma_f32_16x16x32_bf16 v[180:183], a[156:159], v[116:119], v[180:183]
ds_read_b64_tr_b16 a[188:189], v67 offset:8200
v_accvgpr_write_b32 a20, 0
v_mfma_f32_16x16x32_bf16 v[188:191], a[156:159], v[124:127], 0
ds_read_b64_tr_b16 a[190:191], v67 offset:9224
v_accvgpr_write_b32 a21, 0
v_mfma_f32_16x16x32_bf16 v[188:191], a[152:155], v[120:123], v[188:191]
s_waitcnt lgkmcnt(12)
v_accvgpr_write_b32 a22, 0
v_accvgpr_write_b32 a23, 0
v_mfma_f32_16x16x32_bf16 v[192:195], a[160:163], v[96:99], 0
s_add_u32 s97, s95, 95232
buffer_load_dwordx4 v79, s[8:11], s97 offen offset:3072 lds
v_mfma_f32_16x16x32_bf16 v[192:195], a[164:167], v[100:103], v[192:195]
v_accvgpr_write_b32 a24, 0
v_accvgpr_write_b32 a25, 0
v_mfma_f32_16x16x32_bf16 v[200:203], a[164:167], v[108:111], 0
v_accvgpr_write_b32 a26, 0
v_accvgpr_write_b32 a27, 0
v_mfma_f32_16x16x32_bf16 v[200:203], a[160:163], v[104:107], v[200:203]
s_add_u32 m0, s28, 81920
v_accvgpr_write_b32 a28, 0
v_accvgpr_write_b32 a29, 0
v_mfma_f32_16x16x32_bf16 v[208:211], a[160:163], v[112:115], 0
s_add_u32 s97, s94, 0
buffer_load_dwordx4 v76, s[4:7], s97 offen offset:0 lds
v_mfma_f32_16x16x32_bf16 v[208:211], a[164:167], v[116:119], v[208:211]
v_accvgpr_write_b32 a30, 0
v_accvgpr_write_b32 a31, 0
s_waitcnt vmcnt(5) lgkmcnt(0)
v_mfma_f32_16x16x32_bf16 v[216:219], a[164:167], v[124:127], 0
s_barrier
v_accvgpr_write_b32 a32, 0
v_accvgpr_write_b32 a33, 0
v_mfma_f32_16x16x32_bf16 v[216:219], a[160:163], v[120:123], v[216:219]
ds_read_b128 v[32:35], v74 offset:0
v_accvgpr_write_b32 a34, 0
v_mfma_f32_16x16x32_bf16 v[196:199], a[168:171], v[96:99], 0
s_add_u32 s97, s94, 7168
buffer_load_dwordx4 v77, s[4:7], s97 offen offset:1024 lds
v_mfma_f32_16x16x32_bf16 v[196:199], a[172:175], v[100:103], v[196:199]
ds_read_b128 v[36:39], v75 offset:0
v_accvgpr_write_b32 a35, 0
v_mfma_f32_16x16x32_bf16 v[204:207], a[172:175], v[108:111], 0
ds_read_b128 v[40:43], v74 offset:2048
v_accvgpr_write_b32 a36, 0
v_mfma_f32_16x16x32_bf16 v[204:207], a[168:171], v[104:107], v[204:207]
ds_read_b128 v[44:47], v75 offset:2048
v_accvgpr_write_b32 a37, 0
v_mfma_f32_16x16x32_bf16 v[212:215], a[168:171], v[112:115], 0
s_add_u32 s97, s94, 14336
buffer_load_dwordx4 v76, s[4:7], s97 offen offset:2048 lds
v_mfma_f32_16x16x32_bf16 v[212:215], a[172:175], v[116:119], v[212:215]
ds_read_b128 v[48:51], v74 offset:4096
v_accvgpr_write_b32 a38, 0
v_mfma_f32_16x16x32_bf16 v[220:223], a[172:175], v[124:127], 0
ds_read_b128 v[52:55], v75 offset:4096
v_accvgpr_write_b32 a39, 0
v_mfma_f32_16x16x32_bf16 v[220:223], a[168:171], v[120:123], v[220:223]
ds_read_b128 v[56:59], v74 offset:6144
v_accvgpr_write_b32 a40, 0
v_mfma_f32_16x16x32_bf16 v[224:227], a[176:179], v[96:99], 0
s_add_u32 s97, s94, 21504
buffer_load_dwordx4 v77, s[4:7], s97 offen offset:3072 lds
v_mfma_f32_16x16x32_bf16 v[224:227], a[180:183], v[100:103], v[224:227]
ds_read_b128 v[60:63], v75 offset:6144
v_accvgpr_write_b32 a41, 0
v_mfma_f32_16x16x32_bf16 v[232:235], a[180:183], v[108:111], 0
v_accvgpr_write_b32 a42, 0
v_accvgpr_write_b32 a43, 0
v_mfma_f32_16x16x32_bf16 v[232:235], a[176:179], v[104:107], v[232:235]
s_add_u32 m0, s28, 86016
ds_read_b64_tr_b16 a[192:193], v64 offset:16384
v_accvgpr_write_b32 a44, 0
v_mfma_f32_16x16x32_bf16 v[240:243], a[176:179], v[112:115], 0
s_add_u32 s97, s94, 32768
buffer_load_dwordx4 v76, s[4:7], s97 offen offset:0 lds
v_mfma_f32_16x16x32_bf16 v[240:243], a[180:183], v[116:119], v[240:243]
ds_read_b64_tr_b16 a[194:195], v64 offset:17408
v_accvgpr_write_b32 a45, 0
v_mfma_f32_16x16x32_bf16 v[248:251], a[180:183], v[124:127], 0
ds_read_b64_tr_b16 a[196:197], v64 offset:24576
v_accvgpr_write_b32 a46, 0
v_mfma_f32_16x16x32_bf16 v[248:251], a[176:179], v[120:123], v[248:251]
v_accvgpr_write_b32 a47, 0
v_accvgpr_write_b32 a48, 0
v_mfma_f32_16x16x32_bf16 v[228:231], a[184:187], v[96:99], 0
s_add_u32 s97, s94, 39936
buffer_load_dwordx4 v77, s[4:7], s97 offen offset:1024 lds
v_mfma_f32_16x16x32_bf16 v[228:231], a[188:191], v[100:103], v[228:231]
ds_read_b64_tr_b16 a[198:199], v64 offset:25600
v_accvgpr_write_b32 a49, 0
v_mfma_f32_16x16x32_bf16 v[236:239], a[188:191], v[108:111], 0
ds_read_b64_tr_b16 a[200:201], v64 offset:16392
v_accvgpr_write_b32 a50, 0
v_mfma_f32_16x16x32_bf16 v[236:239], a[184:187], v[104:107], v[236:239]
v_accvgpr_write_b32 a51, 0
v_accvgpr_write_b32 a52, 0
v_mfma_f32_16x16x32_bf16 v[244:247], a[184:187], v[112:115], 0
s_add_u32 s97, s94, 47104
buffer_load_dwordx4 v76, s[4:7], s97 offen offset:2048 lds
v_mfma_f32_16x16x32_bf16 v[244:247], a[188:191], v[116:119], v[244:247]
ds_read_b64_tr_b16 a[202:203], v64 offset:17416
ds_read_b64_tr_b16 a[204:205], v64 offset:24584
v_mfma_f32_16x16x32_bf16 v[252:255], a[188:191], v[124:127], 0
ds_read_b64_tr_b16 a[206:207], v64 offset:25608
v_accvgpr_write_b32 a53, 0
v_mfma_f32_16x16x32_bf16 v[252:255], a[184:187], v[120:123], v[252:255]
s_waitcnt lgkmcnt(4)
v_accvgpr_write_b32 a54, 0
v_accvgpr_write_b32 a55, 0
v_mfma_f32_16x16x32_bf16 v[128:131], a[192:195], v[32:35], v[128:131]
s_add_u32 s97, s94, 54272
buffer_load_dwordx4 v77, s[4:7], s97 offen offset:3072 lds
v_mfma_f32_16x16x32_bf16 v[128:131], a[196:199], v[36:39], v[128:131]
s_add_u32 s94, s93, 3
s_and_b32 s94, s94, 7
s_lshl_b32 s95, s94, 19
ds_read_b64_tr_b16 a[208:209], v65 offset:16384
ds_read_b64_tr_b16 a[210:211], v65 offset:17408
v_mfma_f32_16x16x32_bf16 v[136:139], a[196:199], v[44:47], v[136:139]
s_lshl_b32 s94, s94, 7
ds_read_b64_tr_b16 a[212:213], v65 offset:24576
v_accvgpr_write_b32 a56, 0
v_mfma_f32_16x16x32_bf16 v[136:139], a[192:195], v[40:43], v[136:139]
s_add_u32 m0, s27, 32768
v_accvgpr_write_b32 a57, 0
v_accvgpr_write_b32 a58, 0
v_mfma_f32_16x16x32_bf16 v[144:147], a[192:195], v[48:51], v[144:147]
s_add_u32 s97, s95, 0
buffer_load_dwordx4 v78, s[8:11], s97 offen offset:0 lds
v_mfma_f32_16x16x32_bf16 v[144:147], a[196:199], v[52:55], v[144:147]
ds_read_b64_tr_b16 a[214:215], v65 offset:25600
ds_read_b64_tr_b16 a[216:217], v65 offset:16392
v_mfma_f32_16x16x32_bf16 v[152:155], a[196:199], v[60:63], v[152:155]
ds_read_b64_tr_b16 a[218:219], v65 offset:17416
v_accvgpr_write_b32 a59, 0
v_mfma_f32_16x16x32_bf16 v[152:155], a[192:195], v[56:59], v[152:155]
s_waitcnt lgkmcnt(6)
ds_read_b64_tr_b16 a[220:221], v65 offset:24584
v_accvgpr_write_b32 a60, 0
v_mfma_f32_16x16x32_bf16 v[132:135], a[200:203], v[32:35], v[132:135]
s_add_u32 s97, s95, 31744
buffer_load_dwordx4 v78, s[8:11], s97 offen offset:1024 lds
v_mfma_f32_16x16x32_bf16 v[132:135], a[204:207], v[36:39], v[132:135]
ds_read_b64_tr_b16 a[222:223], v65 offset:25608
v_accvgpr_write_b32 a61, 0
v_mfma_f32_16x16x32_bf16 v[140:143], a[204:207], v[44:47], v[140:143]
ds_read_b64_tr_b16 a[224:225], v66 offset:16384
v_accvgpr_write_b32 a62, 0
v_mfma_f32_16x16x32_bf16 v[140:143], a[200:203], v[40:43], v[140:143]
ds_read_b64_tr_b16 a[226:227], v66 offset:17408
v_accvgpr_write_b32 a63, 0
v_mfma_f32_16x16x32_bf16 v[148:151], a[200:203], v[48:51], v[148:151]
s_add_u32 s97, s95, 63488
buffer_load_dwordx4 v79, s[8:11], s97 offen offset:2048 lds
v_mfma_f32_16x16x32_bf16 v[148:151], a[204:207], v[52:55], v[148:151]
ds_read_b64_tr_b16 a[228:229], v66 offset:24576
v_accvgpr_write_b32 a64, 0
v_mfma_f32_16x16x32_bf16 v[156:159], a[204:207], v[60:63], v[156:159]
ds_read_b64_tr_b16 a[230:231], v66 offset:25600
v_accvgpr_write_b32 a65, 0
v_mfma_f32_16x16x32_bf16 v[156:159], a[200:203], v[56:59], v[156:159]
s_waitcnt lgkmcnt(8)
ds_read_b64_tr_b16 a[232:233], v66 offset:16392
v_accvgpr_write_b32 a66, 0
v_mfma_f32_16x16x32_bf16 v[160:163], a[208:211], v[32:35], v[160:163]
s_add_u32 s97, s95, 95232
buffer_load_dwordx4 v79, s[8:11], s97 offen offset:3072 lds
v_mfma_f32_16x16x32_bf16 v[160:163], a[212:215], v[36:39], v[160:163]
ds_read_b64_tr_b16 a[234:235], v66 offset:17416
v_accvgpr_write_b32 a67, 0
v_mfma_f32_16x16x32_bf16 v[168:171], a[212:215], v[44:47], v[168:171]
ds_read_b64_tr_b16 a[236:237], v66 offset:24584
v_accvgpr_write_b32 a68, 0
v_mfma_f32_16x16x32_bf16 v[168:171], a[208:211], v[40:43], v[168:171]
s_add_u32 m0, s28, 131072
ds_read_b64_tr_b16 a[238:239], v66 offset:25608
v_accvgpr_write_b32 a69, 0
v_mfma_f32_16x16x32_bf16 v[176:179], a[208:211], v[48:51], v[176:179]
s_add_u32 s97, s94, 0
buffer_load_dwordx4 v76, s[4:7], s97 offen offset:0 lds
v_mfma_f32_16x16x32_bf16 v[176:179], a[212:215], v[52:55], v[176:179]
ds_read_b64_tr_b16 a[240:241], v67 offset:16384
v_accvgpr_write_b32 a70, 0
v_mfma_f32_16x16x32_bf16 v[184:187], a[212:215], v[60:63], v[184:187]
ds_read_b64_tr_b16 a[242:243], v67 offset:17408
v_accvgpr_write_b32 a71, 0
v_mfma_f32_16x16x32_bf16 v[184:187], a[208:211], v[56:59], v[184:187]
s_waitcnt lgkmcnt(10)
ds_read_b64_tr_b16 a[244:245], v67 offset:24576
v_accvgpr_write_b32 a72, 0
v_mfma_f32_16x16x32_bf16 v[164:167], a[216:219], v[32:35], v[164:167]
s_add_u32 s97, s94, 7168
buffer_load_dwordx4 v77, s[4:7], s97 offen offset:1024 lds
v_mfma_f32_16x16x32_bf16 v[164:167], a[220:223], v[36:39], v[164:167]
ds_read_b64_tr_b16 a[246:247], v67 offset:25600
v_accvgpr_write_b32 a73, 0
v_mfma_f32_16x16x32_bf16 v[172:175], a[220:223], v[44:47], v[172:175]
ds_read_b64_tr_b16 a[248:249], v67 offset:16392
v_accvgpr_write_b32 a74, 0
v_mfma_f32_16x16x32_bf16 v[172:175], a[216:219], v[40:43], v[172:175]
ds_read_b64_tr_b16 a[250:251], v67 offset:17416
v_accvgpr_write_b32 a75, 0
v_mfma_f32_16x16x32_bf16 v[180:183], a[216:219], v[48:51], v[180:183]
s_add_u32 s97, s94, 14336
buffer_load_dwordx4 v76, s[4:7], s97 offen offset:2048 lds
v_mfma_f32_16x16x32_bf16 v[180:183], a[220:223], v[52:55], v[180:183]
ds_read_b64_tr_b16 a[252:253], v67 offset:24584
v_accvgpr_write_b32 a76, 0
v_mfma_f32_16x16x32_bf16 v[188:191], a[220:223], v[60:63], v[188:191]
ds_read_b64_tr_b16 a[254:255], v67 offset:25608
v_accvgpr_write_b32 a77, 0
v_mfma_f32_16x16x32_bf16 v[188:191], a[216:219], v[56:59], v[188:191]
s_waitcnt lgkmcnt(12)
v_accvgpr_write_b32 a78, 0
v_accvgpr_write_b32 a79, 0
v_mfma_f32_16x16x32_bf16 v[192:195], a[224:227], v[32:35], v[192:195]
s_add_u32 s97, s94, 21504
buffer_load_dwordx4 v77, s[4:7], s97 offen offset:3072 lds
v_mfma_f32_16x16x32_bf16 v[192:195], a[228:231], v[36:39], v[192:195]
v_accvgpr_write_b32 a80, 0
v_accvgpr_write_b32 a81, 0
v_mfma_f32_16x16x32_bf16 v[200:203], a[228:231], v[44:47], v[200:203]
v_accvgpr_write_b32 a82, 0
v_accvgpr_write_b32 a83, 0
v_mfma_f32_16x16x32_bf16 v[200:203], a[224:227], v[40:43], v[200:203]
s_add_u32 m0, s28, 135168
v_accvgpr_write_b32 a84, 0
v_accvgpr_write_b32 a85, 0
v_mfma_f32_16x16x32_bf16 v[208:211], a[224:227], v[48:51], v[208:211]
s_add_u32 s97, s94, 32768
buffer_load_dwordx4 v76, s[4:7], s97 offen offset:0 lds
v_mfma_f32_16x16x32_bf16 v[208:211], a[228:231], v[52:55], v[208:211]
v_accvgpr_write_b32 a86, 0
v_accvgpr_write_b32 a87, 0
s_waitcnt vmcnt(9) lgkmcnt(0)
v_mfma_f32_16x16x32_bf16 v[216:219], a[228:231], v[60:63], v[216:219]
s_barrier
v_accvgpr_write_b32 a88, 0
v_accvgpr_write_b32 a89, 0
v_mfma_f32_16x16x32_bf16 v[216:219], a[224:227], v[56:59], v[216:219]
ds_read_b128 v[96:99], v72 offset:0
v_accvgpr_write_b32 a90, 0
v_mfma_f32_16x16x32_bf16 v[196:199], a[232:235], v[32:35], v[196:199]
s_add_u32 s97, s94, 39936
buffer_load_dwordx4 v77, s[4:7], s97 offen offset:1024 lds
v_mfma_f32_16x16x32_bf16 v[196:199], a[236:239], v[36:39], v[196:199]
ds_read_b128 v[100:103], v73 offset:0
v_accvgpr_write_b32 a91, 0
v_mfma_f32_16x16x32_bf16 v[204:207], a[236:239], v[44:47], v[204:207]
ds_read_b128 v[104:107], v72 offset:2048
v_accvgpr_write_b32 a92, 0
v_mfma_f32_16x16x32_bf16 v[204:207], a[232:235], v[40:43], v[204:207]
ds_read_b128 v[108:111], v73 offset:2048
v_accvgpr_write_b32 a93, 0
v_mfma_f32_16x16x32_bf16 v[212:215], a[232:235], v[48:51], v[212:215]
s_add_u32 s97, s94, 47104
buffer_load_dwordx4 v76, s[4:7], s97 offen offset:2048 lds
v_mfma_f32_16x16x32_bf16 v[212:215], a[236:239], v[52:55], v[212:215]
ds_read_b128 v[112:115], v72 offset:4096
v_accvgpr_write_b32 a94, 0
v_mfma_f32_16x16x32_bf16 v[220:223], a[236:239], v[60:63], v[220:223]
ds_read_b128 v[116:119], v73 offset:4096
v_accvgpr_write_b32 a95, 0
v_mfma_f32_16x16x32_bf16 v[220:223], a[232:235], v[56:59], v[220:223]
ds_read_b128 v[120:123], v72 offset:6144
v_accvgpr_write_b32 a96, 0
v_mfma_f32_16x16x32_bf16 v[224:227], a[240:243], v[32:35], v[224:227]
s_add_u32 s97, s94, 54272
buffer_load_dwordx4 v77, s[4:7], s97 offen offset:3072 lds
v_mfma_f32_16x16x32_bf16 v[224:227], a[244:247], v[36:39], v[224:227]
s_add_u32 s94, s93, 4
s_and_b32 s94, s94, 7
s_lshl_b32 s95, s94, 19
ds_read_b128 v[124:127], v73 offset:6144
v_accvgpr_write_b32 a97, 0
v_mfma_f32_16x16x32_bf16 v[232:235], a[244:247], v[44:47], v[232:235]
s_lshl_b32 s94, s94, 7
v_accvgpr_write_b32 a98, 0
v_accvgpr_write_b32 a99, 0
v_mfma_f32_16x16x32_bf16 v[232:235], a[240:243], v[40:43], v[232:235]
s_add_u32 m0, s27, 49152
ds_read_b64_tr_b16 a[128:129], v64 offset:32768
v_accvgpr_write_b32 a100, 0
v_mfma_f32_16x16x32_bf16 v[240:243], a[240:243], v[48:51], v[240:243]
s_add_u32 s97, s95, 0
buffer_load_dwordx4 v78, s[8:11], s97 offen offset:0 lds
v_mfma_f32_16x16x32_bf16 v[240:243], a[244:247], v[52:55], v[240:243]
ds_read_b64_tr_b16 a[130:131], v64 offset:33792
v_accvgpr_write_b32 a101, 0
v_mfma_f32_16x16x32_bf16 v[248:251], a[244:247], v[60:63], v[248:251]
ds_read_b64_tr_b16 a[132:133], v64 offset:40960
v_accvgpr_write_b32 a102, 0
v_mfma_f32_16x16x32_bf16 v[248:251], a[240:243], v[56:59], v[248:251]
v_accvgpr_write_b32 a103, 0
v_accvgpr_write_b32 a104, 0
v_mfma_f32_16x16x32_bf16 v[228:231], a[248:251], v[32:35], v[228:231]
s_add_u32 s97, s95, 31744
buffer_load_dwordx4 v78, s[8:11], s97 offen offset:1024 lds
v_mfma_f32_16x16x32_bf16 v[228:231], a[252:255], v[36:39], v[228:231]
ds_read_b64_tr_b16 a[134:135], v64 offset:41984
v_accvgpr_write_b32 a105, 0
v_mfma_f32_16x16x32_bf16 v[236:239], a[252:255], v[44:47], v[236:239]
ds_read_b64_tr_b16 a[136:137], v64 offset:32776
v_accvgpr_write_b32 a106, 0
v_mfma_f32_16x16x32_bf16 v[236:239], a[248:251], v[40:43], v[236:239]
v_accvgpr_write_b32 a107, 0
v_accvgpr_write_b32 a108, 0
v_mfma_f32_16x16x32_bf16 v[244:247], a[248:251], v[48:51], v[244:247]
s_add_u32 s97, s95, 63488
buffer_load_dwordx4 v79, s[8:11], s97 offen offset:2048 lds
v_mfma_f32_16x16x32_bf16 v[244:247], a[252:255], v[52:55], v[244:247]
ds_read_b64_tr_b16 a[138:139], v64 offset:33800
ds_read_b64_tr_b16 a[140:141], v64 offset:40968
v_mfma_f32_16x16x32_bf16 v[252:255], a[252:255], v[60:63], v[252:255]
ds_read_b64_tr_b16 a[142:143], v64 offset:41992
v_accvgpr_write_b32 a109, 0
v_mfma_f32_16x16x32_bf16 v[252:255], a[248:251], v[56:59], v[252:255]
s_waitcnt lgkmcnt(4)
v_accvgpr_write_b32 a110, 0
v_accvgpr_write_b32 a111, 0
v_mfma_f32_16x16x32_bf16 v[128:131], a[128:131], v[96:99], v[128:131]
s_add_u32 s97, s95, 95232
buffer_load_dwordx4 v79, s[8:11], s97 offen offset:3072 lds
v_mfma_f32_16x16x32_bf16 v[128:131], a[132:135], v[100:103], v[128:131]
ds_read_b64_tr_b16 a[144:145], v65 offset:32768
ds_read_b64_tr_b16 a[146:147], v65 offset:33792
v_mfma_f32_16x16x32_bf16 v[136:139], a[132:135], v[108:111], v[136:139]
ds_read_b64_tr_b16 a[148:149], v65 offset:40960
v_accvgpr_write_b32 a112, 0
v_mfma_f32_16x16x32_bf16 v[136:139], a[128:131], v[104:107], v[136:139]
s_add_u32 m0, s28, 81920
v_accvgpr_write_b32 a113, 0
v_accvgpr_write_b32 a114, 0
v_mfma_f32_16x16x32_bf16 v[144:147], a[128:131], v[112:115], v[144:147]
s_add_u32 s97, s94, 0
buffer_load_dwordx4 v76, s[4:7], s97 offen offset:0 lds
v_mfma_f32_16x16x32_bf16 v[144:147], a[132:135], v[116:119], v[144:147]
ds_read_b64_tr_b16 a[150:151], v65 offset:41984
ds_read_b64_tr_b16 a[152:153], v65 offset:32776
v_mfma_f32_16x16x32_bf16 v[152:155], a[132:135], v[124:127], v[152:155]
ds_read_b64_tr_b16 a[154:155], v65 offset:33800
v_accvgpr_write_b32 a115, 0
v_mfma_f32_16x16x32_bf16 v[152:155], a[128:131], v[120:123], v[152:155]
s_waitcnt lgkmcnt(6)
ds_read_b64_tr_b16 a[156:157], v65 offset:40968
v_accvgpr_write_b32 a116, 0
v_mfma_f32_16x16x32_bf16 v[132:135], a[136:139], v[96:99], v[132:135]
s_add_u32 s97, s94, 7168
buffer_load_dwordx4 v77, s[4:7], s97 offen offset:1024 lds
v_mfma_f32_16x16x32_bf16 v[132:135], a[140:143], v[100:103], v[132:135]
ds_read_b64_tr_b16 a[158:159], v65 offset:41992
v_accvgpr_write_b32 a117, 0
v_mfma_f32_16x16x32_bf16 v[140:143], a[140:143], v[108:111], v[140:143]
ds_read_b64_tr_b16 a[160:161], v66 offset:32768
v_accvgpr_write_b32 a118, 0
v_mfma_f32_16x16x32_bf16 v[140:143], a[136:139], v[104:107], v[140:143]
ds_read_b64_tr_b16 a[162:163], v66 offset:33792
v_accvgpr_write_b32 a119, 0
v_mfma_f32_16x16x32_bf16 v[148:151], a[136:139], v[112:115], v[148:151]
s_add_u32 s97, s94, 14336
buffer_load_dwordx4 v76, s[4:7], s97 offen offset:2048 lds
v_mfma_f32_16x16x32_bf16 v[148:151], a[140:143], v[116:119], v[148:151]
ds_read_b64_tr_b16 a[164:165], v66 offset:40960
v_accvgpr_write_b32 a120, 0
v_mfma_f32_16x16x32_bf16 v[156:159], a[140:143], v[124:127], v[156:159]
ds_read_b64_tr_b16 a[166:167], v66 offset:41984
v_accvgpr_write_b32 a121, 0
v_mfma_f32_16x16x32_bf16 v[156:159], a[136:139], v[120:123], v[156:159]
s_waitcnt lgkmcnt(8)
ds_read_b64_tr_b16 a[168:169], v66 offset:32776
v_accvgpr_write_b32 a122, 0
v_mfma_f32_16x16x32_bf16 v[160:163], a[144:147], v[96:99], v[160:163]
s_add_u32 s97, s94, 21504
buffer_load_dwordx4 v77, s[4:7], s97 offen offset:3072 lds
v_mfma_f32_16x16x32_bf16 v[160:163], a[148:151], v[100:103], v[160:163]
ds_read_b64_tr_b16 a[170:171], v66 offset:33800
v_accvgpr_write_b32 a123, 0
v_mfma_f32_16x16x32_bf16 v[168:171], a[148:151], v[108:111], v[168:171]
ds_read_b64_tr_b16 a[172:173], v66 offset:40968
v_accvgpr_write_b32 a124, 0
v_mfma_f32_16x16x32_bf16 v[168:171], a[144:147], v[104:107], v[168:171]
s_add_u32 m0, s28, 86016
ds_read_b64_tr_b16 a[174:175], v66 offset:41992
v_accvgpr_write_b32 a125, 0
v_mfma_f32_16x16x32_bf16 v[176:179], a[144:147], v[112:115], v[176:179]
s_add_u32 s97, s94, 32768
buffer_load_dwordx4 v76, s[4:7], s97 offen offset:0 lds
v_mfma_f32_16x16x32_bf16 v[176:179], a[148:151], v[116:119], v[176:179]
ds_read_b64_tr_b16 a[176:177], v67 offset:32768
v_accvgpr_write_b32 a126, 0
v_mfma_f32_16x16x32_bf16 v[184:187], a[148:151], v[124:127], v[184:187]
ds_read_b64_tr_b16 a[178:179], v67 offset:33792
v_accvgpr_write_b32 a127, 0
v_mfma_f32_16x16x32_bf16 v[184:187], a[144:147], v[120:123], v[184:187]
s_waitcnt lgkmcnt(10)
ds_read_b64_tr_b16 a[180:181], v67 offset:40960
v_accvgpr_write_b32 a0, 0
v_mfma_f32_16x16x32_bf16 v[164:167], a[152:155], v[96:99], v[164:167]
s_add_u32 s97, s94, 39936
buffer_load_dwordx4 v77, s[4:7], s97 offen offset:1024 lds
v_mfma_f32_16x16x32_bf16 v[164:167], a[156:159], v[100:103], v[164:167]
ds_read_b64_tr_b16 a[182:183], v67 offset:41984
v_accvgpr_write_b32 a1, 0
v_mfma_f32_16x16x32_bf16 v[172:175], a[156:159], v[108:111], v[172:175]
ds_read_b64_tr_b16 a[184:185], v67 offset:32776
v_mfma_f32_16x16x32_bf16 v[172:175], a[152:155], v[104:107], v[172:175]
ds_read_b64_tr_b16 a[186:187], v67 offset:33800
v_mfma_f32_16x16x32_bf16 v[180:183], a[152:155], v[112:115], v[180:183]
s_add_u32 s97, s94, 47104
buffer_load_dwordx4 v76, s[4:7], s97 offen offset:2048 lds
v_mfma_f32_16x16x32_bf16 v[180:183], a[156:159], v[116:119], v[180:183]
ds_read_b64_tr_b16 a[188:189], v67 offset:40968
v_mfma_f32_16x16x32_bf16 v[188:191], a[156:159], v[124:127], v[188:191]
ds_read_b64_tr_b16 a[190:191], v67 offset:41992
v_mfma_f32_16x16x32_bf16 v[188:191], a[152:155], v[120:123], v[188:191]
s_waitcnt lgkmcnt(12)
v_mfma_f32_16x16x32_bf16 v[192:195], a[160:163], v[96:99], v[192:195]
s_add_u32 s97, s94, 54272
buffer_load_dwordx4 v77, s[4:7], s97 offen offset:3072 lds
v_mfma_f32_16x16x32_bf16 v[192:195], a[164:167], v[100:103], v[192:195]
v_mfma_f32_16x16x32_bf16 v[200:203], a[164:167], v[108:111], v[200:203]
s_add_u32 s94, s93, 5
v_mfma_f32_16x16x32_bf16 v[200:203], a[160:163], v[104:107], v[200:203]
s_and_b32 s94, s94, 7
v_mfma_f32_16x16x32_bf16 v[208:211], a[160:163], v[112:115], v[208:211]
s_lshl_b32 s95, s94, 19
v_mfma_f32_16x16x32_bf16 v[208:211], a[164:167], v[116:119], v[208:211]
s_lshl_b32 s94, s94, 7
s_waitcnt vmcnt(12) lgkmcnt(0)
v_mfma_f32_16x16x32_bf16 v[216:219], a[164:167], v[124:127], v[216:219]
s_add_u32 m0, s27, 65536
s_barrier
v_mfma_f32_16x16x32_bf16 v[216:219], a[160:163], v[120:123], v[216:219]
s_add_u32 s97, s95, 0
buffer_load_dwordx4 v78, s[8:11], s97 offen offset:0 lds
v_mfma_f32_16x16x32_bf16 v[196:199], a[168:171], v[96:99], v[196:199]
ds_read_b128 v[32:35], v74 offset:0
v_mfma_f32_16x16x32_bf16 v[196:199], a[172:175], v[100:103], v[196:199]
ds_read_b128 v[36:39], v75 offset:0
v_mfma_f32_16x16x32_bf16 v[204:207], a[172:175], v[108:111], v[204:207]
ds_read_b128 v[40:43], v74 offset:2048
v_mfma_f32_16x16x32_bf16 v[204:207], a[168:171], v[104:107], v[204:207]
s_add_u32 s97, s95, 31744
buffer_load_dwordx4 v78, s[8:11], s97 offen offset:1024 lds
v_mfma_f32_16x16x32_bf16 v[212:215], a[168:171], v[112:115], v[212:215]
ds_read_b128 v[44:47], v75 offset:2048
v_mfma_f32_16x16x32_bf16 v[212:215], a[172:175], v[116:119], v[212:215]
ds_read_b128 v[48:51], v74 offset:4096
v_mfma_f32_16x16x32_bf16 v[220:223], a[172:175], v[124:127], v[220:223]
ds_read_b128 v[52:55], v75 offset:4096
v_mfma_f32_16x16x32_bf16 v[220:223], a[168:171], v[120:123], v[220:223]
s_add_u32 s97, s95, 63488
buffer_load_dwordx4 v79, s[8:11], s97 offen offset:2048 lds
v_mfma_f32_16x16x32_bf16 v[224:227], a[176:179], v[96:99], v[224:227]
ds_read_b128 v[56:59], v74 offset:6144
v_mfma_f32_16x16x32_bf16 v[224:227], a[180:183], v[100:103], v[224:227]
ds_read_b128 v[60:63], v75 offset:6144
v_mfma_f32_16x16x32_bf16 v[232:235], a[180:183], v[108:111], v[232:235]
v_mfma_f32_16x16x32_bf16 v[232:235], a[176:179], v[104:107], v[232:235]
s_add_u32 s97, s95, 95232
buffer_load_dwordx4 v79, s[8:11], s97 offen offset:3072 lds
v_mfma_f32_16x16x32_bf16 v[240:243], a[176:179], v[112:115], v[240:243]
ds_read_b64_tr_b16 a[192:193], v64 offset:0
v_mfma_f32_16x16x32_bf16 v[240:243], a[180:183], v[116:119], v[240:243]
ds_read_b64_tr_b16 a[194:195], v64 offset:1024
v_mfma_f32_16x16x32_bf16 v[248:251], a[180:183], v[124:127], v[248:251]
s_waitcnt lgkmcnt(2)
ds_read_b64_tr_b16 a[196:197], v64 offset:8192
v_mfma_f32_16x16x32_bf16 v[248:251], a[176:179], v[120:123], v[248:251]
s_add_u32 m0, s28, 131072
v_mfma_f32_16x16x32_bf16 v[228:231], a[184:187], v[96:99], v[228:231]
s_add_u32 s97, s94, 0
buffer_load_dwordx4 v76, s[4:7], s97 offen offset:0 lds
v_mfma_f32_16x16x32_bf16 v[228:231], a[188:191], v[100:103], v[228:231]
ds_read_b64_tr_b16 a[198:199], v64 offset:9216
v_mfma_f32_16x16x32_bf16 v[236:239], a[188:191], v[108:111], v[236:239]
ds_read_b64_tr_b16 a[200:201], v64 offset:8
v_mfma_f32_16x16x32_bf16 v[236:239], a[184:187], v[104:107], v[236:239]
v_mfma_f32_16x16x32_bf16 v[244:247], a[184:187], v[112:115], v[244:247]
s_add_u32 s97, s94, 7168
buffer_load_dwordx4 v77, s[4:7], s97 offen offset:1024 lds
v_mfma_f32_16x16x32_bf16 v[244:247], a[188:191], v[116:119], v[244:247]
ds_read_b64_tr_b16 a[202:203], v64 offset:1032
ds_read_b64_tr_b16 a[204:205], v64 offset:8200
v_mfma_f32_16x16x32_bf16 v[252:255], a[188:191], v[124:127], v[252:255]
ds_read_b64_tr_b16 a[206:207], v64 offset:9224
v_mfma_f32_16x16x32_bf16 v[252:255], a[184:187], v[120:123], v[252:255]
s_waitcnt lgkmcnt(4)
v_mfma_f32_16x16x32_bf16 v[128:131], a[192:195], v[32:35], v[128:131]
s_add_u32 s97, s94, 14336
buffer_load_dwordx4 v76, s[4:7], s97 offen offset:2048 lds
v_mfma_f32_16x16x32_bf16 v[128:131], a[196:199], v[36:39], v[128:131]
ds_read_b64_tr_b16 a[208:209], v65 offset:0
ds_read_b64_tr_b16 a[210:211], v65 offset:1024
v_mfma_f32_16x16x32_bf16 v[136:139], a[196:199], v[44:47], v[136:139]
ds_read_b64_tr_b16 a[212:213], v65 offset:8192
v_mfma_f32_16x16x32_bf16 v[136:139], a[192:195], v[40:43], v[136:139]
v_mfma_f32_16x16x32_bf16 v[144:147], a[192:195], v[48:51], v[144:147]
s_add_u32 s97, s94, 21504
buffer_load_dwordx4 v77, s[4:7], s97 offen offset:3072 lds
v_mfma_f32_16x16x32_bf16 v[144:147], a[196:199], v[52:55], v[144:147]
ds_read_b64_tr_b16 a[214:215], v65 offset:9216
ds_read_b64_tr_b16 a[216:217], v65 offset:8
v_mfma_f32_16x16x32_bf16 v[152:155], a[196:199], v[60:63], v[152:155]
ds_read_b64_tr_b16 a[218:219], v65 offset:1032
v_mfma_f32_16x16x32_bf16 v[152:155], a[192:195], v[56:59], v[152:155]
s_add_u32 m0, s28, 135168
s_waitcnt lgkmcnt(6)
ds_read_b64_tr_b16 a[220:221], v65 offset:8200
v_mfma_f32_16x16x32_bf16 v[132:135], a[200:203], v[32:35], v[132:135]
s_add_u32 s97, s94, 32768
buffer_load_dwordx4 v76, s[4:7], s97 offen offset:0 lds
v_mfma_f32_16x16x32_bf16 v[132:135], a[204:207], v[36:39], v[132:135]
ds_read_b64_tr_b16 a[222:223], v65 offset:9224
v_mfma_f32_16x16x32_bf16 v[140:143], a[204:207], v[44:47], v[140:143]
ds_read_b64_tr_b16 a[224:225], v66 offset:0
v_mfma_f32_16x16x32_bf16 v[140:143], a[200:203], v[40:43], v[140:143]
ds_read_b64_tr_b16 a[226:227], v66 offset:1024
v_mfma_f32_16x16x32_bf16 v[148:151], a[200:203], v[48:51], v[148:151]
s_add_u32 s97, s94, 39936
buffer_load_dwordx4 v77, s[4:7], s97 offen offset:1024 lds
v_mfma_f32_16x16x32_bf16 v[148:151], a[204:207], v[52:55], v[148:151]
ds_read_b64_tr_b16 a[228:229], v66 offset:8192
v_mfma_f32_16x16x32_bf16 v[156:159], a[204:207], v[60:63], v[156:159]
ds_read_b64_tr_b16 a[230:231], v66 offset:9216
v_mfma_f32_16x16x32_bf16 v[156:159], a[200:203], v[56:59], v[156:159]
s_waitcnt lgkmcnt(8)
ds_read_b64_tr_b16 a[232:233], v66 offset:8
v_mfma_f32_16x16x32_bf16 v[160:163], a[208:211], v[32:35], v[160:163]
s_add_u32 s97, s94, 47104
buffer_load_dwordx4 v76, s[4:7], s97 offen offset:2048 lds
v_mfma_f32_16x16x32_bf16 v[160:163], a[212:215], v[36:39], v[160:163]
ds_read_b64_tr_b16 a[234:235], v66 offset:1032
v_mfma_f32_16x16x32_bf16 v[168:171], a[212:215], v[44:47], v[168:171]
ds_read_b64_tr_b16 a[236:237], v66 offset:8200
v_mfma_f32_16x16x32_bf16 v[168:171], a[208:211], v[40:43], v[168:171]
ds_read_b64_tr_b16 a[238:239], v66 offset:9224
v_mfma_f32_16x16x32_bf16 v[176:179], a[208:211], v[48:51], v[176:179]
s_add_u32 s97, s94, 54272
buffer_load_dwordx4 v77, s[4:7], s97 offen offset:3072 lds
v_mfma_f32_16x16x32_bf16 v[176:179], a[212:215], v[52:55], v[176:179]
ds_read_b64_tr_b16 a[240:241], v67 offset:0
v_mfma_f32_16x16x32_bf16 v[184:187], a[212:215], v[60:63], v[184:187]
s_add_u32 m0, s27, 0
ds_read_b64_tr_b16 a[242:243], v67 offset:1024
v_mfma_f32_16x16x32_bf16 v[184:187], a[208:211], v[56:59], v[184:187]
s_nop 0
s_waitcnt lgkmcnt(10)
buffer_load_dwordx4 v13, s[12:15], s49 offen offset:0 nt lds
v_mfma_f32_16x16x32_bf16 v[164:167], a[216:219], v[32:35], v[164:167]
ds_read_b64_tr_b16 a[244:245], v67 offset:8192
ds_read_b64_tr_b16 a[246:247], v67 offset:9216
v_mfma_f32_16x16x32_bf16 v[164:167], a[220:223], v[36:39], v[164:167]
v_mfma_f32_16x16x32_bf16 v[172:175], a[220:223], v[44:47], v[172:175]
buffer_load_dwordx4 v16, s[12:15], s49 offen offset:3072 nt lds
v_mfma_f32_16x16x32_bf16 v[172:175], a[216:219], v[40:43], v[172:175]
ds_read_b64_tr_b16 a[248:249], v67 offset:8
ds_read_b64_tr_b16 a[250:251], v67 offset:1032
v_mfma_f32_16x16x32_bf16 v[180:183], a[216:219], v[48:51], v[180:183]
ds_read_b64_tr_b16 a[252:253], v67 offset:8200
v_mfma_f32_16x16x32_bf16 v[180:183], a[220:223], v[52:55], v[180:183]
buffer_load_dwordx4 v14, s[12:15], s49 offen offset:1024 nt lds
v_mfma_f32_16x16x32_bf16 v[188:191], a[220:223], v[60:63], v[188:191]
ds_read_b64_tr_b16 a[254:255], v67 offset:9224
v_mfma_f32_16x16x32_bf16 v[188:191], a[216:219], v[56:59], v[188:191]
s_waitcnt lgkmcnt(12)
v_mfma_f32_16x16x32_bf16 v[192:195], a[224:227], v[32:35], v[192:195]
buffer_load_dwordx4 v15, s[12:15], s49 offen offset:2048 nt lds
v_mfma_f32_16x16x32_bf16 v[192:195], a[228:231], v[36:39], v[192:195]
v_mfma_f32_16x16x32_bf16 v[200:203], a[228:231], v[44:47], v[200:203]
s_add_u32 s94, s93, 6
v_mfma_f32_16x16x32_bf16 v[200:203], a[224:227], v[40:43], v[200:203]
s_and_b32 s94, s94, 7
v_mfma_f32_16x16x32_bf16 v[208:211], a[224:227], v[48:51], v[208:211]
s_lshl_b32 s95, s94, 19
v_mfma_f32_16x16x32_bf16 v[208:211], a[228:231], v[52:55], v[208:211]
s_lshl_b32 s94, s94, 7
s_waitcnt vmcnt(16) lgkmcnt(0)
v_mfma_f32_16x16x32_bf16 v[216:219], a[228:231], v[60:63], v[216:219]
s_add_u32 m0, s27, 32768
s_barrier
v_mfma_f32_16x16x32_bf16 v[216:219], a[224:227], v[56:59], v[216:219]
s_add_u32 s97, s95, 0
buffer_load_dwordx4 v78, s[8:11], s97 offen offset:0 lds
v_mfma_f32_16x16x32_bf16 v[196:199], a[232:235], v[32:35], v[196:199]
ds_read_b128 v[96:99], v72 offset:0
ds_read_b128 v[100:103], v73 offset:0
v_mfma_f32_16x16x32_bf16 v[196:199], a[236:239], v[36:39], v[196:199]
ds_read_b128 v[104:107], v72 offset:2048
ds_read_b128 v[108:111], v73 offset:2048
v_mfma_f32_16x16x32_bf16 v[204:207], a[236:239], v[44:47], v[204:207]
ds_read_b128 v[112:115], v72 offset:4096
ds_read_b128 v[116:119], v73 offset:4096
v_mfma_f32_16x16x32_bf16 v[204:207], a[232:235], v[40:43], v[204:207]
s_add_u32 s97, s95, 31744
buffer_load_dwordx4 v78, s[8:11], s97 offen offset:1024 lds
v_mfma_f32_16x16x32_bf16 v[212:215], a[232:235], v[48:51], v[212:215]
ds_read_b128 v[120:123], v72 offset:6144
ds_read_b128 v[124:127], v73 offset:6144
v_mfma_f32_16x16x32_bf16 v[212:215], a[236:239], v[52:55], v[212:215]
ds_read_b64_tr_b16 a[128:129], v64 offset:16384
v_mfma_f32_16x16x32_bf16 v[220:223], a[236:239], v[60:63], v[220:223]
v_mfma_f32_16x16x32_bf16 v[220:223], a[232:235], v[56:59], v[220:223]
s_add_u32 s97, s95, 63488
buffer_load_dwordx4 v79, s[8:11], s97 offen offset:2048 lds
v_mfma_f32_16x16x32_bf16 v[224:227], a[240:243], v[32:35], v[224:227]
ds_read_b64_tr_b16 a[130:131], v64 offset:17408
ds_read_b64_tr_b16 a[132:133], v64 offset:24576
v_mfma_f32_16x16x32_bf16 v[224:227], a[244:247], v[36:39], v[224:227]
ds_read_b64_tr_b16 a[134:135], v64 offset:25600
v_mfma_f32_16x16x32_bf16 v[232:235], a[244:247], v[44:47], v[232:235]
ds_read_b64_tr_b16 a[136:137], v64 offset:16392
v_mfma_f32_16x16x32_bf16 v[232:235], a[240:243], v[40:43], v[232:235]
s_add_u32 s97, s95, 95232
buffer_load_dwordx4 v79, s[8:11], s97 offen offset:3072 lds
v_mfma_f32_16x16x32_bf16 v[240:243], a[240:243], v[48:51], v[240:243]
ds_read_b64_tr_b16 a[138:139], v64 offset:17416
v_mfma_f32_16x16x32_bf16 v[240:243], a[244:247], v[52:55], v[240:243]
ds_read_b64_tr_b16 a[140:141], v64 offset:24584
v_mfma_f32_16x16x32_bf16 v[248:251], a[244:247], v[60:63], v[248:251]
s_waitcnt lgkmcnt(7)
ds_read_b64_tr_b16 a[142:143], v64 offset:25608
v_mfma_f32_16x16x32_bf16 v[248:251], a[240:243], v[56:59], v[248:251]
s_add_u32 m0, s28, 81920
v_mfma_f32_16x16x32_bf16 v[228:231], a[248:251], v[32:35], v[228:231]
s_add_u32 s97, s94, 0
buffer_load_dwordx4 v76, s[4:7], s97 offen offset:0 lds
v_mfma_f32_16x16x32_bf16 v[228:231], a[252:255], v[36:39], v[228:231]
ds_read_b64_tr_b16 a[144:145], v65 offset:16384
ds_read_b64_tr_b16 a[146:147], v65 offset:17408
v_mfma_f32_16x16x32_bf16 v[236:239], a[252:255], v[44:47], v[236:239]
ds_read_b64_tr_b16 a[148:149], v65 offset:24576
v_mfma_f32_16x16x32_bf16 v[236:239], a[248:251], v[40:43], v[236:239]
v_mfma_f32_16x16x32_bf16 v[244:247], a[248:251], v[48:51], v[244:247]
s_add_u32 s97, s94, 7168
buffer_load_dwordx4 v77, s[4:7], s97 offen offset:1024 lds
v_mfma_f32_16x16x32_bf16 v[244:247], a[252:255], v[52:55], v[244:247]
ds_read_b64_tr_b16 a[150:151], v65 offset:25600
ds_read_b64_tr_b16 a[152:153], v65 offset:16392
v_mfma_f32_16x16x32_bf16 v[252:255], a[252:255], v[60:63], v[252:255]
ds_read_b64_tr_b16 a[154:155], v65 offset:17416
v_mfma_f32_16x16x32_bf16 v[252:255], a[248:251], v[56:59], v[252:255]
s_waitcnt lgkmcnt(10)
ds_read_b64_tr_b16 a[156:157], v65 offset:24584
v_mfma_f32_16x16x32_bf16 v[128:131], a[128:131], v[96:99], v[128:131]
s_add_u32 s97, s94, 14336
buffer_load_dwordx4 v76, s[4:7], s97 offen offset:2048 lds
v_mfma_f32_16x16x32_bf16 v[128:131], a[132:135], v[100:103], v[128:131]
ds_read_b64_tr_b16 a[158:159], v65 offset:25608
v_mfma_f32_16x16x32_bf16 v[136:139], a[132:135], v[108:111], v[136:139]
ds_read_b64_tr_b16 a[160:161], v66 offset:16384
v_mfma_f32_16x16x32_bf16 v[136:139], a[128:131], v[104:107], v[136:139]
ds_read_b64_tr_b16 a[162:163], v66 offset:17408
v_mfma_f32_16x16x32_bf16 v[144:147], a[128:131], v[112:115], v[144:147]
s_add_u32 s97, s94, 21504
buffer_load_dwordx4 v77, s[4:7], s97 offen offset:3072 lds
v_mfma_f32_16x16x32_bf16 v[144:147], a[132:135], v[116:119], v[144:147]
ds_read_b64_tr_b16 a[164:165], v66 offset:24576
v_mfma_f32_16x16x32_bf16 v[152:155], a[132:135], v[124:127], v[152:155]
ds_read_b64_tr_b16 a[166:167], v66 offset:25600
v_mfma_f32_16x16x32_bf16 v[152:155], a[128:131], v[120:123], v[152:155]
s_add_u32 m0, s28, 86016
s_waitcnt lgkmcnt(12)
ds_read_b64_tr_b16 a[168:169], v66 offset:16392
v_mfma_f32_16x16x32_bf16 v[132:135], a[136:139], v[96:99], v[132:135]
s_add_u32 s97, s94, 32768
buffer_load_dwordx4 v76, s[4:7], s97 offen offset:0 lds
v_mfma_f32_16x16x32_bf16 v[132:135], a[140:143], v[100:103], v[132:135]
ds_read_b64_tr_b16 a[170:171], v66 offset:17416
v_mfma_f32_16x16x32_bf16 v[140:143], a[140:143], v[108:111], v[140:143]
ds_read_b64_tr_b16 a[172:173], v66 offset:24584
v_mfma_f32_16x16x32_bf16 v[140:143], a[136:139], v[104:107], v[140:143]
ds_read_b64_tr_b16 a[174:175], v66 offset:25608
v_mfma_f32_16x16x32_bf16 v[148:151], a[136:139], v[112:115], v[148:151]
s_add_u32 s97, s94, 39936
buffer_load_dwordx4 v77, s[4:7], s97 offen offset:1024 lds
v_mfma_f32_16x16x32_bf16 v[148:151], a[140:143], v[116:119], v[148:151]
ds_read_b64_tr_b16 a[176:177], v67 offset:16384
v_mfma_f32_16x16x32_bf16 v[156:159], a[140:143], v[124:127], v[156:159]
ds_read_b64_tr_b16 a[178:179], v67 offset:17408
v_mfma_f32_16x16x32_bf16 v[156:159], a[136:139], v[120:123], v[156:159]
s_waitcnt lgkmcnt(14)
ds_read_b64_tr_b16 a[180:181], v67 offset:24576
v_mfma_f32_16x16x32_bf16 v[160:163], a[144:147], v[96:99], v[160:163]
s_add_u32 s97, s94, 47104
buffer_load_dwordx4 v76, s[4:7], s97 offen offset:2048 lds
v_mfma_f32_16x16x32_bf16 v[160:163], a[148:151], v[100:103], v[160:163]
ds_read_b64_tr_b16 a[182:183], v67 offset:25600
v_mfma_f32_16x16x32_bf16 v[168:171], a[148:151], v[108:111], v[168:171]
ds_read_b64_tr_b16 a[184:185], v67 offset:16392
v_mfma_f32_16x16x32_bf16 v[168:171], a[144:147], v[104:107], v[168:171]
ds_read_b64_tr_b16 a[186:187], v67 offset:17416
v_mfma_f32_16x16x32_bf16 v[176:179], a[144:147], v[112:115], v[176:179]
s_add_u32 s97, s94, 54272
buffer_load_dwordx4 v77, s[4:7], s97 offen offset:3072 lds
v_mfma_f32_16x16x32_bf16 v[176:179], a[148:151], v[116:119], v[176:179]
ds_read_b64_tr_b16 a[188:189], v67 offset:24584
v_mfma_f32_16x16x32_bf16 v[184:187], a[148:151], v[124:127], v[184:187]
ds_read_b64_tr_b16 a[190:191], v67 offset:25608
v_mfma_f32_16x16x32_bf16 v[184:187], a[144:147], v[120:123], v[184:187]
s_waitcnt lgkmcnt(15)
v_mfma_f32_16x16x32_bf16 v[164:167], a[152:155], v[96:99], v[164:167]
v_mfma_f32_16x16x32_bf16 v[164:167], a[156:159], v[100:103], v[164:167]
v_mfma_f32_16x16x32_bf16 v[172:175], a[156:159], v[108:111], v[172:175]
s_add_u32 s94, s93, 7
v_mfma_f32_16x16x32_bf16 v[172:175], a[152:155], v[104:107], v[172:175]
s_and_b32 s94, s94, 7
v_mfma_f32_16x16x32_bf16 v[180:183], a[152:155], v[112:115], v[180:183]
s_lshl_b32 s95, s94, 19
v_mfma_f32_16x16x32_bf16 v[180:183], a[156:159], v[116:119], v[180:183]
s_lshl_b32 s94, s94, 7
s_waitcnt vmcnt(16) lgkmcnt(0)
v_mfma_f32_16x16x32_bf16 v[188:191], a[156:159], v[124:127], v[188:191]
s_add_u32 m0, s27, 49152
s_barrier
v_mfma_f32_16x16x32_bf16 v[188:191], a[152:155], v[120:123], v[188:191]
s_add_u32 s97, s95, 0
buffer_load_dwordx4 v78, s[8:11], s97 offen offset:0 lds
v_mfma_f32_16x16x32_bf16 v[192:195], a[160:163], v[96:99], v[192:195]
ds_read_b128 v[32:35], v74 offset:0
ds_read_b128 v[36:39], v75 offset:0
v_mfma_f32_16x16x32_bf16 v[192:195], a[164:167], v[100:103], v[192:195]
ds_read_b128 v[40:43], v74 offset:2048
ds_read_b128 v[44:47], v75 offset:2048
v_mfma_f32_16x16x32_bf16 v[200:203], a[164:167], v[108:111], v[200:203]
ds_read_b128 v[48:51], v74 offset:4096
ds_read_b128 v[52:55], v75 offset:4096
v_mfma_f32_16x16x32_bf16 v[200:203], a[160:163], v[104:107], v[200:203]
s_add_u32 s97, s95, 31744
buffer_load_dwordx4 v78, s[8:11], s97 offen offset:1024 lds
v_mfma_f32_16x16x32_bf16 v[208:211], a[160:163], v[112:115], v[208:211]
ds_read_b128 v[56:59], v74 offset:6144
ds_read_b128 v[60:63], v75 offset:6144
v_mfma_f32_16x16x32_bf16 v[208:211], a[164:167], v[116:119], v[208:211]
ds_read_b64_tr_b16 a[192:193], v64 offset:32768
ds_read_b64_tr_b16 a[194:195], v64 offset:33792
v_mfma_f32_16x16x32_bf16 v[216:219], a[164:167], v[124:127], v[216:219]
ds_read_b64_tr_b16 a[196:197], v64 offset:40960
ds_read_b64_tr_b16 a[198:199], v64 offset:41984
v_mfma_f32_16x16x32_bf16 v[216:219], a[160:163], v[120:123], v[216:219]
s_add_u32 s97, s95, 63488
buffer_load_dwordx4 v79, s[8:11], s97 offen offset:2048 lds
v_mfma_f32_16x16x32_bf16 v[196:199], a[168:171], v[96:99], v[196:199]
ds_read_b64_tr_b16 a[200:201], v64 offset:32776
ds_read_b64_tr_b16 a[202:203], v64 offset:33800
v_mfma_f32_16x16x32_bf16 v[196:199], a[172:175], v[100:103], v[196:199]
ds_read_b64_tr_b16 a[204:205], v64 offset:40968
ds_read_b64_tr_b16 a[206:207], v64 offset:41992
v_mfma_f32_16x16x32_bf16 v[204:207], a[172:175], v[108:111], v[204:207]
ds_read_b64_tr_b16 a[208:209], v65 offset:32768
ds_read_b64_tr_b16 a[210:211], v65 offset:33792
v_mfma_f32_16x16x32_bf16 v[204:207], a[168:171], v[104:107], v[204:207]
s_add_u32 s97, s95, 95232
buffer_load_dwordx4 v79, s[8:11], s97 offen offset:3072 lds
v_mfma_f32_16x16x32_bf16 v[212:215], a[168:171], v[112:115], v[212:215]
ds_read_b64_tr_b16 a[212:213], v65 offset:40960
ds_read_b64_tr_b16 a[214:215], v65 offset:41984
v_mfma_f32_16x16x32_bf16 v[212:215], a[172:175], v[116:119], v[212:215]
ds_read_b64_tr_b16 a[216:217], v65 offset:32776
ds_read_b64_tr_b16 a[218:219], v65 offset:33800
v_mfma_f32_16x16x32_bf16 v[220:223], a[172:175], v[124:127], v[220:223]
s_waitcnt lgkmcnt(14)
ds_read_b64_tr_b16 a[220:221], v65 offset:40968
ds_read_b64_tr_b16 a[222:223], v65 offset:41992
v_mfma_f32_16x16x32_bf16 v[220:223], a[168:171], v[120:123], v[220:223]
s_add_u32 m0, s28, 131072
ds_read_b64_tr_b16 a[224:225], v66 offset:32768
ds_read_b64_tr_b16 a[226:227], v66 offset:33792
v_mfma_f32_16x16x32_bf16 v[224:227], a[176:179], v[96:99], v[224:227]
s_add_u32 s97, s94, 0
buffer_load_dwordx4 v76, s[4:7], s97 offen offset:0 lds
v_mfma_f32_16x16x32_bf16 v[224:227], a[180:183], v[100:103], v[224:227]
ds_read_b64_tr_b16 a[228:229], v66 offset:40960
v_mfma_f32_16x16x32_bf16 v[232:235], a[180:183], v[108:111], v[232:235]
ds_read_b64_tr_b16 a[230:231], v66 offset:41984
v_mfma_f32_16x16x32_bf16 v[232:235], a[176:179], v[104:107], v[232:235]
ds_read_b64_tr_b16 a[232:233], v66 offset:32776
v_mfma_f32_16x16x32_bf16 v[240:243], a[176:179], v[112:115], v[240:243]
s_add_u32 s97, s94, 7168
buffer_load_dwordx4 v77, s[4:7], s97 offen offset:1024 lds
v_mfma_f32_16x16x32_bf16 v[240:243], a[180:183], v[116:119], v[240:243]
ds_read_b64_tr_b16 a[234:235], v66 offset:33800
v_mfma_f32_16x16x32_bf16 v[248:251], a[180:183], v[124:127], v[248:251]
ds_read_b64_tr_b16 a[236:237], v66 offset:40968
v_mfma_f32_16x16x32_bf16 v[248:251], a[176:179], v[120:123], v[248:251]
ds_read_b64_tr_b16 a[238:239], v66 offset:41992
v_mfma_f32_16x16x32_bf16 v[228:231], a[184:187], v[96:99], v[228:231]
s_add_u32 s97, s94, 14336
buffer_load_dwordx4 v76, s[4:7], s97 offen offset:2048 lds
v_mfma_f32_16x16x32_bf16 v[228:231], a[188:191], v[100:103], v[228:231]
ds_read_b64_tr_b16 a[240:241], v67 offset:32768
v_mfma_f32_16x16x32_bf16 v[236:239], a[188:191], v[108:111], v[236:239]
ds_read_b64_tr_b16 a[242:243], v67 offset:33792
v_mfma_f32_16x16x32_bf16 v[236:239], a[184:187], v[104:107], v[236:239]
ds_read_b64_tr_b16 a[244:245], v67 offset:40960
v_mfma_f32_16x16x32_bf16 v[244:247], a[184:187], v[112:115], v[244:247]
s_add_u32 s97, s94, 21504
buffer_load_dwordx4 v77, s[4:7], s97 offen offset:3072 lds
v_mfma_f32_16x16x32_bf16 v[244:247], a[188:191], v[116:119], v[244:247]
ds_read_b64_tr_b16 a[246:247], v67 offset:41984
v_mfma_f32_16x16x32_bf16 v[252:255], a[188:191], v[124:127], v[252:255]
ds_read_b64_tr_b16 a[248:249], v67 offset:32776
v_mfma_f32_16x16x32_bf16 v[252:255], a[184:187], v[120:123], v[252:255]
s_add_u32 m0, s28, 135168
s_waitcnt lgkmcnt(15)
ds_read_b64_tr_b16 a[250:251], v67 offset:33800
v_mfma_f32_16x16x32_bf16 v[128:131], a[192:195], v[32:35], v[128:131]
s_add_u32 s97, s94, 32768
buffer_load_dwordx4 v76, s[4:7], s97 offen offset:0 lds
v_mfma_f32_16x16x32_bf16 v[128:131], a[196:199], v[36:39], v[128:131]
ds_read_b64_tr_b16 a[252:253], v67 offset:40968
v_mfma_f32_16x16x32_bf16 v[136:139], a[196:199], v[44:47], v[136:139]
ds_read_b64_tr_b16 a[254:255], v67 offset:41992
v_mfma_f32_16x16x32_bf16 v[136:139], a[192:195], v[40:43], v[136:139]
v_mfma_f32_16x16x32_bf16 v[144:147], a[192:195], v[48:51], v[144:147]
s_add_u32 s97, s94, 39936
buffer_load_dwordx4 v77, s[4:7], s97 offen offset:1024 lds
v_mfma_f32_16x16x32_bf16 v[144:147], a[196:199], v[52:55], v[144:147]
v_mfma_f32_16x16x32_bf16 v[152:155], a[196:199], v[60:63], v[152:155]
v_mfma_f32_16x16x32_bf16 v[152:155], a[192:195], v[56:59], v[152:155]
v_mfma_f32_16x16x32_bf16 v[132:135], a[200:203], v[32:35], v[132:135]
s_add_u32 s97, s94, 47104
buffer_load_dwordx4 v76, s[4:7], s97 offen offset:2048 lds
v_mfma_f32_16x16x32_bf16 v[132:135], a[204:207], v[36:39], v[132:135]
s_waitcnt vmcnt(11) lgkmcnt(0)
v_mfma_f32_16x16x32_bf16 v[140:143], a[204:207], v[44:47], v[140:143]
s_barrier
v_mfma_f32_16x16x32_bf16 v[140:143], a[200:203], v[40:43], v[140:143]
ds_read_b128 v[96:99], v72 offset:0
ds_read_b128 v[100:103], v73 offset:0
v_mfma_f32_16x16x32_bf16 v[148:151], a[200:203], v[48:51], v[148:151]
s_add_u32 s97, s94, 54272
buffer_load_dwordx4 v77, s[4:7], s97 offen offset:3072 lds
v_mfma_f32_16x16x32_bf16 v[148:151], a[204:207], v[52:55], v[148:151]
ds_read_b128 v[104:107], v72 offset:2048
ds_read_b128 v[108:111], v73 offset:2048
v_mfma_f32_16x16x32_bf16 v[156:159], a[204:207], v[60:63], v[156:159]
ds_read_b128 v[112:115], v72 offset:4096
ds_read_b128 v[116:119], v73 offset:4096
v_mfma_f32_16x16x32_bf16 v[156:159], a[200:203], v[56:59], v[156:159]
ds_read_b128 v[120:123], v72 offset:6144
ds_read_b128 v[124:127], v73 offset:6144
v_mfma_f32_16x16x32_bf16 v[160:163], a[208:211], v[32:35], v[160:163]
ds_read_b64_tr_b16 a[128:129], v64 offset:0
ds_read_b64_tr_b16 a[130:131], v64 offset:1024
v_mfma_f32_16x16x32_bf16 v[160:163], a[212:215], v[36:39], v[160:163]
ds_read_b64_tr_b16 a[132:133], v64 offset:8192
ds_read_b64_tr_b16 a[134:135], v64 offset:9216
v_mfma_f32_16x16x32_bf16 v[168:171], a[212:215], v[44:47], v[168:171]
ds_read_b64_tr_b16 a[136:137], v64 offset:8
ds_read_b64_tr_b16 a[138:139], v64 offset:1032
v_mfma_f32_16x16x32_bf16 v[168:171], a[208:211], v[40:43], v[168:171]
ds_read_b64_tr_b16 a[140:141], v64 offset:8200
ds_read_b64_tr_b16 a[142:143], v64 offset:9224
v_mfma_f32_16x16x32_bf16 v[176:179], a[208:211], v[48:51], v[176:179]
s_add_u32 m0, s27, 114688
ds_read_b64_tr_b16 a[144:145], v65 offset:0
ds_read_b64_tr_b16 a[146:147], v65 offset:1024
v_mfma_f32_16x16x32_bf16 v[176:179], a[212:215], v[52:55], v[176:179]
s_mov_b32 s97, 0
buffer_load_dwordx4 v25, s[84:87], s97 offen offset:0 nt lds
v_mfma_f32_16x16x32_bf16 v[184:187], a[212:215], v[60:63], v[184:187]
ds_read_b64_tr_b16 a[148:149], v65 offset:8192
ds_read_b64_tr_b16 a[150:151], v65 offset:9216
v_mfma_f32_16x16x32_bf16 v[184:187], a[208:211], v[56:59], v[184:187]
ds_read_b64_tr_b16 a[152:153], v65 offset:8
ds_read_b64_tr_b16 a[154:155], v65 offset:1032
v_mfma_f32_16x16x32_bf16 v[164:167], a[216:219], v[32:35], v[164:167]
ds_read_b64_tr_b16 a[156:157], v65 offset:8200
ds_read_b64_tr_b16 a[158:159], v65 offset:9224
v_mfma_f32_16x16x32_bf16 v[164:167], a[220:223], v[36:39], v[164:167]
ds_read_b64_tr_b16 a[160:161], v66 offset:0
ds_read_b64_tr_b16 a[162:163], v66 offset:1024
v_mfma_f32_16x16x32_bf16 v[172:175], a[220:223], v[44:47], v[172:175]
ds_read_b64_tr_b16 a[164:165], v66 offset:8192
ds_read_b64_tr_b16 a[166:167], v66 offset:9216
v_mfma_f32_16x16x32_bf16 v[172:175], a[216:219], v[40:43], v[172:175]
ds_read_b64_tr_b16 a[168:169], v66 offset:8
v_mfma_f32_16x16x32_bf16 v[180:183], a[216:219], v[48:51], v[180:183]
v_mfma_f32_16x16x32_bf16 v[180:183], a[220:223], v[52:55], v[180:183]
ds_read_b64_tr_b16 a[170:171], v66 offset:1032
v_mfma_f32_16x16x32_bf16 v[188:191], a[220:223], v[60:63], v[188:191]
s_mov_b32 s97, 1024
buffer_load_dwordx4 v25, s[84:87], s97 offen offset:1024 nt lds
v_mfma_f32_16x16x32_bf16 v[188:191], a[216:219], v[56:59], v[188:191]
ds_read_b64_tr_b16 a[172:173], v66 offset:8200
ds_read_b64_tr_b16 a[174:175], v66 offset:9224
v_mfma_f32_16x16x32_bf16 v[192:195], a[224:227], v[32:35], v[192:195]
ds_read_b64_tr_b16 a[176:177], v67 offset:0
v_mfma_f32_16x16x32_bf16 v[192:195], a[228:231], v[36:39], v[192:195]
v_mfma_f32_16x16x32_bf16 v[200:203], a[228:231], v[44:47], v[200:203]
ds_read_b64_tr_b16 a[178:179], v67 offset:1024
v_mfma_f32_16x16x32_bf16 v[200:203], a[224:227], v[40:43], v[200:203]
ds_read_b64_tr_b16 a[180:181], v67 offset:8192
v_mfma_f32_16x16x32_bf16 v[208:211], a[224:227], v[48:51], v[208:211]
ds_read_b64_tr_b16 a[182:183], v67 offset:9216
v_mfma_f32_16x16x32_bf16 v[208:211], a[228:231], v[52:55], v[208:211]
v_mfma_f32_16x16x32_bf16 v[216:219], a[228:231], v[60:63], v[216:219]
ds_read_b64_tr_b16 a[184:185], v67 offset:8
v_mfma_f32_16x16x32_bf16 v[216:219], a[224:227], v[56:59], v[216:219]
s_mov_b32 s97, 2048
buffer_load_dwordx4 v25, s[84:87], s97 offen offset:2048 nt lds
v_mfma_f32_16x16x32_bf16 v[196:199], a[232:235], v[32:35], v[196:199]
ds_read_b64_tr_b16 a[186:187], v67 offset:1032
ds_read_b64_tr_b16 a[188:189], v67 offset:8200
v_mfma_f32_16x16x32_bf16 v[196:199], a[236:239], v[36:39], v[196:199]
v_mfma_f32_16x16x32_bf16 v[204:207], a[236:239], v[44:47], v[204:207]
ds_read_b64_tr_b16 a[190:191], v67 offset:9224
v_mfma_f32_16x16x32_bf16 v[204:207], a[232:235], v[40:43], v[204:207]
v_mfma_f32_16x16x32_bf16 v[212:215], a[232:235], v[48:51], v[212:215]
v_mfma_f32_16x16x32_bf16 v[212:215], a[236:239], v[52:55], v[212:215]
v_mfma_f32_16x16x32_bf16 v[220:223], a[236:239], v[60:63], v[220:223]
v_mfma_f32_16x16x32_bf16 v[220:223], a[232:235], v[56:59], v[220:223]
v_mfma_f32_16x16x32_bf16 v[224:227], a[240:243], v[32:35], v[224:227]
s_mov_b32 s97, 3072
buffer_load_dwordx4 v25, s[84:87], s97 offen offset:3072 nt lds
v_mfma_f32_16x16x32_bf16 v[224:227], a[244:247], v[36:39], v[224:227]
s_waitcnt vmcnt(4) lgkmcnt(0)
v_mfma_f32_16x16x32_bf16 v[232:235], a[244:247], v[44:47], v[232:235]
s_barrier
v_mfma_f32_16x16x32_bf16 v[232:235], a[240:243], v[40:43], v[232:235]
ds_read_b64_tr_b16 a[192:193], v64 offset:16384
v_mfma_f32_16x16x32_bf16 v[240:243], a[240:243], v[48:51], v[240:243]
v_mfma_f32_16x16x32_bf16 v[240:243], a[244:247], v[52:55], v[240:243]
s_or_b32 s49, s49, 0xffff87ff
ds_read_b64_tr_b16 a[194:195], v64 offset:17408
v_mfma_f32_16x16x32_bf16 v[248:251], a[244:247], v[60:63], v[248:251]
s_add_u32 s49, s49, 1
v_mfma_f32_16x16x32_bf16 v[248:251], a[240:243], v[56:59], v[248:251]
s_and_b32 s49, s49, 0x7800
ds_read_b64_tr_b16 a[196:197], v64 offset:24576
v_mfma_f32_16x16x32_bf16 v[228:231], a[248:251], v[32:35], v[228:231]
s_add_u32 m0, s27, 16384
v_mfma_f32_16x16x32_bf16 v[228:231], a[252:255], v[36:39], v[228:231]
s_nop 0
buffer_load_dwordx4 v13, s[12:15], s49 offen offset:0 nt lds
v_mfma_f32_16x16x32_bf16 v[236:239], a[252:255], v[44:47], v[236:239]
ds_read_b64_tr_b16 a[198:199], v64 offset:25600
v_mfma_f32_16x16x32_bf16 v[236:239], a[248:251], v[40:43], v[236:239]
v_mfma_f32_16x16x32_bf16 v[244:247], a[248:251], v[48:51], v[244:247]
ds_read_b128 v[32:35], v74 offset:0
v_mfma_f32_16x16x32_bf16 v[244:247], a[252:255], v[52:55], v[244:247]
v_mfma_f32_16x16x32_bf16 v[252:255], a[252:255], v[60:63], v[252:255]
ds_read_b128 v[36:39], v75 offset:0
v_mfma_f32_16x16x32_bf16 v[252:255], a[248:251], v[56:59], v[252:255]
v_mfma_f32_16x16x32_bf16 v[128:131], a[128:131], v[96:99], v[128:131]
ds_read_b64_tr_b16 a[200:201], v64 offset:16392
v_mfma_f32_16x16x32_bf16 v[128:131], a[132:135], v[100:103], v[128:131]
v_mfma_f32_16x16x32_bf16 v[132:135], a[140:143], v[100:103], v[132:135]
buffer_load_dwordx4 v16, s[12:15], s49 offen offset:3072 nt lds
v_mfma_f32_16x16x32_bf16 v[132:135], a[136:139], v[96:99], v[132:135]
ds_read_b64_tr_b16 a[202:203], v64 offset:17416
v_mfma_f32_16x16x32_bf16 v[160:163], a[144:147], v[96:99], v[160:163]
ds_read_b64_tr_b16 a[204:205], v64 offset:24584
v_mfma_f32_16x16x32_bf16 v[160:163], a[148:151], v[100:103], v[160:163]
v_mfma_f32_16x16x32_bf16 v[164:167], a[156:159], v[100:103], v[164:167]
ds_read_b64_tr_b16 a[206:207], v64 offset:25608
v_mfma_f32_16x16x32_bf16 v[164:167], a[152:155], v[96:99], v[164:167]
ds_read_b64_tr_b16 a[208:209], v65 offset:16384
v_mfma_f32_16x16x32_bf16 v[192:195], a[160:163], v[96:99], v[192:195]
ds_read_b64_tr_b16 a[210:211], v65 offset:17408
v_mfma_f32_16x16x32_bf16 v[192:195], a[164:167], v[100:103], v[192:195]
v_mfma_f32_16x16x32_bf16 v[196:199], a[172:175], v[100:103], v[196:199]
ds_read_b64_tr_b16 a[212:213], v65 offset:24576
v_mfma_f32_16x16x32_bf16 v[196:199], a[168:171], v[96:99], v[196:199]
buffer_load_dwordx4 v14, s[12:15], s49 offen offset:1024 nt lds
v_mfma_f32_16x16x32_bf16 v[224:227], a[176:179], v[96:99], v[224:227]
ds_read_b64_tr_b16 a[214:215], v65 offset:25600
ds_read_b64_tr_b16 a[216:217], v65 offset:16392
v_mfma_f32_16x16x32_bf16 v[224:227], a[180:183], v[100:103], v[224:227]
v_mfma_f32_16x16x32_bf16 v[228:231], a[188:191], v[100:103], v[228:231]
ds_read_b64_tr_b16 a[218:219], v65 offset:17416
v_mfma_f32_16x16x32_bf16 v[228:231], a[184:187], v[96:99], v[228:231]
ds_read_b64_tr_b16 a[220:221], v65 offset:24584
v_mfma_f32_16x16x32_bf16 v[136:139], a[128:131], v[104:107], v[136:139]
ds_read_b64_tr_b16 a[222:223], v65 offset:25608
v_mfma_f32_16x16x32_bf16 v[136:139], a[132:135], v[108:111], v[136:139]
ds_read_b64_tr_b16 a[224:225], v66 offset:16384
v_mfma_f32_16x16x32_bf16 v[140:143], a[140:143], v[108:111], v[140:143]
v_mfma_f32_16x16x32_bf16 v[140:143], a[136:139], v[104:107], v[140:143]
ds_read_b64_tr_b16 a[226:227], v66 offset:17408
v_mfma_f32_16x16x32_bf16 v[168:171], a[144:147], v[104:107], v[168:171]
buffer_load_dwordx4 v15, s[12:15], s49 offen offset:2048 nt lds
v_mfma_f32_16x16x32_bf16 v[168:171], a[148:151], v[108:111], v[168:171]
ds_read_b64_tr_b16 a[228:229], v66 offset:24576
ds_read_b64_tr_b16 a[230:231], v66 offset:25600
v_mfma_f32_16x16x32_bf16 v[172:175], a[156:159], v[108:111], v[172:175]
v_mfma_f32_16x16x32_bf16 v[172:175], a[152:155], v[104:107], v[172:175]
ds_read_b64_tr_b16 a[232:233], v66 offset:16392
v_mfma_f32_16x16x32_bf16 v[200:203], a[160:163], v[104:107], v[200:203]
ds_read_b64_tr_b16 a[234:235], v66 offset:17416
v_mfma_f32_16x16x32_bf16 v[200:203], a[164:167], v[108:111], v[200:203]
ds_read_b64_tr_b16 a[236:237], v66 offset:24584
v_mfma_f32_16x16x32_bf16 v[204:207], a[172:175], v[108:111], v[204:207]
v_mfma_f32_16x16x32_bf16 v[204:207], a[168:171], v[104:107], v[204:207]
ds_read_b64_tr_b16 a[238:239], v66 offset:25608
v_mfma_f32_16x16x32_bf16 v[232:235], a[176:179], v[104:107], v[232:235]
s_add_u32 m0, s27, 65536
ds_read_b64_tr_b16 a[240:241], v67 offset:16384
v_mfma_f32_16x16x32_bf16 v[232:235], a[180:183], v[108:111], v[232:235]
s_nop 0
buffer_load_dwordx4 v17, s[16:19], s44 offen offset:0 nt lds
v_mfma_f32_16x16x32_bf16 v[236:239], a[188:191], v[108:111], v[236:239]
ds_read_b64_tr_b16 a[242:243], v67 offset:17408
ds_read_b64_tr_b16 a[244:245], v67 offset:24576
v_mfma_f32_16x16x32_bf16 v[236:239], a[184:187], v[104:107], v[236:239]
s_waitcnt lgkmcnt(15)
v_mfma_f32_16x16x32_bf16 v[128:131], a[192:195], v[32:35], v[128:131]
ds_read_b64_tr_b16 a[246:247], v67 offset:25600
v_mfma_f32_16x16x32_bf16 v[128:131], a[196:199], v[36:39], v[128:131]
ds_read_b64_tr_b16 a[248:249], v67 offset:16392
v_mfma_f32_16x16x32_bf16 v[132:135], a[204:207], v[36:39], v[132:135]
ds_read_b64_tr_b16 a[250:251], v67 offset:17416
v_mfma_f32_16x16x32_bf16 v[132:135], a[200:203], v[32:35], v[132:135]
v_mfma_f32_16x16x32_bf16 v[160:163], a[208:211], v[32:35], v[160:163]
ds_read_b64_tr_b16 a[252:253], v67 offset:24584
v_mfma_f32_16x16x32_bf16 v[160:163], a[212:215], v[36:39], v[160:163]
s_waitcnt lgkmcnt(15)
ds_read_b64_tr_b16 a[254:255], v67 offset:25608
v_mfma_f32_16x16x32_bf16 v[164:167], a[220:223], v[36:39], v[164:167]
s_add_u32 s92, s44, 129024
buffer_load_dwordx4 v18, s[16:19], s92 offen offset:3072 nt lds
v_mfma_f32_16x16x32_bf16 v[164:167], a[216:219], v[32:35], v[164:167]
s_waitcnt lgkmcnt(12)
ds_read_b128 v[40:43], v74 offset:2048
v_mul_f32 v128, s47, v128
v_mfma_f32_16x16x32_bf16 v[192:195], a[224:227], v[32:35], v[192:195]
ds_read_b128 v[44:47], v75 offset:2048
v_mul_f32 v129, s47, v129
v_mfma_f32_16x16x32_bf16 v[192:195], a[228:231], v[36:39], v[192:195]
s_waitcnt lgkmcnt(10)
v_mul_f32 v130, s47, v130
v_mul_f32 v131, s47, v131
v_mfma_f32_16x16x32_bf16 v[196:199], a[236:239], v[36:39], v[196:199]
ds_read_b128 v[48:51], v74 offset:4096
v_mul_f32 v132, s47, v132
v_mfma_f32_16x16x32_bf16 v[196:199], a[232:235], v[32:35], v[196:199]
s_waitcnt lgkmcnt(7)
v_mul_f32 v133, s47, v133
v_mul_f32 v134, s47, v134
v_mfma_f32_16x16x32_bf16 v[224:227], a[240:243], v[32:35], v[224:227]
ds_read_b128 v[52:55], v75 offset:4096
v_mul_f32 v135, s47, v135
v_mfma_f32_16x16x32_bf16 v[224:227], a[244:247], v[36:39], v[224:227]
s_waitcnt lgkmcnt(4)
v_cvt_pk_bf16_f32 v64, v128, v129
v_cvt_pk_bf16_f32 v66, v132, v133
v_mfma_f32_16x16x32_bf16 v[228:231], a[252:255], v[36:39], v[228:231]
ds_read_b128 v[56:59], v74 offset:6144
v_cvt_pk_bf16_f32 v65, v130, v131
v_mfma_f32_16x16x32_bf16 v[228:231], a[248:251], v[32:35], v[228:231]
s_waitcnt lgkmcnt(3)
buffer_load_dwordx4 v18, s[16:19], s44 offen offset:1024 nt lds
v_mfma_f32_16x16x32_bf16 v[136:139], a[192:195], v[40:43], v[136:139]
ds_read_b128 v[60:63], v75 offset:6144
v_cvt_pk_bf16_f32 v67, v134, v135
v_mfma_f32_16x16x32_bf16 v[136:139], a[196:199], v[44:47], v[136:139]
v_mul_f32 v160, s47, v160
v_mul_f32 v161, s47, v161
v_mfma_f32_16x16x32_bf16 v[140:143], a[204:207], v[44:47], v[140:143]
v_mul_f32 v162, s47, v162
v_mul_f32 v163, s47, v163
v_mfma_f32_16x16x32_bf16 v[140:143], a[200:203], v[40:43], v[140:143]
v_mul_f32 v164, s47, v164
v_mul_f32 v165, s47, v165
v_mfma_f32_16x16x32_bf16 v[168:171], a[208:211], v[40:43], v[168:171]
v_mul_f32 v166, s47, v166
v_mul_f32 v167, s47, v167
v_mfma_f32_16x16x32_bf16 v[168:171], a[212:215], v[44:47], v[168:171]
v_cvt_pk_bf16_f32 v68, v160, v161
v_cvt_pk_bf16_f32 v70, v164, v165
v_mfma_f32_16x16x32_bf16 v[172:175], a[220:223], v[44:47], v[172:175]
v_cvt_pk_bf16_f32 v69, v162, v163
v_cvt_pk_bf16_f32 v71, v166, v167
v_mfma_f32_16x16x32_bf16 v[172:175], a[216:219], v[40:43], v[172:175]
v_mul_f32 v192, s47, v192
v_mul_f32 v193, s47, v193
v_mfma_f32_16x16x32_bf16 v[200:203], a[224:227], v[40:43], v[200:203]
buffer_load_dwordx4 v17, s[16:19], s92 offen offset:2048 nt lds
v_mfma_f32_16x16x32_bf16 v[200:203], a[228:231], v[44:47], v[200:203]
v_mul_f32 v194, s47, v194
v_mul_f32 v195, s47, v195
v_mfma_f32_16x16x32_bf16 v[204:207], a[236:239], v[44:47], v[204:207]
v_mul_f32 v196, s47, v196
v_mul_f32 v197, s47, v197
v_mfma_f32_16x16x32_bf16 v[204:207], a[232:235], v[40:43], v[204:207]
v_mul_f32 v198, s47, v198
v_mul_f32 v199, s47, v199
v_mfma_f32_16x16x32_bf16 v[232:235], a[240:243], v[40:43], v[232:235]
v_cvt_pk_bf16_f32 v72, v192, v193
v_cvt_pk_bf16_f32 v74, v196, v197
v_mfma_f32_16x16x32_bf16 v[232:235], a[244:247], v[44:47], v[232:235]
v_cvt_pk_bf16_f32 v73, v194, v195
v_cvt_pk_bf16_f32 v75, v198, v199
v_mfma_f32_16x16x32_bf16 v[236:239], a[252:255], v[44:47], v[236:239]
v_mul_f32 v224, s47, v224
v_mul_f32 v225, s47, v225
v_mfma_f32_16x16x32_bf16 v[236:239], a[248:251], v[40:43], v[236:239]
v_mul_f32 v226, s47, v226
v_mul_f32 v227, s47, v227
v_mfma_f32_16x16x32_bf16 v[144:147], a[128:131], v[112:115], v[144:147]
v_mul_f32 v228, s47, v228
v_mul_f32 v229, s47, v229
v_mfma_f32_16x16x32_bf16 v[144:147], a[132:135], v[116:119], v[144:147]
v_mul_f32 v230, s47, v230
v_mul_f32 v231, s47, v231
v_mfma_f32_16x16x32_bf16 v[148:151], a[140:143], v[116:119], v[148:151]
v_cvt_pk_bf16_f32 v76, v224, v225
v_cvt_pk_bf16_f32 v78, v228, v229
v_mfma_f32_16x16x32_bf16 v[148:151], a[136:139], v[112:115], v[148:151]
v_cvt_pk_bf16_f32 v77, v226, v227
v_cvt_pk_bf16_f32 v79, v230, v231
v_mfma_f32_16x16x32_bf16 v[176:179], a[144:147], v[112:115], v[176:179]
v_mul_f32 v136, s47, v136
v_mul_f32 v137, s47, v137
v_mfma_f32_16x16x32_bf16 v[176:179], a[148:151], v[116:119], v[176:179]
v_mul_f32 v138, s47, v138
v_mul_f32 v139, s47, v139
v_mfma_f32_16x16x32_bf16 v[180:183], a[156:159], v[116:119], v[180:183]
v_mul_f32 v140, s47, v140
v_mul_f32 v141, s47, v141
v_mfma_f32_16x16x32_bf16 v[180:183], a[152:155], v[112:115], v[180:183]
v_mul_f32 v142, s47, v142
v_mul_f32 v143, s47, v143
v_mfma_f32_16x16x32_bf16 v[208:211], a[160:163], v[112:115], v[208:211]
v_cvt_pk_bf16_f32 v80, v136, v137
v_cvt_pk_bf16_f32 v82, v140, v141
v_mfma_f32_16x16x32_bf16 v[208:211], a[164:167], v[116:119], v[208:211]
v_cvt_pk_bf16_f32 v81, v138, v139
v_cvt_pk_bf16_f32 v83, v142, v143
v_mfma_f32_16x16x32_bf16 v[212:215], a[172:175], v[116:119], v[212:215]
v_mul_f32 v168, s47, v168
v_mul_f32 v169, s47, v169
v_mfma_f32_16x16x32_bf16 v[212:215], a[168:171], v[112:115], v[212:215]
v_mul_f32 v170, s47, v170
v_mul_f32 v171, s47, v171
v_mfma_f32_16x16x32_bf16 v[240:243], a[176:179], v[112:115], v[240:243]
v_mul_f32 v172, s47, v172
v_mul_f32 v173, s47, v173
v_mfma_f32_16x16x32_bf16 v[240:243], a[180:183], v[116:119], v[240:243]
v_mul_f32 v174, s47, v174
v_mul_f32 v175, s47, v175
v_mfma_f32_16x16x32_bf16 v[244:247], a[188:191], v[116:119], v[244:247]
v_cvt_pk_bf16_f32 v84, v168, v169
v_cvt_pk_bf16_f32 v86, v172, v173
v_mfma_f32_16x16x32_bf16 v[244:247], a[184:187], v[112:115], v[244:247]
v_cvt_pk_bf16_f32 v85, v170, v171
v_cvt_pk_bf16_f32 v87, v174, v175
v_mfma_f32_16x16x32_bf16 v[152:155], a[128:131], v[120:123], v[152:155]
v_mul_f32 v200, s47, v200
v_mul_f32 v201, s47, v201
v_mfma_f32_16x16x32_bf16 v[152:155], a[132:135], v[124:127], v[152:155]
v_mul_f32 v202, s47, v202
v_mul_f32 v203, s47, v203
v_mfma_f32_16x16x32_bf16 v[156:159], a[140:143], v[124:127], v[156:159]
v_mul_f32 v204, s47, v204
v_mul_f32 v205, s47, v205
v_mfma_f32_16x16x32_bf16 v[156:159], a[136:139], v[120:123], v[156:159]
v_mul_f32 v206, s47, v206
v_mul_f32 v207, s47, v207
v_mfma_f32_16x16x32_bf16 v[184:187], a[144:147], v[120:123], v[184:187]
v_cvt_pk_bf16_f32 v88, v200, v201
v_cvt_pk_bf16_f32 v90, v204, v205
v_mfma_f32_16x16x32_bf16 v[184:187], a[148:151], v[124:127], v[184:187]
v_cvt_pk_bf16_f32 v89, v202, v203
v_cvt_pk_bf16_f32 v91, v206, v207
v_mfma_f32_16x16x32_bf16 v[188:191], a[156:159], v[124:127], v[188:191]
v_mul_f32 v232, s47, v232
v_mul_f32 v233, s47, v233
v_mfma_f32_16x16x32_bf16 v[188:191], a[152:155], v[120:123], v[188:191]
v_mul_f32 v234, s47, v234
v_mul_f32 v235, s47, v235
v_mfma_f32_16x16x32_bf16 v[216:219], a[160:163], v[120:123], v[216:219]
v_mul_f32 v236, s47, v236
v_mul_f32 v237, s47, v237
v_mfma_f32_16x16x32_bf16 v[216:219], a[164:167], v[124:127], v[216:219]
v_mul_f32 v238, s47, v238
v_mul_f32 v239, s47, v239
v_mfma_f32_16x16x32_bf16 v[220:223], a[172:175], v[124:127], v[220:223]
v_cvt_pk_bf16_f32 v92, v232, v233
v_cvt_pk_bf16_f32 v94, v236, v237
v_mfma_f32_16x16x32_bf16 v[220:223], a[168:171], v[120:123], v[220:223]
s_or_b32 s49, s49, 0xffff87ff
v_cvt_pk_bf16_f32 v93, v234, v235
v_cvt_pk_bf16_f32 v95, v238, v239
v_mfma_f32_16x16x32_bf16 v[248:251], a[176:179], v[120:123], v[248:251]
s_add_u32 s49, s49, 1
v_mfma_f32_16x16x32_bf16 v[248:251], a[180:183], v[124:127], v[248:251]
s_and_b32 s49, s49, 0x7800
s_waitcnt vmcnt(8)
v_mfma_f32_16x16x32_bf16 v[252:255], a[188:191], v[124:127], v[252:255]
s_add_u32 m0, s27, 32768
s_barrier
v_mfma_f32_16x16x32_bf16 v[252:255], a[184:187], v[120:123], v[252:255]
s_nop 0
s_waitcnt lgkmcnt(2)
buffer_load_dwordx4 v13, s[12:15], s49 offen offset:0 nt lds
v_mfma_f32_16x16x32_bf16 v[144:147], a[192:195], v[48:51], v[144:147]
ds_read_b128 a[128:131], v1 offset:0
ds_read_b128 a[132:135], v2 offset:0
v_mfma_f32_16x16x32_bf16 v[144:147], a[196:199], v[52:55], v[144:147]
v_mfma_f32_16x16x32_bf16 v[148:151], a[204:207], v[52:55], v[148:151]
v_mfma_f32_16x16x32_bf16 v[148:151], a[200:203], v[48:51], v[148:151]
ds_read_b128 a[136:139], v3 offset:0
ds_read_b128 a[140:143], v4 offset:0
v_mfma_f32_16x16x32_bf16 v[176:179], a[208:211], v[48:51], v[176:179]
v_mfma_f32_16x16x32_bf16 v[176:179], a[212:215], v[52:55], v[176:179]
v_mfma_f32_16x16x32_bf16 v[180:183], a[220:223], v[52:55], v[180:183]
ds_read_b128 a[144:147], v1 offset:4096
ds_read_b128 a[148:151], v2 offset:4096
v_mfma_f32_16x16x32_bf16 v[180:183], a[216:219], v[48:51], v[180:183]
v_mul_f32 v144, s47, v144
v_mul_f32 v145, s47, v145
v_mfma_f32_16x16x32_bf16 v[208:211], a[224:227], v[48:51], v[208:211]
buffer_load_dwordx4 v16, s[12:15], s49 offen offset:3072 nt lds
v_mfma_f32_16x16x32_bf16 v[208:211], a[228:231], v[52:55], v[208:211]
v_mul_f32 v146, s47, v146
v_mul_f32 v147, s47, v147
v_mfma_f32_16x16x32_bf16 v[212:215], a[236:239], v[52:55], v[212:215]
ds_read_b128 a[152:155], v3 offset:4096
ds_read_b128 a[156:159], v4 offset:4096
v_mfma_f32_16x16x32_bf16 v[212:215], a[232:235], v[48:51], v[212:215]
v_mul_f32 v148, s47, v148
v_mul_f32 v149, s47, v149
v_mfma_f32_16x16x32_bf16 v[240:243], a[240:243], v[48:51], v[240:243]
v_mul_f32 v150, s47, v150
v_mul_f32 v151, s47, v151
v_mfma_f32_16x16x32_bf16 v[240:243], a[244:247], v[52:55], v[240:243]
ds_read_b128 a[160:163], v1 offset:8192
ds_read_b128 a[164:167], v2 offset:8192
v_mfma_f32_16x16x32_bf16 v[244:247], a[252:255], v[52:55], v[244:247]
v_cvt_pk_bf16_f32 v96, v144, v145
v_cvt_pk_bf16_f32 v98, v148, v149
v_mfma_f32_16x16x32_bf16 v[244:247], a[248:251], v[48:51], v[244:247]
s_waitcnt lgkmcnt(10)
v_cvt_pk_bf16_f32 v97, v146, v147
v_cvt_pk_bf16_f32 v99, v150, v151
v_mfma_f32_16x16x32_bf16 v[152:155], a[192:195], v[56:59], v[152:155]
ds_read_b128 a[168:171], v3 offset:8192
ds_read_b128 a[172:175], v4 offset:8192
v_mfma_f32_16x16x32_bf16 v[152:155], a[196:199], v[60:63], v[152:155]
buffer_load_dwordx4 v14, s[12:15], s49 offen offset:1024 nt lds
v_mfma_f32_16x16x32_bf16 v[156:159], a[204:207], v[60:63], v[156:159]
v_mul_f32 v176, s47, v176
v_mul_f32 v177, s47, v177
v_mfma_f32_16x16x32_bf16 v[156:159], a[200:203], v[56:59], v[156:159]
v_mul_f32 v178, s47, v178
v_mul_f32 v179, s47, v179
v_mfma_f32_16x16x32_bf16 v[184:187], a[208:211], v[56:59], v[184:187]
ds_read_b128 a[176:179], v1 offset:12288
ds_read_b128 a[180:183], v2 offset:12288
v_mfma_f32_16x16x32_bf16 v[184:187], a[212:215], v[60:63], v[184:187]
v_mul_f32 v180, s47, v180
v_mul_f32 v181, s47, v181
v_mfma_f32_16x16x32_bf16 v[188:191], a[220:223], v[60:63], v[188:191]
v_mul_f32 v182, s47, v182
v_mul_f32 v183, s47, v183
v_mfma_f32_16x16x32_bf16 v[188:191], a[216:219], v[56:59], v[188:191]
ds_read_b128 a[184:187], v3 offset:12288
ds_read_b128 a[188:191], v4 offset:12288
v_mfma_f32_16x16x32_bf16 v[216:219], a[224:227], v[56:59], v[216:219]
v_cvt_pk_bf16_f32 v100, v176, v177
v_cvt_pk_bf16_f32 v102, v180, v181
v_mfma_f32_16x16x32_bf16 v[216:219], a[228:231], v[60:63], v[216:219]
v_cvt_pk_bf16_f32 v101, v178, v179
v_cvt_pk_bf16_f32 v103, v182, v183
v_mfma_f32_16x16x32_bf16 v[220:223], a[236:239], v[60:63], v[220:223]
buffer_load_dwordx4 v15, s[12:15], s49 offen offset:2048 nt lds
v_mfma_f32_16x16x32_bf16 v[220:223], a[232:235], v[56:59], v[220:223]
v_mul_f32 v208, s47, v208
v_mul_f32 v209, s47, v209
v_mfma_f32_16x16x32_bf16 v[248:251], a[240:243], v[56:59], v[248:251]
v_mul_f32 v210, s47, v210
v_mul_f32 v211, s47, v211
v_mfma_f32_16x16x32_bf16 v[248:251], a[244:247], v[60:63], v[248:251]
v_mul_f32 v212, s47, v212
v_mul_f32 v213, s47, v213
v_mfma_f32_16x16x32_bf16 v[252:255], a[252:255], v[60:63], v[252:255]
v_mul_f32 v214, s47, v214
v_mul_f32 v215, s47, v215
v_mfma_f32_16x16x32_bf16 v[252:255], a[248:251], v[56:59], v[252:255]
s_or_b32 s44, s44, 0xffff87ff
v_cvt_pk_bf16_f32 v104, v208, v209
v_cvt_pk_bf16_f32 v106, v212, v213
s_nop 1
s_waitcnt lgkmcnt(0)
v_mfma_f32_16x16x32_bf16 v[128:131], a[128:131], v[64:67], 0
s_add_u32 s44, s44, 1
v_cvt_pk_bf16_f32 v105, v210, v211
v_cvt_pk_bf16_f32 v107, v214, v215
v_mfma_f32_16x16x32_bf16 v[128:131], a[132:135], v[68:71], v[128:131]
s_and_b32 s44, s44, 0x7800
ds_read_b64_tr_b16 a[192:193], v19 offset:0
ds_read_b64_tr_b16 a[194:195], v19 offset:8192
v_mfma_f32_16x16x32_bf16 v[128:131], a[136:139], v[72:75], v[128:131]
s_add_u32 m0, s27, 81920
v_mul_f32 v240, s47, v240
v_mul_f32 v241, s47, v241
v_mfma_f32_16x16x32_bf16 v[128:131], a[140:143], v[76:79], v[128:131]
s_nop 0
buffer_load_dwordx4 v17, s[16:19], s44 offen offset:0 nt lds
v_mfma_f32_16x16x32_bf16 v[132:135], a[156:159], v[76:79], 0
ds_read_b64_tr_b16 a[196:197], v19 offset:8
ds_read_b64_tr_b16 a[198:199], v19 offset:8200
v_mfma_f32_16x16x32_bf16 v[132:135], a[152:155], v[72:75], v[132:135]
v_mul_f32 v242, s47, v242
v_mul_f32 v243, s47, v243
v_mfma_f32_16x16x32_bf16 v[132:135], a[148:151], v[68:71], v[132:135]
v_mul_f32 v244, s47, v244
v_mul_f32 v245, s47, v245
v_mfma_f32_16x16x32_bf16 v[132:135], a[144:147], v[64:67], v[132:135]
ds_read_b64_tr_b16 a[200:201], v19 offset:64
ds_read_b64_tr_b16 a[202:203], v19 offset:8256
v_mfma_f32_16x16x32_bf16 v[160:163], a[160:163], v[64:67], 0
v_mul_f32 v246, s47, v246
v_mul_f32 v247, s47, v247
v_mfma_f32_16x16x32_bf16 v[160:163], a[164:167], v[68:71], v[160:163]
ds_read_b64_tr_b16 a[204:205], v19 offset:72
ds_read_b64_tr_b16 a[206:207], v19 offset:8264
v_mfma_f32_16x16x32_bf16 v[160:163], a[168:171], v[72:75], v[160:163]
v_cvt_pk_bf16_f32 v108, v240, v241
v_cvt_pk_bf16_f32 v110, v244, v245
v_mfma_f32_16x16x32_bf16 v[160:163], a[172:175], v[76:79], v[160:163]
v_cvt_pk_bf16_f32 v109, v242, v243
v_cvt_pk_bf16_f32 v111, v246, v247
v_mfma_f32_16x16x32_bf16 v[164:167], a[188:191], v[76:79], 0
s_add_u32 s92, s44, 129024
buffer_load_dwordx4 v18, s[16:19], s92 offen offset:3072 nt lds
v_mfma_f32_16x16x32_bf16 v[164:167], a[184:187], v[72:75], v[164:167]
v_mul_f32 v152, s47, v152
v_mul_f32 v153, s47, v153
v_mfma_f32_16x16x32_bf16 v[164:167], a[180:183], v[68:71], v[164:167]
v_mul_f32 v154, s47, v154
v_mul_f32 v155, s47, v155
v_mfma_f32_16x16x32_bf16 v[164:167], a[176:179], v[64:67], v[164:167]
v_mul_f32 v156, s47, v156
v_mul_f32 v157, s47, v157
s_nop 1
v_mfma_f32_16x16x32_bf16 v[136:139], a[128:131], v[80:83], 0
v_mul_f32 v158, s47, v158
v_mul_f32 v159, s47, v159
v_mfma_f32_16x16x32_bf16 v[136:139], a[132:135], v[84:87], v[136:139]
v_cvt_pk_bf16_f32 v112, v152, v153
v_cvt_pk_bf16_f32 v114, v156, v157
v_mfma_f32_16x16x32_bf16 v[136:139], a[136:139], v[88:91], v[136:139]
v_cvt_pk_bf16_f32 v113, v154, v155
v_cvt_pk_bf16_f32 v115, v158, v159
v_mfma_f32_16x16x32_bf16 v[136:139], a[140:143], v[92:95], v[136:139]
v_mul_f32 v184, s47, v184
v_mul_f32 v185, s47, v185
v_mfma_f32_16x16x32_bf16 v[140:143], a[156:159], v[92:95], 0
v_mul_f32 v186, s47, v186
v_mul_f32 v187, s47, v187
v_mfma_f32_16x16x32_bf16 v[140:143], a[152:155], v[88:91], v[140:143]
buffer_load_dwordx4 v18, s[16:19], s44 offen offset:1024 nt lds
v_mfma_f32_16x16x32_bf16 v[140:143], a[148:151], v[84:87], v[140:143]
v_mul_f32 v188, s47, v188
v_mul_f32 v189, s47, v189
v_mfma_f32_16x16x32_bf16 v[140:143], a[144:147], v[80:83], v[140:143]
v_mul_f32 v190, s47, v190
v_mul_f32 v191, s47, v191
v_mfma_f32_16x16x32_bf16 v[168:171], a[160:163], v[80:83], 0
v_cvt_pk_bf16_f32 v116, v184, v185
v_cvt_pk_bf16_f32 v118, v188, v189
v_mfma_f32_16x16x32_bf16 v[168:171], a[164:167], v[84:87], v[168:171]
v_cvt_pk_bf16_f32 v117, v186, v187
v_cvt_pk_bf16_f32 v119, v190, v191
v_mfma_f32_16x16x32_bf16 v[168:171], a[168:171], v[88:91], v[168:171]
v_mul_f32 v216, s47, v216
v_mul_f32 v217, s47, v217
v_mfma_f32_16x16x32_bf16 v[168:171], a[172:175], v[92:95], v[168:171]
v_mul_f32 v218, s47, v218
v_mul_f32 v219, s47, v219
v_mfma_f32_16x16x32_bf16 v[172:175], a[188:191], v[92:95], 0
v_mul_f32 v220, s47, v220
v_mul_f32 v221, s47, v221
v_mfma_f32_16x16x32_bf16 v[172:175], a[184:187], v[88:91], v[172:175]
v_mul_f32 v222, s47, v222
v_mul_f32 v223, s47, v223
v_mfma_f32_16x16x32_bf16 v[172:175], a[180:183], v[84:87], v[172:175]
buffer_load_dwordx4 v17, s[16:19], s92 offen offset:2048 nt lds
v_mfma_f32_16x16x32_bf16 v[172:175], a[176:179], v[80:83], v[172:175]
v_cvt_pk_bf16_f32 v120, v216, v217
v_cvt_pk_bf16_f32 v122, v220, v221
s_nop 1
v_mfma_f32_16x16x32_bf16 v[144:147], a[128:131], v[96:99], 0
v_cvt_pk_bf16_f32 v121, v218, v219
v_cvt_pk_bf16_f32 v123, v222, v223
v_mfma_f32_16x16x32_bf16 v[144:147], a[132:135], v[100:103], v[144:147]
v_mul_f32 v248, s47, v248
v_mul_f32 v249, s47, v249
v_mfma_f32_16x16x32_bf16 v[144:147], a[136:139], v[104:107], v[144:147]
v_mul_f32 v250, s47, v250
v_mul_f32 v251, s47, v251
v_mfma_f32_16x16x32_bf16 v[144:147], a[140:143], v[108:111], v[144:147]
v_mul_f32 v252, s47, v252
v_mul_f32 v253, s47, v253
v_mfma_f32_16x16x32_bf16 v[148:151], a[156:159], v[108:111], 0
v_mul_f32 v254, s47, v254
v_mul_f32 v255, s47, v255
v_mfma_f32_16x16x32_bf16 v[148:151], a[152:155], v[104:107], v[148:151]
v_cvt_pk_bf16_f32 v124, v248, v249
v_cvt_pk_bf16_f32 v126, v252, v253
v_mfma_f32_16x16x32_bf16 v[148:151], a[148:151], v[100:103], v[148:151]
v_cvt_pk_bf16_f32 v125, v250, v251
v_cvt_pk_bf16_f32 v127, v254, v255
v_mfma_f32_16x16x32_bf16 v[148:151], a[144:147], v[96:99], v[148:151]
v_mov_b32 v48, 0
v_mov_b32 v49, 0
v_mfma_f32_16x16x32_bf16 v[176:179], a[160:163], v[96:99], 0
v_mov_b32 v50, 0
v_mov_b32 v51, 0
v_mfma_f32_16x16x32_bf16 v[176:179], a[164:167], v[100:103], v[176:179]
v_mov_b32 v52, 0
v_mov_b32 v53, 0
v_mfma_f32_16x16x32_bf16 v[176:179], a[168:171], v[104:107], v[176:179]
v_mov_b32 v54, 0
v_mov_b32 v55, 0
v_mfma_f32_16x16x32_bf16 v[176:179], a[172:175], v[108:111], v[176:179]
v_mov_b32 v56, 0
v_mov_b32 v57, 0
v_mfma_f32_16x16x32_bf16 v[180:183], a[188:191], v[108:111], 0
v_mov_b32 v58, 0
v_mov_b32 v59, 0
v_mfma_f32_16x16x32_bf16 v[180:183], a[184:187], v[104:107], v[180:183]
v_mov_b32 v60, 0
v_mov_b32 v61, 0
v_mfma_f32_16x16x32_bf16 v[180:183], a[180:183], v[100:103], v[180:183]
v_mov_b32 v62, 0
v_mov_b32 v63, 0
v_mfma_f32_16x16x32_bf16 v[180:183], a[176:179], v[96:99], v[180:183]
v_max3_f32 v32, v128, v129, v130
v_max3_f32 v32, v131, v132, v32
s_nop 1
v_mfma_f32_16x16x32_bf16 v[152:155], a[128:131], v[112:115], 0
v_max3_f32 v32, v133, v134, v32
v_max3_f32 v32, v135, v160, v32
v_mfma_f32_16x16x32_bf16 v[152:155], a[132:135], v[116:119], v[152:155]
v_max3_f32 v32, v161, v162, v32
v_max3_f32 v32, v163, v164, v32
v_mfma_f32_16x16x32_bf16 v[152:155], a[136:139], v[120:123], v[152:155]
v_max3_f32 v32, v165, v166, v32
v_max_f32 v32, v167, v32
v_mfma_f32_16x16x32_bf16 v[152:155], a[140:143], v[124:127], v[152:155]
v_mov_b32 v33, v32
s_nop 1
v_mfma_f32_16x16x32_bf16 v[156:159], a[156:159], v[124:127], 0
v_permlane32_swap_b32 v32, v33
v_mfma_f32_16x16x32_bf16 v[156:159], a[152:155], v[120:123], v[156:159]
v_max_f32 v32, v32, v33
v_mov_b32 v33, v32
s_nop 1
v_mfma_f32_16x16x32_bf16 v[156:159], a[148:151], v[116:119], v[156:159]
v_permlane16_swap_b32 v32, v33
v_mfma_f32_16x16x32_bf16 v[156:159], a[144:147], v[112:115], v[156:159]
v_max_f32 v32, v32, v33
v_sub_f32 v35, 0, v32
s_waitcnt vmcnt(8) lgkmcnt(0)
v_mfma_f32_16x16x32_bf16 v[184:187], a[160:163], v[112:115], 0
s_barrier
v_sub_f32 v34, 0, v32
v_sub_f32 v33, 0, v32
v_mfma_f32_16x16x32_bf16 v[184:187], a[164:167], v[116:119], v[184:187]
s_mov_b32 s44, s49
v_sub_f32 v32, 0, v32
v_add_f32 v128, v128, v32
v_mfma_f32_16x16x32_bf16 v[184:187], a[168:171], v[120:123], v[184:187]
s_or_b32 s49, s49, 0xffff87ff
v_add_f32 v129, v129, v33
v_add_f32 v130, v130, v32
v_mfma_f32_16x16x32_bf16 v[184:187], a[172:175], v[124:127], v[184:187]
s_add_u32 s49, s49, 1
v_add_f32 v131, v131, v33
v_add_f32 v132, v132, v32
v_mfma_f32_16x16x32_bf16 v[188:191], a[188:191], v[124:127], 0
s_and_b32 s49, s49, 0x7800
v_add_f32 v133, v133, v33
v_add_f32 v134, v134, v32
v_mfma_f32_16x16x32_bf16 v[188:191], a[184:187], v[120:123], v[188:191]
s_mov_b32 s45, 0
v_add_f32 v135, v135, v33
v_add_f32 v160, v160, v32
v_mfma_f32_16x16x32_bf16 v[188:191], a[180:183], v[116:119], v[188:191]
v_add_f32 v161, v161, v33
v_add_f32 v162, v162, v32
v_mfma_f32_16x16x32_bf16 v[188:191], a[176:179], v[112:115], v[188:191]
v_add_f32 v163, v163, v33
v_add_f32 v164, v164, v32
ds_read_b128 a[128:131], v1 offset:16384
ds_read_b128 a[132:135], v2 offset:16384
ds_read_b128 a[136:139], v3 offset:16384
ds_read_b128 a[140:143], v4 offset:16384
ds_read_b128 a[144:147], v1 offset:20480
ds_read_b128 a[148:151], v2 offset:20480
ds_read_b128 a[152:155], v3 offset:20480
ds_read_b128 a[156:159], v4 offset:20480
ds_read_b128 a[160:163], v1 offset:24576
ds_read_b128 a[164:167], v2 offset:24576
ds_read_b128 a[168:171], v3 offset:24576
ds_read_b128 a[172:175], v4 offset:24576
ds_read_b128 a[176:179], v1 offset:28672
ds_read_b128 a[180:183], v2 offset:28672
v_mov_b32 v24, 0
v_mov_b32 v25, 0
v_mov_b32 v26, 0
v_mov_b32 v27, 0
buffer_store_dwordx4 v[24:27], v21, s[72:75], 0 offen sc1
v_add_f32 v165, v165, v33
v_pk_add_f32 v[166:167], v[166:167], v[32:33]
v_max3_f32 v36, v136, v137, v138
v_max3_f32 v36, v139, v140, v36
v_max3_f32 v36, v141, v142, v36
v_max3_f32 v36, v143, v168, v36
v_max3_f32 v36, v169, v170, v36
v_max3_f32 v36, v171, v172, v36
v_max3_f32 v36, v173, v174, v36
v_max_f32 v36, v175, v36
v_mov_b32 v37, v36
s_nop 1
v_permlane32_swap_b32 v36, v37
v_max_f32 v36, v36, v37
v_mov_b32 v37, v36
s_nop 1
v_permlane16_swap_b32 v36, v37
v_max_f32 v36, v36, v37
v_sub_f32 v39, 0, v36
v_sub_f32 v38, 0, v36
v_sub_f32 v37, 0, v36
v_sub_f32 v36, 0, v36
v_pk_add_f32 v[136:137], v[136:137], v[36:37]
v_pk_add_f32 v[138:139], v[138:139], v[36:37]
v_pk_add_f32 v[140:141], v[140:141], v[36:37]
v_pk_add_f32 v[142:143], v[142:143], v[36:37]
v_pk_add_f32 v[168:169], v[168:169], v[36:37]
v_pk_add_f32 v[170:171], v[170:171], v[36:37]
s_mov_b32 s52, 0
buffer_store_dwordx4 a[192:195], v20, s[80:83], s52 offen offset:0 sc1
v_pk_add_f32 v[172:173], v[172:173], v[36:37]
v_pk_add_f32 v[174:175], v[174:175], v[36:37]
v_max3_f32 v40, v144, v145, v146
v_max3_f32 v40, v147, v148, v40
v_max3_f32 v40, v149, v150, v40
v_max3_f32 v40, v151, v176, v40
v_max3_f32 v40, v177, v178, v40
v_max3_f32 v40, v179, v180, v40
v_max3_f32 v40, v181, v182, v40
v_max_f32 v40, v183, v40
v_mov_b32 v41, v40
s_nop 1
v_permlane32_swap_b32 v40, v41
v_max_f32 v40, v40, v41
v_mov_b32 v41, v40
s_nop 1
v_permlane16_swap_b32 v40, v41
v_max_f32 v40, v40, v41
v_sub_f32 v43, 0, v40
v_sub_f32 v42, 0, v40
v_sub_f32 v41, 0, v40
v_sub_f32 v40, 0, v40
v_pk_add_f32 v[144:145], v[144:145], v[40:41]
v_pk_add_f32 v[146:147], v[146:147], v[40:41]
v_pk_add_f32 v[148:149], v[148:149], v[40:41]
v_pk_add_f32 v[150:151], v[150:151], v[40:41]
s_mov_b32 s52, 0
buffer_store_dwordx4 a[196:199], v20, s[80:83], s52 offen offset:1024 sc1
v_pk_add_f32 v[176:177], v[176:177], v[40:41]
v_pk_add_f32 v[178:179], v[178:179], v[40:41]
v_pk_add_f32 v[180:181], v[180:181], v[40:41]
v_pk_add_f32 v[182:183], v[182:183], v[40:41]
v_max3_f32 v44, v152, v153, v154
v_max3_f32 v44, v155, v156, v44
v_max3_f32 v44, v157, v158, v44
v_max3_f32 v44, v159, v184, v44
v_max3_f32 v44, v185, v186, v44
v_max3_f32 v44, v187, v188, v44
v_max3_f32 v44, v189, v190, v44
v_max_f32 v44, v191, v44
v_mov_b32 v45, v44
s_nop 1
v_permlane32_swap_b32 v44, v45
v_max_f32 v44, v44, v45
v_mov_b32 v45, v44
s_nop 1
v_permlane16_swap_b32 v44, v45
v_max_f32 v44, v44, v45
v_sub_f32 v47, 0, v44
v_sub_f32 v46, 0, v44
v_sub_f32 v45, 0, v44
v_sub_f32 v44, 0, v44
v_pk_add_f32 v[152:153], v[152:153], v[44:45]
v_pk_add_f32 v[154:155], v[154:155], v[44:45]
v_pk_add_f32 v[156:157], v[156:157], v[44:45]
v_pk_add_f32 v[158:159], v[158:159], v[44:45]
s_mov_b32 s52, 262144
buffer_store_dwordx4 a[200:203], v20, s[80:83], s52 offen offset:0 sc1
v_pk_add_f32 v[184:185], v[184:185], v[44:45]
v_pk_add_f32 v[186:187], v[186:187], v[44:45]
v_pk_add_f32 v[188:189], v[188:189], v[44:45]
v_pk_add_f32 v[190:191], v[190:191], v[44:45]
v_exp_f32 v128, v128
v_exp_f32 v129, v129
v_exp_f32 v130, v130
v_exp_f32 v131, v131
v_exp_f32 v132, v132
v_exp_f32 v133, v133
v_exp_f32 v134, v134
v_exp_f32 v135, v135
v_exp_f32 v160, v160
v_exp_f32 v161, v161
v_exp_f32 v162, v162
v_exp_f32 v163, v163
v_exp_f32 v164, v164
v_exp_f32 v165, v165
v_exp_f32 v166, v166
v_exp_f32 v167, v167
v_exp_f32 v168, v168
v_exp_f32 v169, v169
v_exp_f32 v170, v170
v_exp_f32 v171, v171
v_exp_f32 v172, v172
v_exp_f32 v173, v173
v_exp_f32 v174, v174
v_exp_f32 v175, v175
s_mov_b32 s52, 262144
buffer_store_dwordx4 a[204:207], v20, s[80:83], s52 offen offset:1024 sc1
v_exp_f32 v136, v136
v_exp_f32 v137, v137
v_exp_f32 v138, v138
v_exp_f32 v139, v139
v_exp_f32 v140, v140
v_exp_f32 v141, v141
v_exp_f32 v142, v142
v_exp_f32 v143, v143
v_exp_f32 v144, v144
v_exp_f32 v145, v145
v_exp_f32 v146, v146
v_exp_f32 v147, v147
v_exp_f32 v148, v148
v_exp_f32 v149, v149
v_exp_f32 v150, v150
v_exp_f32 v151, v151
v_cvt_pk_bf16_f32 v128, v128, v129
v_cvt_pk_bf16_f32 v129, v130, v131
v_cvt_pk_bf16_f32 v130, v132, v133
v_cvt_pk_bf16_f32 v131, v134, v135
v_cvt_pk_bf16_f32 v160, v160, v161
v_cvt_pk_bf16_f32 v161, v162, v163
v_cvt_pk_bf16_f32 v162, v164, v165
v_cvt_pk_bf16_f32 v163, v166, v167
v_cvt_pk_bf16_f32 v168, v168, v169
v_cvt_pk_bf16_f32 v169, v170, v171
v_cvt_pk_bf16_f32 v170, v172, v173
v_cvt_pk_bf16_f32 v171, v174, v175
v_cvt_pk_bf16_f32 v136, v136, v137
v_cvt_pk_bf16_f32 v137, v138, v139
s_waitcnt lgkmcnt(10)
L_loop:
v_mfma_f32_16x16x32_bf16 v[192:195], a[128:131], v[64:67], v[32:35]
v_exp_f32 v176, v176
v_mfma_f32_16x16x32_bf16 v[192:195], a[132:135], v[68:71], v[192:195]
ds_read_b128 a[184:187], v3 offset:28672
ds_read_b128 a[188:191], v4 offset:28672
v_mfma_f32_16x16x32_bf16 v[192:195], a[136:139], v[72:75], v[192:195]
v_exp_f32 v177, v177
v_mfma_f32_16x16x32_bf16 v[192:195], a[140:143], v[76:79], v[192:195]
s_add_u32 m0, s27, 49152
v_cvt_pk_bf16_f32 v138, v140, v141
v_cvt_pk_bf16_f32 v139, v142, v143
v_mfma_f32_16x16x32_bf16 v[200:203], a[140:143], v[92:95], v[36:39]
buffer_load_dwordx4 v13, s[12:15], s49 offen offset:0 nt lds
v_mfma_f32_16x16x32_bf16 v[200:203], a[136:139], v[88:91], v[200:203]
v_cvt_pk_bf16_f32 v144, v144, v145
v_cvt_pk_bf16_f32 v145, v146, v147
v_mfma_f32_16x16x32_bf16 v[200:203], a[132:135], v[84:87], v[200:203]
v_exp_f32 v178, v178
v_mfma_f32_16x16x32_bf16 v[200:203], a[128:131], v[80:83], v[200:203]
v_max3_f32 v19, v192, v193, v194
v_max_f32 v19, v195, v19
v_mfma_f32_16x16x32_bf16 v[208:211], a[128:131], v[96:99], v[40:43]
v_exp_f32 v179, v179
v_mfma_f32_16x16x32_bf16 v[208:211], a[132:135], v[100:103], v[208:211]
v_cvt_pk_bf16_f32 v146, v148, v149
v_cvt_pk_bf16_f32 v147, v150, v151
v_mfma_f32_16x16x32_bf16 v[208:211], a[136:139], v[104:107], v[208:211]
v_max3_f32 v20, v200, v201, v202
v_max_f32 v20, v203, v20
v_mfma_f32_16x16x32_bf16 v[208:211], a[140:143], v[108:111], v[208:211]
v_exp_f32 v180, v180
v_mfma_f32_16x16x32_bf16 v[216:219], a[140:143], v[124:127], v[44:47]
v_cvt_pk_bf16_f32 v176, v176, v177
v_cvt_pk_bf16_f32 v177, v178, v179
v_mfma_f32_16x16x32_bf16 v[216:219], a[136:139], v[120:123], v[216:219]
v_exp_f32 v181, v181
v_mfma_f32_16x16x32_bf16 v[216:219], a[132:135], v[116:119], v[216:219]
v_max3_f32 v19, v208, v209, v19
v_max3_f32 v19, v210, v211, v19
v_mfma_f32_16x16x32_bf16 v[216:219], a[128:131], v[112:115], v[216:219]
s_waitcnt lgkmcnt(8)
ds_read_b64_tr_b16 a[128:129], v5 offset:0
ds_read_b64_tr_b16 a[130:131], v5 offset:4096
v_mfma_f32_16x16x32_bf16 v[196:199], a[144:147], v[64:67], v[32:35]
v_exp_f32 v182, v182
v_mfma_f32_16x16x32_bf16 v[196:199], a[148:151], v[68:71], v[196:199]
ds_read_b64_tr_b16 a[132:133], v5 offset:8192
ds_read_b64_tr_b16 a[134:135], v5 offset:12288
v_mfma_f32_16x16x32_bf16 v[196:199], a[152:155], v[72:75], v[196:199]
buffer_load_dwordx4 v16, s[12:15], s49 offen offset:3072 nt lds
v_mfma_f32_16x16x32_bf16 v[196:199], a[156:159], v[76:79], v[196:199]
v_exp_f32 v183, v183
v_mfma_f32_16x16x32_bf16 v[204:207], a[156:159], v[92:95], v[36:39]
v_max3_f32 v20, v216, v217, v20
v_max3_f32 v20, v218, v219, v20
v_mfma_f32_16x16x32_bf16 v[204:207], a[152:155], v[88:91], v[204:207]
ds_read_b64_tr_b16 a[136:137], v6 offset:0
ds_read_b64_tr_b16 a[138:139], v6 offset:4096
v_mfma_f32_16x16x32_bf16 v[204:207], a[148:151], v[84:87], v[204:207]
v_exp_f32 v184, v184
v_mfma_f32_16x16x32_bf16 v[204:207], a[144:147], v[80:83], v[204:207]
v_max3_f32 v19, v196, v197, v19
v_max3_f32 v19, v198, v199, v19
v_mfma_f32_16x16x32_bf16 v[212:215], a[144:147], v[96:99], v[40:43]
v_exp_f32 v185, v185
v_mfma_f32_16x16x32_bf16 v[212:215], a[148:151], v[100:103], v[212:215]
ds_read_b64_tr_b16 a[140:141], v6 offset:8192
ds_read_b64_tr_b16 a[142:143], v6 offset:12288
v_mfma_f32_16x16x32_bf16 v[212:215], a[152:155], v[104:107], v[212:215]
v_max3_f32 v20, v204, v205, v20
v_max3_f32 v20, v206, v207, v20
v_mfma_f32_16x16x32_bf16 v[212:215], a[156:159], v[108:111], v[212:215]
v_exp_f32 v186, v186
v_mfma_f32_16x16x32_bf16 v[220:223], a[156:159], v[124:127], v[44:47]
v_cvt_pk_bf16_f32 v178, v180, v181
v_cvt_pk_bf16_f32 v179, v182, v183
v_mfma_f32_16x16x32_bf16 v[220:223], a[152:155], v[120:123], v[220:223]
v_exp_f32 v187, v187
v_mfma_f32_16x16x32_bf16 v[220:223], a[148:151], v[116:119], v[220:223]
v_max3_f32 v19, v212, v213, v19
v_max3_f32 v19, v214, v215, v19
v_mfma_f32_16x16x32_bf16 v[220:223], a[144:147], v[112:115], v[220:223]
s_waitcnt lgkmcnt(12)
ds_read_b64_tr_b16 a[144:145], v7 offset:0
ds_read_b64_tr_b16 a[146:147], v7 offset:4096
v_mfma_f32_16x16x32_bf16 v[224:227], a[160:163], v[64:67], v[32:35]
buffer_load_dwordx4 v14, s[12:15], s49 offen offset:1024 nt lds
v_mfma_f32_16x16x32_bf16 v[224:227], a[164:167], v[68:71], v[224:227]
v_exp_f32 v188, v188
v_mfma_f32_16x16x32_bf16 v[224:227], a[168:171], v[72:75], v[224:227]
v_max3_f32 v20, v220, v221, v20
v_max3_f32 v20, v222, v223, v20
v_mfma_f32_16x16x32_bf16 v[224:227], a[172:175], v[76:79], v[224:227]
v_exp_f32 v189, v189
v_mfma_f32_16x16x32_bf16 v[232:235], a[172:175], v[92:95], v[36:39]
ds_read_b64_tr_b16 a[148:149], v7 offset:8192
ds_read_b64_tr_b16 a[150:151], v7 offset:12288
v_mfma_f32_16x16x32_bf16 v[232:235], a[168:171], v[88:91], v[232:235]
ds_read_b64_tr_b16 a[152:153], v8 offset:0
ds_read_b64_tr_b16 a[154:155], v8 offset:4096
v_mfma_f32_16x16x32_bf16 v[232:235], a[164:167], v[84:87], v[232:235]
v_exp_f32 v190, v190
v_mfma_f32_16x16x32_bf16 v[232:235], a[160:163], v[80:83], v[232:235]
v_max3_f32 v19, v224, v225, v19
v_max3_f32 v19, v226, v227, v19
v_mfma_f32_16x16x32_bf16 v[240:243], a[160:163], v[96:99], v[40:43]
v_exp_f32 v191, v191
v_mfma_f32_16x16x32_bf16 v[240:243], a[164:167], v[100:103], v[240:243]
ds_read_b64_tr_b16 a[156:157], v8 offset:8192
v_cvt_pk_bf16_f32 v184, v184, v185
v_mfma_f32_16x16x32_bf16 v[240:243], a[168:171], v[104:107], v[240:243]
v_max3_f32 v20, v232, v233, v20
v_max3_f32 v20, v234, v235, v20
v_mfma_f32_16x16x32_bf16 v[240:243], a[172:175], v[108:111], v[240:243]
v_exp_f32 v152, v152
v_mfma_f32_16x16x32_bf16 v[248:251], a[172:175], v[124:127], v[44:47]
ds_read_b64_tr_b16 a[158:159], v8 offset:12288
v_cvt_pk_bf16_f32 v185, v186, v187
v_mfma_f32_16x16x32_bf16 v[248:251], a[168:171], v[120:123], v[248:251]
v_exp_f32 v153, v153
v_mfma_f32_16x16x32_bf16 v[248:251], a[164:167], v[116:119], v[248:251]
buffer_load_dwordx4 v15, s[12:15], s49 offen offset:2048 nt lds
v_mfma_f32_16x16x32_bf16 v[248:251], a[160:163], v[112:115], v[248:251]
s_waitcnt lgkmcnt(15)
v_max3_f32 v19, v240, v241, v19
v_max3_f32 v19, v242, v243, v19
v_mfma_f32_16x16x32_bf16 v[228:231], a[176:179], v[64:67], v[32:35]
ds_read_b64_tr_b16 a[160:161], v9 offset:0
v_cvt_pk_bf16_f32 v186, v188, v189
v_mfma_f32_16x16x32_bf16 v[228:231], a[180:183], v[68:71], v[228:231]
v_exp_f32 v154, v154
v_mfma_f32_16x16x32_bf16 v[228:231], a[184:187], v[72:75], v[228:231]
v_max3_f32 v20, v248, v249, v20
v_max3_f32 v20, v250, v251, v20
v_mfma_f32_16x16x32_bf16 v[228:231], a[188:191], v[76:79], v[228:231]
v_exp_f32 v155, v155
v_mfma_f32_16x16x32_bf16 v[236:239], a[188:191], v[92:95], v[36:39]
ds_read_b64_tr_b16 a[162:163], v9 offset:4096
v_cvt_pk_bf16_f32 v187, v190, v191
v_mfma_f32_16x16x32_bf16 v[236:239], a[184:187], v[88:91], v[236:239]
ds_read_b64_tr_b16 a[164:165], v9 offset:8192
v_cvt_pk_bf16_f32 v152, v152, v153
v_mfma_f32_16x16x32_bf16 v[236:239], a[180:183], v[84:87], v[236:239]
v_exp_f32 v156, v156
v_mfma_f32_16x16x32_bf16 v[236:239], a[176:179], v[80:83], v[236:239]
v_max3_f32 v19, v228, v229, v19
v_max3_f32 v19, v230, v231, v19
v_mfma_f32_16x16x32_bf16 v[244:247], a[176:179], v[96:99], v[40:43]
v_exp_f32 v157, v157
v_mfma_f32_16x16x32_bf16 v[244:247], a[180:183], v[100:103], v[244:247]
ds_read_b64_tr_b16 a[166:167], v9 offset:12288
v_cvt_pk_bf16_f32 v153, v154, v155
v_mfma_f32_16x16x32_bf16 v[244:247], a[184:187], v[104:107], v[244:247]
v_max3_f32 v20, v236, v237, v20
v_max3_f32 v20, v238, v239, v20
v_mfma_f32_16x16x32_bf16 v[244:247], a[188:191], v[108:111], v[244:247]
v_exp_f32 v158, v158
v_mfma_f32_16x16x32_bf16 v[252:255], a[188:191], v[124:127], v[44:47]
v_cvt_pk_bf16_f32 v154, v156, v157
v_mfma_f32_16x16x32_bf16 v[252:255], a[184:187], v[120:123], v[252:255]
v_exp_f32 v159, v159
v_mfma_f32_16x16x32_bf16 v[252:255], a[180:183], v[116:119], v[252:255]
v_max3_f32 v19, v244, v245, v19
v_max3_f32 v19, v246, v247, v19
v_mfma_f32_16x16x32_bf16 v[252:255], a[176:179], v[112:115], v[252:255]
s_waitcnt lgkmcnt(15)
v_cvt_pk_bf16_f32 v155, v158, v159
v_mfma_f32_16x16x32_bf16 a[0:3], a[128:131], v[128:131], a[0:3]
v_mfma_f32_16x16x32_bf16 a[0:3], a[132:135], v[160:163], a[0:3]
v_mfma_f32_16x16x32_bf16 a[32:35], a[132:135], v[168:171], a[32:35]
v_max3_f32 v20, v252, v253, v20
v_max3_f32 v20, v254, v255, v20
v_mfma_f32_16x16x32_bf16 a[32:35], a[128:131], v[136:139], a[32:35]
v_max_f32 v19, v19, v20
v_cmp_lt_f32 vcc, s46, v19
v_mfma_f32_16x16x32_bf16 a[64:67], a[128:131], v[144:147], a[64:67]
v_mfma_f32_16x16x32_bf16 a[64:67], a[132:135], v[176:179], a[64:67]
s_cbranch_vccnz L_r0a
L_r0a_back:
v_exp_f32 v192, v192
v_mfma_f32_16x16x32_bf16 a[96:99], a[132:135], v[184:187], a[96:99]
s_add_u32 m0, s27, 98304
v_exp_f32 v193, v193
v_mfma_f32_16x16x32_bf16 a[96:99], a[128:131], v[152:155], a[96:99]
s_waitcnt lgkmcnt(12)
ds_read_b64_tr_b16 a[168:169], v10 offset:0
ds_read_b64_tr_b16 a[170:171], v10 offset:4096
v_mfma_f32_16x16x32_bf16 a[4:7], a[136:139], v[128:131], a[4:7]
buffer_load_dwordx4 v17, s[16:19], s44 offen offset:0 nt lds
v_mfma_f32_16x16x32_bf16 a[4:7], a[140:143], v[160:163], a[4:7]
v_exp_f32 v194, v194
v_mfma_f32_16x16x32_bf16 a[36:39], a[140:143], v[168:171], a[36:39]
v_exp_f32 v195, v195
v_mfma_f32_16x16x32_bf16 a[36:39], a[136:139], v[136:139], a[36:39]
ds_read_b64_tr_b16 a[172:173], v10 offset:8192
ds_read_b64_tr_b16 a[174:175], v10 offset:12288
v_mfma_f32_16x16x32_bf16 a[68:71], a[136:139], v[144:147], a[68:71]
v_exp_f32 v196, v196
v_mfma_f32_16x16x32_bf16 a[68:71], a[140:143], v[176:179], a[68:71]
v_exp_f32 v197, v197
v_mfma_f32_16x16x32_bf16 a[100:103], a[140:143], v[184:187], a[100:103]
ds_read_b64_tr_b16 a[176:177], v11 offset:0
ds_read_b64_tr_b16 a[178:179], v11 offset:4096
v_mfma_f32_16x16x32_bf16 a[100:103], a[136:139], v[152:155], a[100:103]
s_waitcnt lgkmcnt(14)
v_exp_f32 v198, v198
v_mfma_f32_16x16x32_bf16 a[8:11], a[144:147], v[128:131], a[8:11]
v_exp_f32 v199, v199
v_mfma_f32_16x16x32_bf16 a[8:11], a[148:151], v[160:163], a[8:11]
ds_read_b64_tr_b16 a[180:181], v11 offset:8192
ds_read_b64_tr_b16 a[182:183], v11 offset:12288
v_mfma_f32_16x16x32_bf16 a[40:43], a[148:151], v[168:171], a[40:43]
v_exp_f32 v224, v224
v_mfma_f32_16x16x32_bf16 a[40:43], a[144:147], v[136:139], a[40:43]
v_exp_f32 v225, v225
v_mfma_f32_16x16x32_bf16 a[72:75], a[144:147], v[144:147], a[72:75]
ds_read_b64_tr_b16 a[184:185], v12 offset:0
ds_read_b64_tr_b16 a[186:187], v12 offset:4096
v_mfma_f32_16x16x32_bf16 a[72:75], a[148:151], v[176:179], a[72:75]
v_exp_f32 v226, v226
v_mfma_f32_16x16x32_bf16 a[104:107], a[148:151], v[184:187], a[104:107]
s_add_u32 s92, s44, 129024
buffer_load_dwordx4 v18, s[16:19], s92 offen offset:3072 nt lds
v_mfma_f32_16x16x32_bf16 a[104:107], a[144:147], v[152:155], a[104:107]
s_waitcnt lgkmcnt(14)
ds_read_b64_tr_b16 a[188:189], v12 offset:8192
ds_read_b64_tr_b16 a[190:191], v12 offset:12288
v_mfma_f32_16x16x32_bf16 a[12:15], a[152:155], v[128:131], a[12:15]
v_exp_f32 v227, v227
v_mfma_f32_16x16x32_bf16 a[12:15], a[156:159], v[160:163], a[12:15]
v_exp_f32 v228, v228
v_mfma_f32_16x16x32_bf16 a[44:47], a[156:159], v[168:171], a[44:47]
v_cvt_pk_bf16_f32 v192, v192, v193
v_cvt_pk_bf16_f32 v193, v194, v195
v_mfma_f32_16x16x32_bf16 a[44:47], a[152:155], v[136:139], a[44:47]
v_exp_f32 v229, v229
v_mfma_f32_16x16x32_bf16 a[76:79], a[152:155], v[144:147], a[76:79]
v_exp_f32 v230, v230
v_mfma_f32_16x16x32_bf16 a[76:79], a[156:159], v[176:179], a[76:79]
v_cvt_pk_bf16_f32 v194, v196, v197
v_cvt_pk_bf16_f32 v195, v198, v199
v_mfma_f32_16x16x32_bf16 a[108:111], a[156:159], v[184:187], a[108:111]
v_exp_f32 v231, v231
v_mfma_f32_16x16x32_bf16 a[108:111], a[152:155], v[152:155], a[108:111]
s_waitcnt lgkmcnt(12)
v_exp_f32 v232, v232
v_mfma_f32_16x16x32_bf16 a[16:19], a[160:163], v[128:131], a[16:19]
v_cvt_pk_bf16_f32 v224, v224, v225
v_cvt_pk_bf16_f32 v225, v226, v227
v_mfma_f32_16x16x32_bf16 a[16:19], a[164:167], v[160:163], a[16:19]
v_exp_f32 v233, v233
v_mfma_f32_16x16x32_bf16 a[48:51], a[164:167], v[168:171], a[48:51]
v_exp_f32 v234, v234
v_mfma_f32_16x16x32_bf16 a[48:51], a[160:163], v[136:139], a[48:51]
v_cvt_pk_bf16_f32 v226, v228, v229
v_cvt_pk_bf16_f32 v227, v230, v231
v_mfma_f32_16x16x32_bf16 a[80:83], a[160:163], v[144:147], a[80:83]
buffer_load_dwordx4 v18, s[16:19], s44 offen offset:1024 nt lds
v_mfma_f32_16x16x32_bf16 a[80:83], a[164:167], v[176:179], a[80:83]
v_exp_f32 v235, v235
v_mfma_f32_16x16x32_bf16 a[112:115], a[164:167], v[184:187], a[112:115]
v_cvt_pk_bf16_f32 v232, v232, v233
v_cvt_pk_bf16_f32 v233, v234, v235
v_mfma_f32_16x16x32_bf16 a[112:115], a[160:163], v[152:155], a[112:115]
s_waitcnt lgkmcnt(8)
v_exp_f32 v236, v236
v_mfma_f32_16x16x32_bf16 a[20:23], a[168:171], v[128:131], a[20:23]
v_exp_f32 v237, v237
v_mfma_f32_16x16x32_bf16 a[20:23], a[172:175], v[160:163], a[20:23]
v_cvt_pk_bf16_f32 v234, v236, v237
v_mfma_f32_16x16x32_bf16 a[52:55], a[172:175], v[168:171], a[52:55]
v_exp_f32 v238, v238
v_mfma_f32_16x16x32_bf16 a[52:55], a[168:171], v[136:139], a[52:55]
v_exp_f32 v239, v239
v_mfma_f32_16x16x32_bf16 a[84:87], a[168:171], v[144:147], a[84:87]
v_cvt_pk_bf16_f32 v235, v238, v239
v_mfma_f32_16x16x32_bf16 a[84:87], a[172:175], v[176:179], a[84:87]
v_exp_f32 v200, v200
v_mfma_f32_16x16x32_bf16 a[116:119], a[172:175], v[184:187], a[116:119]
v_exp_f32 v201, v201
v_mfma_f32_16x16x32_bf16 a[116:119], a[168:171], v[152:155], a[116:119]
s_waitcnt lgkmcnt(4)
v_cvt_pk_bf16_f32 v200, v200, v201
v_mfma_f32_16x16x32_bf16 a[24:27], a[176:179], v[128:131], a[24:27]
v_exp_f32 v202, v202
v_mfma_f32_16x16x32_bf16 a[24:27], a[180:183], v[160:163], a[24:27]
v_exp_f32 v203, v203
v_mfma_f32_16x16x32_bf16 a[56:59], a[180:183], v[168:171], a[56:59]
buffer_load_dwordx4 v17, s[16:19], s92 offen offset:2048 nt lds
v_mfma_f32_16x16x32_bf16 a[56:59], a[176:179], v[136:139], a[56:59]
v_cvt_pk_bf16_f32 v201, v202, v203
v_mfma_f32_16x16x32_bf16 a[88:91], a[176:179], v[144:147], a[88:91]
v_exp_f32 v204, v204
v_mfma_f32_16x16x32_bf16 a[88:91], a[180:183], v[176:179], a[88:91]
s_waitcnt vmcnt(8) lgkmcnt(0)
v_exp_f32 v205, v205
v_mfma_f32_16x16x32_bf16 a[120:123], a[180:183], v[184:187], a[120:123]
s_barrier
v_mfma_f32_16x16x32_bf16 a[120:123], a[176:179], v[152:155], a[120:123]
ds_read_b128 a[128:131], v1 offset:32768
ds_read_b128 a[132:135], v2 offset:32768
v_mfma_f32_16x16x32_bf16 a[28:31], a[184:187], v[128:131], a[28:31]
s_mov_b32 s44, s49
v_exp_f32 v206, v206
v_mfma_f32_16x16x32_bf16 a[28:31], a[188:191], v[160:163], a[28:31]
s_or_b32 s49, s49, 0xffff87ff
ds_read_b128 a[136:139], v3 offset:32768
ds_read_b128 a[140:143], v4 offset:32768
v_mfma_f32_16x16x32_bf16 a[60:63], a[188:191], v[168:171], a[60:63]
s_add_u32 s49, s49, 1
v_exp_f32 v207, v207
v_mfma_f32_16x16x32_bf16 a[60:63], a[184:187], v[136:139], a[60:63]
s_and_b32 s49, s49, 0x7800
v_exp_f32 v208, v208
v_mfma_f32_16x16x32_bf16 a[92:95], a[184:187], v[144:147], a[92:95]
ds_read_b128 a[144:147], v1 offset:36864
ds_read_b128 a[148:151], v2 offset:36864
v_mfma_f32_16x16x32_bf16 a[92:95], a[188:191], v[176:179], a[92:95]
v_exp_f32 v209, v209
v_mfma_f32_16x16x32_bf16 a[124:127], a[188:191], v[184:187], a[124:127]
v_exp_f32 v210, v210
v_mfma_f32_16x16x32_bf16 a[124:127], a[184:187], v[152:155], a[124:127]
ds_read_b128 a[152:155], v3 offset:36864
ds_read_b128 a[156:159], v4 offset:36864
v_mfma_f32_16x16x32_bf16 v[48:51], v[28:31], v[128:131], v[48:51]
v_exp_f32 v211, v211
v_mfma_f32_16x16x32_bf16 v[48:51], v[28:31], v[160:163], v[48:51]
v_exp_f32 v212, v212
v_mfma_f32_16x16x32_bf16 v[52:55], v[28:31], v[136:139], v[52:55]
ds_read_b128 a[160:163], v1 offset:40960
ds_read_b128 a[164:167], v2 offset:40960
v_mfma_f32_16x16x32_bf16 v[52:55], v[28:31], v[168:171], v[52:55]
v_exp_f32 v213, v213
v_mfma_f32_16x16x32_bf16 v[56:59], v[28:31], v[144:147], v[56:59]
v_exp_f32 v214, v214
v_mfma_f32_16x16x32_bf16 v[56:59], v[28:31], v[176:179], v[56:59]
ds_read_b128 a[168:171], v3 offset:40960
ds_read_b128 a[172:175], v4 offset:40960
v_mfma_f32_16x16x32_bf16 v[60:63], v[28:31], v[152:155], v[60:63]
s_waitcnt lgkmcnt(8)
v_exp_f32 v215, v215
v_mfma_f32_16x16x32_bf16 v[60:63], v[28:31], v[184:187], v[60:63]
s_cbranch_vccnz L_r0b
L_r0b_back:
ds_read_b128 a[176:179], v1 offset:45056
ds_read_b128 a[180:183], v2 offset:45056
v_mfma_f32_16x16x32_bf16 v[128:131], a[128:131], v[64:67], v[32:35]
v_exp_f32 v240, v240
v_mfma_f32_16x16x32_bf16 v[128:131], a[132:135], v[68:71], v[128:131]
ds_read_b128 a[184:187], v3 offset:45056
ds_read_b128 a[188:191], v4 offset:45056
v_mfma_f32_16x16x32_bf16 v[128:131], a[136:139], v[72:75], v[128:131]
v_exp_f32 v241, v241
v_mfma_f32_16x16x32_bf16 v[128:131], a[140:143], v[76:79], v[128:131]
s_add_u32 m0, s27, 0
v_cvt_pk_bf16_f32 v202, v204, v205
v_cvt_pk_bf16_f32 v203, v206, v207
v_mfma_f32_16x16x32_bf16 v[136:139], a[140:143], v[92:95], v[36:39]
buffer_load_dwordx4 v13, s[12:15], s49 offen offset:0 nt lds
v_mfma_f32_16x16x32_bf16 v[136:139], a[136:139], v[88:91], v[136:139]
v_cvt_pk_bf16_f32 v208, v208, v209
v_cvt_pk_bf16_f32 v209, v210, v211
v_mfma_f32_16x16x32_bf16 v[136:139], a[132:135], v[84:87], v[136:139]
v_exp_f32 v242, v242
v_mfma_f32_16x16x32_bf16 v[136:139], a[128:131], v[80:83], v[136:139]
v_max3_f32 v19, v128, v129, v130
v_max_f32 v19, v131, v19
v_mfma_f32_16x16x32_bf16 v[144:147], a[128:131], v[96:99], v[40:43]
v_exp_f32 v243, v243
v_mfma_f32_16x16x32_bf16 v[144:147], a[132:135], v[100:103], v[144:147]
v_cvt_pk_bf16_f32 v210, v212, v213
v_cvt_pk_bf16_f32 v211, v214, v215
v_mfma_f32_16x16x32_bf16 v[144:147], a[136:139], v[104:107], v[144:147]
v_max3_f32 v20, v136, v137, v138
v_max_f32 v20, v139, v20
v_mfma_f32_16x16x32_bf16 v[144:147], a[140:143], v[108:111], v[144:147]
v_exp_f32 v244, v244
v_mfma_f32_16x16x32_bf16 v[152:155], a[140:143], v[124:127], v[44:47]
v_cvt_pk_bf16_f32 v240, v240, v241
v_cvt_pk_bf16_f32 v241, v242, v243
v_mfma_f32_16x16x32_bf16 v[152:155], a[136:139], v[120:123], v[152:155]
v_exp_f32 v245, v245
v_mfma_f32_16x16x32_bf16 v[152:155], a[132:135], v[116:119], v[152:155]
v_max3_f32 v19, v144, v145, v19
v_max3_f32 v19, v146, v147, v19
v_mfma_f32_16x16x32_bf16 v[152:155], a[128:131], v[112:115], v[152:155]
s_waitcnt lgkmcnt(8)
ds_read_b64_tr_b16 a[128:129], v5 offset:16384
ds_read_b64_tr_b16 a[130:131], v5 offset:20480
v_mfma_f32_16x16x32_bf16 v[132:135], a[144:147], v[64:67], v[32:35]
v_exp_f32 v246, v246
v_mfma_f32_16x16x32_bf16 v[132:135], a[148:151], v[68:71], v[132:135]
ds_read_b64_tr_b16 a[132:133], v5 offset:24576
ds_read_b64_tr_b16 a[134:135], v5 offset:28672
v_mfma_f32_16x16x32_bf16 v[132:135], a[152:155], v[72:75], v[132:135]
buffer_load_dwordx4 v16, s[12:15], s49 offen offset:3072 nt lds
v_mfma_f32_16x16x32_bf16 v[132:135], a[156:159], v[76:79], v[132:135]
v_exp_f32 v247, v247
v_mfma_f32_16x16x32_bf16 v[140:143], a[156:159], v[92:95], v[36:39]
v_max3_f32 v20, v152, v153, v20
v_max3_f32 v20, v154, v155, v20
v_mfma_f32_16x16x32_bf16 v[140:143], a[152:155], v[88:91], v[140:143]
ds_read_b64_tr_b16 a[136:137], v6 offset:16384
ds_read_b64_tr_b16 a[138:139], v6 offset:20480
v_mfma_f32_16x16x32_bf16 v[140:143], a[148:151], v[84:87], v[140:143]
v_exp_f32 v248, v248
v_mfma_f32_16x16x32_bf16 v[140:143], a[144:147], v[80:83], v[140:143]
v_max3_f32 v19, v132, v133, v19
v_max3_f32 v19, v134, v135, v19
v_mfma_f32_16x16x32_bf16 v[148:151], a[144:147], v[96:99], v[40:43]
v_exp_f32 v249, v249
v_mfma_f32_16x16x32_bf16 v[148:151], a[148:151], v[100:103], v[148:151]
ds_read_b64_tr_b16 a[140:141], v6 offset:24576
ds_read_b64_tr_b16 a[142:143], v6 offset:28672
v_mfma_f32_16x16x32_bf16 v[148:151], a[152:155], v[104:107], v[148:151]
v_max3_f32 v20, v140, v141, v20
v_max3_f32 v20, v142, v143, v20
v_mfma_f32_16x16x32_bf16 v[148:151], a[156:159], v[108:111], v[148:151]
v_exp_f32 v250, v250
v_mfma_f32_16x16x32_bf16 v[156:159], a[156:159], v[124:127], v[44:47]
v_cvt_pk_bf16_f32 v242, v244, v245
v_cvt_pk_bf16_f32 v243, v246, v247
v_mfma_f32_16x16x32_bf16 v[156:159], a[152:155], v[120:123], v[156:159]
v_exp_f32 v251, v251
v_mfma_f32_16x16x32_bf16 v[156:159], a[148:151], v[116:119], v[156:159]
v_max3_f32 v19, v148, v149, v19
v_max3_f32 v19, v150, v151, v19
v_mfma_f32_16x16x32_bf16 v[156:159], a[144:147], v[112:115], v[156:159]
s_waitcnt lgkmcnt(12)
ds_read_b64_tr_b16 a[144:145], v7 offset:16384
ds_read_b64_tr_b16 a[146:147], v7 offset:20480
v_mfma_f32_16x16x32_bf16 v[160:163], a[160:163], v[64:67], v[32:35]
buffer_load_dwordx4 v14, s[12:15], s49 offen offset:1024 nt lds
v_mfma_f32_16x16x32_bf16 v[160:163], a[164:167], v[68:71], v[160:163]
v_exp_f32 v252, v252
v_mfma_f32_16x16x32_bf16 v[160:163], a[168:171], v[72:75], v[160:163]
v_max3_f32 v20, v156, v157, v20
v_max3_f32 v20, v158, v159, v20
v_mfma_f32_16x16x32_bf16 v[160:163], a[172:175], v[76:79], v[160:163]
v_exp_f32 v253, v253
v_mfma_f32_16x16x32_bf16 v[168:171], a[172:175], v[92:95], v[36:39]
ds_read_b64_tr_b16 a[148:149], v7 offset:24576
ds_read_b64_tr_b16 a[150:151], v7 offset:28672
v_mfma_f32_16x16x32_bf16 v[168:171], a[168:171], v[88:91], v[168:171]
ds_read_b64_tr_b16 a[152:153], v8 offset:16384
ds_read_b64_tr_b16 a[154:155], v8 offset:20480
v_mfma_f32_16x16x32_bf16 v[168:171], a[164:167], v[84:87], v[168:171]
v_exp_f32 v254, v254
v_mfma_f32_16x16x32_bf16 v[168:171], a[160:163], v[80:83], v[168:171]
v_max3_f32 v19, v160, v161, v19
v_max3_f32 v19, v162, v163, v19
v_mfma_f32_16x16x32_bf16 v[176:179], a[160:163], v[96:99], v[40:43]
s_cmp_eq_u32 s45, 2
v_exp_f32 v255, v255
v_mfma_f32_16x16x32_bf16 v[176:179], a[164:167], v[100:103], v[176:179]
s_cselect_b32 s78, 256, 0
ds_read_b64_tr_b16 a[156:157], v8 offset:24576
v_cvt_pk_bf16_f32 v248, v248, v249
v_mfma_f32_16x16x32_bf16 v[176:179], a[168:171], v[104:107], v[176:179]
v_max3_f32 v20, v168, v169, v20
v_max3_f32 v20, v170, v171, v20
v_mfma_f32_16x16x32_bf16 v[176:179], a[172:175], v[108:111], v[176:179]
v_exp_f32 v216, v216
v_mfma_f32_16x16x32_bf16 v[184:187], a[172:175], v[124:127], v[44:47]
ds_read_b64_tr_b16 a[158:159], v8 offset:28672
v_cvt_pk_bf16_f32 v249, v250, v251
v_mfma_f32_16x16x32_bf16 v[184:187], a[168:171], v[120:123], v[184:187]
v_exp_f32 v217, v217
v_mfma_f32_16x16x32_bf16 v[184:187], a[164:167], v[116:119], v[184:187]
buffer_load_dwordx4 v15, s[12:15], s49 offen offset:2048 nt lds
v_mfma_f32_16x16x32_bf16 v[184:187], a[160:163], v[112:115], v[184:187]
s_waitcnt lgkmcnt(15)
v_max3_f32 v19, v176, v177, v19
v_max3_f32 v19, v178, v179, v19
v_mfma_f32_16x16x32_bf16 v[164:167], a[176:179], v[64:67], v[32:35]
ds_read_b64_tr_b16 a[160:161], v9 offset:16384
v_cvt_pk_bf16_f32 v250, v252, v253
v_mfma_f32_16x16x32_bf16 v[164:167], a[180:183], v[68:71], v[164:167]
v_exp_f32 v218, v218
v_mfma_f32_16x16x32_bf16 v[164:167], a[184:187], v[72:75], v[164:167]
v_max3_f32 v20, v184, v185, v20
v_max3_f32 v20, v186, v187, v20
v_mfma_f32_16x16x32_bf16 v[164:167], a[188:191], v[76:79], v[164:167]
v_exp_f32 v219, v219
v_mfma_f32_16x16x32_bf16 v[172:175], a[188:191], v[92:95], v[36:39]
ds_read_b64_tr_b16 a[162:163], v9 offset:20480
v_cvt_pk_bf16_f32 v251, v254, v255
v_mfma_f32_16x16x32_bf16 v[172:175], a[184:187], v[88:91], v[172:175]
ds_read_b64_tr_b16 a[164:165], v9 offset:24576
v_cvt_pk_bf16_f32 v216, v216, v217
v_mfma_f32_16x16x32_bf16 v[172:175], a[180:183], v[84:87], v[172:175]
v_exp_f32 v220, v220
v_mfma_f32_16x16x32_bf16 v[172:175], a[176:179], v[80:83], v[172:175]
v_max3_f32 v19, v164, v165, v19
v_max3_f32 v19, v166, v167, v19
v_mfma_f32_16x16x32_bf16 v[180:183], a[176:179], v[96:99], v[40:43]
v_exp_f32 v221, v221
v_mfma_f32_16x16x32_bf16 v[180:183], a[180:183], v[100:103], v[180:183]
ds_read_b64_tr_b16 a[166:167], v9 offset:28672
v_cvt_pk_bf16_f32 v217, v218, v219
v_mfma_f32_16x16x32_bf16 v[180:183], a[184:187], v[104:107], v[180:183]
v_max3_f32 v20, v172, v173, v20
v_max3_f32 v20, v174, v175, v20
v_mfma_f32_16x16x32_bf16 v[180:183], a[188:191], v[108:111], v[180:183]
v_exp_f32 v222, v222
v_mfma_f32_16x16x32_bf16 v[188:191], a[188:191], v[124:127], v[44:47]
v_cvt_pk_bf16_f32 v218, v220, v221
v_mfma_f32_16x16x32_bf16 v[188:191], a[184:187], v[120:123], v[188:191]
v_exp_f32 v223, v223
v_mfma_f32_16x16x32_bf16 v[188:191], a[180:183], v[116:119], v[188:191]
v_max3_f32 v19, v180, v181, v19
v_max3_f32 v19, v182, v183, v19
v_mfma_f32_16x16x32_bf16 v[188:191], a[176:179], v[112:115], v[188:191]
s_waitcnt lgkmcnt(15)
v_cvt_pk_bf16_f32 v219, v222, v223
v_mfma_f32_16x16x32_bf16 a[0:3], a[128:131], v[192:195], a[0:3]
v_and_b32 v22, 3, v0
v_lshlrev_b32 v22, 6, v22
v_mfma_f32_16x16x32_bf16 a[0:3], a[132:135], v[224:227], a[0:3]
buffer_load_dword v22, v22, s[76:79], 0 offen sc1
v_mfma_f32_16x16x32_bf16 a[32:35], a[132:135], v[232:235], a[32:35]
v_max3_f32 v20, v188, v189, v20
v_max3_f32 v20, v190, v191, v20
v_mfma_f32_16x16x32_bf16 a[32:35], a[128:131], v[200:203], a[32:35]
v_max_f32 v19, v19, v20
v_cmp_lt_f32 vcc, s46, v19
v_mfma_f32_16x16x32_bf16 a[64:67], a[128:131], v[208:211], a[64:67]
buffer_atomic_add v28, v21, s[88:91], 0 offen sc1
v_mfma_f32_16x16x32_bf16 a[64:67], a[132:135], v[240:243], a[64:67]
s_cbranch_vccnz L_r1a
L_r1a_back:
v_exp_f32 v128, v128
v_mfma_f32_16x16x32_bf16 a[96:99], a[132:135], v[248:251], a[96:99]
s_add_u32 m0, s27, 114688
v_exp_f32 v129, v129
v_mfma_f32_16x16x32_bf16 a[96:99], a[128:131], v[216:219], a[96:99]
s_waitcnt lgkmcnt(12)
ds_read_b64_tr_b16 a[168:169], v10 offset:16384
ds_read_b64_tr_b16 a[170:171], v10 offset:20480
v_mfma_f32_16x16x32_bf16 a[4:7], a[136:139], v[192:195], a[4:7]
buffer_load_dwordx4 v17, s[16:19], s44 offen offset:0 nt lds
v_mfma_f32_16x16x32_bf16 a[4:7], a[140:143], v[224:227], a[4:7]
v_exp_f32 v130, v130
v_mfma_f32_16x16x32_bf16 a[36:39], a[140:143], v[232:235], a[36:39]
v_exp_f32 v131, v131
v_mfma_f32_16x16x32_bf16 a[36:39], a[136:139], v[200:203], a[36:39]
s_mov_b32 s90, 0
ds_read_b64_tr_b16 a[172:173], v10 offset:24576
ds_read_b64_tr_b16 a[174:175], v10 offset:28672
v_mfma_f32_16x16x32_bf16 a[68:71], a[136:139], v[208:211], a[68:71]
v_exp_f32 v132, v132
v_mfma_f32_16x16x32_bf16 a[68:71], a[140:143], v[240:243], a[68:71]
v_exp_f32 v133, v133
v_mfma_f32_16x16x32_bf16 a[100:103], a[140:143], v[248:251], a[100:103]
ds_read_b64_tr_b16 a[176:177], v11 offset:16384
ds_read_b64_tr_b16 a[178:179], v11 offset:20480
v_mfma_f32_16x16x32_bf16 a[100:103], a[136:139], v[216:219], a[100:103]
s_waitcnt lgkmcnt(14)
v_exp_f32 v134, v134
v_mfma_f32_16x16x32_bf16 a[8:11], a[144:147], v[192:195], a[8:11]
v_exp_f32 v135, v135
v_mfma_f32_16x16x32_bf16 a[8:11], a[148:151], v[224:227], a[8:11]
ds_read_b64_tr_b16 a[180:181], v11 offset:24576
ds_read_b64_tr_b16 a[182:183], v11 offset:28672
v_mfma_f32_16x16x32_bf16 a[40:43], a[148:151], v[232:235], a[40:43]
v_exp_f32 v160, v160
v_mfma_f32_16x16x32_bf16 a[40:43], a[144:147], v[200:203], a[40:43]
v_exp_f32 v161, v161
v_mfma_f32_16x16x32_bf16 a[72:75], a[144:147], v[208:211], a[72:75]
ds_read_b64_tr_b16 a[184:185], v12 offset:16384
ds_read_b64_tr_b16 a[186:187], v12 offset:20480
v_mfma_f32_16x16x32_bf16 a[72:75], a[148:151], v[240:243], a[72:75]
v_exp_f32 v162, v162
v_mfma_f32_16x16x32_bf16 a[104:107], a[148:151], v[248:251], a[104:107]
s_add_u32 s92, s44, 129024
buffer_load_dwordx4 v18, s[16:19], s92 offen offset:3072 nt lds
v_mfma_f32_16x16x32_bf16 a[104:107], a[144:147], v[216:219], a[104:107]
s_waitcnt lgkmcnt(14)
ds_read_b64_tr_b16 a[188:189], v12 offset:24576
ds_read_b64_tr_b16 a[190:191], v12 offset:28672
v_mfma_f32_16x16x32_bf16 a[12:15], a[152:155], v[192:195], a[12:15]
v_exp_f32 v163, v163
v_mfma_f32_16x16x32_bf16 a[12:15], a[156:159], v[224:227], a[12:15]
v_exp_f32 v164, v164
v_mfma_f32_16x16x32_bf16 a[44:47], a[156:159], v[232:235], a[44:47]
v_cvt_pk_bf16_f32 v128, v128, v129
v_cvt_pk_bf16_f32 v129, v130, v131
v_mfma_f32_16x16x32_bf16 a[44:47], a[152:155], v[200:203], a[44:47]
v_exp_f32 v165, v165
v_mfma_f32_16x16x32_bf16 a[76:79], a[152:155], v[208:211], a[76:79]
v_exp_f32 v166, v166
v_mfma_f32_16x16x32_bf16 a[76:79], a[156:159], v[240:243], a[76:79]
v_cvt_pk_bf16_f32 v130, v132, v133
v_cvt_pk_bf16_f32 v131, v134, v135
v_mfma_f32_16x16x32_bf16 a[108:111], a[156:159], v[248:251], a[108:111]
v_exp_f32 v167, v167
v_mfma_f32_16x16x32_bf16 a[108:111], a[152:155], v[216:219], a[108:111]
s_waitcnt lgkmcnt(12)
v_exp_f32 v168, v168
v_mfma_f32_16x16x32_bf16 a[16:19], a[160:163], v[192:195], a[16:19]
v_cvt_pk_bf16_f32 v160, v160, v161
v_cvt_pk_bf16_f32 v161, v162, v163
v_mfma_f32_16x16x32_bf16 a[16:19], a[164:167], v[224:227], a[16:19]
v_exp_f32 v169, v169
v_mfma_f32_16x16x32_bf16 a[48:51], a[164:167], v[232:235], a[48:51]
v_exp_f32 v170, v170
v_mfma_f32_16x16x32_bf16 a[48:51], a[160:163], v[200:203], a[48:51]
v_cvt_pk_bf16_f32 v162, v164, v165
v_cvt_pk_bf16_f32 v163, v166, v167
v_mfma_f32_16x16x32_bf16 a[80:83], a[160:163], v[208:211], a[80:83]
buffer_load_dwordx4 v18, s[16:19], s44 offen offset:1024 nt lds
v_mfma_f32_16x16x32_bf16 a[80:83], a[164:167], v[240:243], a[80:83]
v_exp_f32 v171, v171
v_mfma_f32_16x16x32_bf16 a[112:115], a[164:167], v[248:251], a[112:115]
v_cvt_pk_bf16_f32 v168, v168, v169
v_cvt_pk_bf16_f32 v169, v170, v171
v_mfma_f32_16x16x32_bf16 a[112:115], a[160:163], v[216:219], a[112:115]
s_waitcnt lgkmcnt(8)
v_exp_f32 v172, v172
v_mfma_f32_16x16x32_bf16 a[20:23], a[168:171], v[192:195], a[20:23]
v_exp_f32 v173, v173
v_mfma_f32_16x16x32_bf16 a[20:23], a[172:175], v[224:227], a[20:23]
v_cvt_pk_bf16_f32 v170, v172, v173
v_mfma_f32_16x16x32_bf16 a[52:55], a[172:175], v[232:235], a[52:55]
v_exp_f32 v174, v174
v_mfma_f32_16x16x32_bf16 a[52:55], a[168:171], v[200:203], a[52:55]
v_exp_f32 v175, v175
v_mfma_f32_16x16x32_bf16 a[84:87], a[168:171], v[208:211], a[84:87]
v_cvt_pk_bf16_f32 v171, v174, v175
v_mfma_f32_16x16x32_bf16 a[84:87], a[172:175], v[240:243], a[84:87]
v_exp_f32 v136, v136
v_mfma_f32_16x16x32_bf16 a[116:119], a[172:175], v[248:251], a[116:119]
v_exp_f32 v137, v137
v_mfma_f32_16x16x32_bf16 a[116:119], a[168:171], v[216:219], a[116:119]
s_waitcnt lgkmcnt(4)
v_cvt_pk_bf16_f32 v136, v136, v137
v_mfma_f32_16x16x32_bf16 a[24:27], a[176:179], v[192:195], a[24:27]
v_exp_f32 v138, v138
v_mfma_f32_16x16x32_bf16 a[24:27], a[180:183], v[224:227], a[24:27]
v_exp_f32 v139, v139
v_mfma_f32_16x16x32_bf16 a[56:59], a[180:183], v[232:235], a[56:59]
buffer_load_dwordx4 v17, s[16:19], s92 offen offset:2048 nt lds
v_mfma_f32_16x16x32_bf16 a[56:59], a[176:179], v[200:203], a[56:59]
v_cvt_pk_bf16_f32 v137, v138, v139
v_mfma_f32_16x16x32_bf16 a[88:91], a[176:179], v[208:211], a[88:91]
v_exp_f32 v140, v140
v_mfma_f32_16x16x32_bf16 a[88:91], a[180:183], v[240:243], a[88:91]
s_waitcnt vmcnt(10) lgkmcnt(0)
v_exp_f32 v141, v141
v_mfma_f32_16x16x32_bf16 a[120:123], a[180:183], v[248:251], a[120:123]
s_barrier
v_mfma_f32_16x16x32_bf16 a[120:123], a[176:179], v[216:219], a[120:123]
ds_read_b128 a[128:131], v1 offset:49152
ds_read_b128 a[132:135], v2 offset:49152
v_mfma_f32_16x16x32_bf16 a[28:31], a[184:187], v[192:195], a[28:31]
s_mov_b32 s44, s49
v_exp_f32 v142, v142
v_mfma_f32_16x16x32_bf16 a[28:31], a[188:191], v[224:227], a[28:31]
s_or_b32 s49, s49, 0xffff87ff
ds_read_b128 a[136:139], v3 offset:49152
ds_read_b128 a[140:143], v4 offset:49152
v_mfma_f32_16x16x32_bf16 a[60:63], a[188:191], v[232:235], a[60:63]
s_add_u32 s49, s49, 1
v_exp_f32 v143, v143
v_mfma_f32_16x16x32_bf16 a[60:63], a[184:187], v[200:203], a[60:63]
s_and_b32 s49, s49, 0x7800
v_exp_f32 v144, v144
v_mfma_f32_16x16x32_bf16 a[92:95], a[184:187], v[208:211], a[92:95]
ds_read_b128 a[144:147], v1 offset:53248
ds_read_b128 a[148:151], v2 offset:53248
v_mfma_f32_16x16x32_bf16 a[92:95], a[188:191], v[240:243], a[92:95]
v_exp_f32 v145, v145
v_mfma_f32_16x16x32_bf16 a[124:127], a[188:191], v[248:251], a[124:127]
v_exp_f32 v146, v146
v_mfma_f32_16x16x32_bf16 a[124:127], a[184:187], v[216:219], a[124:127]
ds_read_b128 a[152:155], v3 offset:53248
ds_read_b128 a[156:159], v4 offset:53248
v_mfma_f32_16x16x32_bf16 v[48:51], v[28:31], v[192:195], v[48:51]
v_exp_f32 v147, v147
v_mfma_f32_16x16x32_bf16 v[48:51], v[28:31], v[224:227], v[48:51]
v_exp_f32 v148, v148
v_mfma_f32_16x16x32_bf16 v[52:55], v[28:31], v[200:203], v[52:55]
ds_read_b128 a[160:163], v1 offset:57344
ds_read_b128 a[164:167], v2 offset:57344
v_mfma_f32_16x16x32_bf16 v[52:55], v[28:31], v[232:235], v[52:55]
v_exp_f32 v149, v149
v_mfma_f32_16x16x32_bf16 v[56:59], v[28:31], v[208:211], v[56:59]
v_exp_f32 v150, v150
v_mfma_f32_16x16x32_bf16 v[56:59], v[28:31], v[240:243], v[56:59]
ds_read_b128 a[168:171], v3 offset:57344
ds_read_b128 a[172:175], v4 offset:57344
v_mfma_f32_16x16x32_bf16 v[60:63], v[28:31], v[216:219], v[60:63]
s_waitcnt lgkmcnt(8)
v_exp_f32 v151, v151
v_mfma_f32_16x16x32_bf16 v[60:63], v[28:31], v[248:251], v[60:63]
s_cbranch_vccnz L_r1b
L_r1b_back:
ds_read_b128 a[176:179], v1 offset:61440
ds_read_b128 a[180:183], v2 offset:61440
v_mfma_f32_16x16x32_bf16 v[192:195], a[128:131], v[64:67], v[32:35]
v_exp_f32 v176, v176
v_mfma_f32_16x16x32_bf16 v[192:195], a[132:135], v[68:71], v[192:195]
ds_read_b128 a[184:187], v3 offset:61440
ds_read_b128 a[188:191], v4 offset:61440
v_mfma_f32_16x16x32_bf16 v[192:195], a[136:139], v[72:75], v[192:195]
v_exp_f32 v177, v177
v_mfma_f32_16x16x32_bf16 v[192:195], a[140:143], v[76:79], v[192:195]
s_add_u32 m0, s27, 16384
v_cvt_pk_bf16_f32 v138, v140, v141
v_cvt_pk_bf16_f32 v139, v142, v143
v_mfma_f32_16x16x32_bf16 v[200:203], a[140:143], v[92:95], v[36:39]
buffer_load_dwordx4 v13, s[12:15], s49 offen offset:0 nt lds
v_mfma_f32_16x16x32_bf16 v[200:203], a[136:139], v[88:91], v[200:203]
v_cvt_pk_bf16_f32 v144, v144, v145
v_cvt_pk_bf16_f32 v145, v146, v147
v_mfma_f32_16x16x32_bf16 v[200:203], a[132:135], v[84:87], v[200:203]
v_exp_f32 v178, v178
v_mfma_f32_16x16x32_bf16 v[200:203], a[128:131], v[80:83], v[200:203]
v_max3_f32 v19, v192, v193, v194
v_max_f32 v19, v195, v19
v_mfma_f32_16x16x32_bf16 v[208:211], a[128:131], v[96:99], v[40:43]
v_exp_f32 v179, v179
v_mfma_f32_16x16x32_bf16 v[208:211], a[132:135], v[100:103], v[208:211]
v_cvt_pk_bf16_f32 v146, v148, v149
v_cvt_pk_bf16_f32 v147, v150, v151
v_mfma_f32_16x16x32_bf16 v[208:211], a[136:139], v[104:107], v[208:211]
v_max3_f32 v20, v200, v201, v202
v_max_f32 v20, v203, v20
v_mfma_f32_16x16x32_bf16 v[208:211], a[140:143], v[108:111], v[208:211]
v_exp_f32 v180, v180
v_mfma_f32_16x16x32_bf16 v[216:219], a[140:143], v[124:127], v[44:47]
v_cvt_pk_bf16_f32 v176, v176, v177
v_cvt_pk_bf16_f32 v177, v178, v179
v_mfma_f32_16x16x32_bf16 v[216:219], a[136:139], v[120:123], v[216:219]
v_exp_f32 v181, v181
v_mfma_f32_16x16x32_bf16 v[216:219], a[132:135], v[116:119], v[216:219]
v_max3_f32 v19, v208, v209, v19
v_max3_f32 v19, v210, v211, v19
v_mfma_f32_16x16x32_bf16 v[216:219], a[128:131], v[112:115], v[216:219]
s_waitcnt lgkmcnt(8)
ds_read_b64_tr_b16 a[128:129], v5 offset:32768
ds_read_b64_tr_b16 a[130:131], v5 offset:36864
v_mfma_f32_16x16x32_bf16 v[196:199], a[144:147], v[64:67], v[32:35]
v_exp_f32 v182, v182
v_mfma_f32_16x16x32_bf16 v[196:199], a[148:151], v[68:71], v[196:199]
ds_read_b64_tr_b16 a[132:133], v5 offset:40960
ds_read_b64_tr_b16 a[134:135], v5 offset:45056
v_mfma_f32_16x16x32_bf16 v[196:199], a[152:155], v[72:75], v[196:199]
buffer_load_dwordx4 v16, s[12:15], s49 offen offset:3072 nt lds
v_mfma_f32_16x16x32_bf16 v[196:199], a[156:159], v[76:79], v[196:199]
v_exp_f32 v183, v183
v_mfma_f32_16x16x32_bf16 v[204:207], a[156:159], v[92:95], v[36:39]
v_max3_f32 v20, v216, v217, v20
v_max3_f32 v20, v218, v219, v20
v_mfma_f32_16x16x32_bf16 v[204:207], a[152:155], v[88:91], v[204:207]
ds_read_b64_tr_b16 a[136:137], v6 offset:32768
ds_read_b64_tr_b16 a[138:139], v6 offset:36864
v_mfma_f32_16x16x32_bf16 v[204:207], a[148:151], v[84:87], v[204:207]
v_exp_f32 v184, v184
v_mfma_f32_16x16x32_bf16 v[204:207], a[144:147], v[80:83], v[204:207]
v_max3_f32 v19, v196, v197, v19
v_max3_f32 v19, v198, v199, v19
v_mfma_f32_16x16x32_bf16 v[212:215], a[144:147], v[96:99], v[40:43]
v_exp_f32 v185, v185
v_mfma_f32_16x16x32_bf16 v[212:215], a[148:151], v[100:103], v[212:215]
ds_read_b64_tr_b16 a[140:141], v6 offset:40960
ds_read_b64_tr_b16 a[142:143], v6 offset:45056
v_mfma_f32_16x16x32_bf16 v[212:215], a[152:155], v[104:107], v[212:215]
v_max3_f32 v20, v204, v205, v20
v_max3_f32 v20, v206, v207, v20
v_mfma_f32_16x16x32_bf16 v[212:215], a[156:159], v[108:111], v[212:215]
v_exp_f32 v186, v186
v_mfma_f32_16x16x32_bf16 v[220:223], a[156:159], v[124:127], v[44:47]
v_cvt_pk_bf16_f32 v178, v180, v181
v_cvt_pk_bf16_f32 v179, v182, v183
v_mfma_f32_16x16x32_bf16 v[220:223], a[152:155], v[120:123], v[220:223]
v_exp_f32 v187, v187
v_mfma_f32_16x16x32_bf16 v[220:223], a[148:151], v[116:119], v[220:223]
v_max3_f32 v19, v212, v213, v19
v_max3_f32 v19, v214, v215, v19
v_mfma_f32_16x16x32_bf16 v[220:223], a[144:147], v[112:115], v[220:223]
s_waitcnt lgkmcnt(12)
ds_read_b64_tr_b16 a[144:145], v7 offset:32768
ds_read_b64_tr_b16 a[146:147], v7 offset:36864
v_mfma_f32_16x16x32_bf16 v[224:227], a[160:163], v[64:67], v[32:35]
buffer_load_dwordx4 v14, s[12:15], s49 offen offset:1024 nt lds
v_mfma_f32_16x16x32_bf16 v[224:227], a[164:167], v[68:71], v[224:227]
v_exp_f32 v188, v188
v_mfma_f32_16x16x32_bf16 v[224:227], a[168:171], v[72:75], v[224:227]
v_max3_f32 v20, v220, v221, v20
v_max3_f32 v20, v222, v223, v20
v_mfma_f32_16x16x32_bf16 v[224:227], a[172:175], v[76:79], v[224:227]
v_exp_f32 v189, v189
v_mfma_f32_16x16x32_bf16 v[232:235], a[172:175], v[92:95], v[36:39]
ds_read_b64_tr_b16 a[148:149], v7 offset:40960
ds_read_b64_tr_b16 a[150:151], v7 offset:45056
v_mfma_f32_16x16x32_bf16 v[232:235], a[168:171], v[88:91], v[232:235]
ds_read_b64_tr_b16 a[152:153], v8 offset:32768
ds_read_b64_tr_b16 a[154:155], v8 offset:36864
v_mfma_f32_16x16x32_bf16 v[232:235], a[164:167], v[84:87], v[232:235]
v_exp_f32 v190, v190
v_mfma_f32_16x16x32_bf16 v[232:235], a[160:163], v[80:83], v[232:235]
v_max3_f32 v19, v224, v225, v19
v_max3_f32 v19, v226, v227, v19
v_mfma_f32_16x16x32_bf16 v[240:243], a[160:163], v[96:99], v[40:43]
v_exp_f32 v191, v191
v_mfma_f32_16x16x32_bf16 v[240:243], a[164:167], v[100:103], v[240:243]
ds_read_b64_tr_b16 a[156:157], v8 offset:40960
v_cvt_pk_bf16_f32 v184, v184, v185
v_mfma_f32_16x16x32_bf16 v[240:243], a[168:171], v[104:107], v[240:243]
v_max3_f32 v20, v232, v233, v20
v_max3_f32 v20, v234, v235, v20
v_mfma_f32_16x16x32_bf16 v[240:243], a[172:175], v[108:111], v[240:243]
v_exp_f32 v152, v152
v_mfma_f32_16x16x32_bf16 v[248:251], a[172:175], v[124:127], v[44:47]
ds_read_b64_tr_b16 a[158:159], v8 offset:45056
v_cvt_pk_bf16_f32 v185, v186, v187
v_mfma_f32_16x16x32_bf16 v[248:251], a[168:171], v[120:123], v[248:251]
v_exp_f32 v153, v153
v_mfma_f32_16x16x32_bf16 v[248:251], a[164:167], v[116:119], v[248:251]
buffer_load_dwordx4 v15, s[12:15], s49 offen offset:2048 nt lds
v_mfma_f32_16x16x32_bf16 v[248:251], a[160:163], v[112:115], v[248:251]
s_waitcnt lgkmcnt(15)
v_max3_f32 v19, v240, v241, v19
v_max3_f32 v19, v242, v243, v19
v_mfma_f32_16x16x32_bf16 v[228:231], a[176:179], v[64:67], v[32:35]
ds_read_b64_tr_b16 a[160:161], v9 offset:32768
v_cvt_pk_bf16_f32 v186, v188, v189
v_mfma_f32_16x16x32_bf16 v[228:231], a[180:183], v[68:71], v[228:231]
v_exp_f32 v154, v154
v_mfma_f32_16x16x32_bf16 v[228:231], a[184:187], v[72:75], v[228:231]
v_max3_f32 v20, v248, v249, v20
v_max3_f32 v20, v250, v251, v20
v_mfma_f32_16x16x32_bf16 v[228:231], a[188:191], v[76:79], v[228:231]
v_exp_f32 v155, v155
v_mfma_f32_16x16x32_bf16 v[236:239], a[188:191], v[92:95], v[36:39]
ds_read_b64_tr_b16 a[162:163], v9 offset:36864
v_cvt_pk_bf16_f32 v187, v190, v191
v_mfma_f32_16x16x32_bf16 v[236:239], a[184:187], v[88:91], v[236:239]
ds_read_b64_tr_b16 a[164:165], v9 offset:40960
v_cvt_pk_bf16_f32 v152, v152, v153
v_mfma_f32_16x16x32_bf16 v[236:239], a[180:183], v[84:87], v[236:239]
v_exp_f32 v156, v156
v_mfma_f32_16x16x32_bf16 v[236:239], a[176:179], v[80:83], v[236:239]
v_max3_f32 v19, v228, v229, v19
v_max3_f32 v19, v230, v231, v19
v_mfma_f32_16x16x32_bf16 v[244:247], a[176:179], v[96:99], v[40:43]
v_exp_f32 v157, v157
v_mfma_f32_16x16x32_bf16 v[244:247], a[180:183], v[100:103], v[244:247]
ds_read_b64_tr_b16 a[166:167], v9 offset:45056
v_cvt_pk_bf16_f32 v153, v154, v155
v_mfma_f32_16x16x32_bf16 v[244:247], a[184:187], v[104:107], v[244:247]
v_max3_f32 v20, v236, v237, v20
v_max3_f32 v20, v238, v239, v20
v_mfma_f32_16x16x32_bf16 v[244:247], a[188:191], v[108:111], v[244:247]
v_exp_f32 v158, v158
v_mfma_f32_16x16x32_bf16 v[252:255], a[188:191], v[124:127], v[44:47]
v_cvt_pk_bf16_f32 v154, v156, v157
v_mfma_f32_16x16x32_bf16 v[252:255], a[184:187], v[120:123], v[252:255]
v_exp_f32 v159, v159
v_mfma_f32_16x16x32_bf16 v[252:255], a[180:183], v[116:119], v[252:255]
v_max3_f32 v19, v244, v245, v19
v_max3_f32 v19, v246, v247, v19
v_mfma_f32_16x16x32_bf16 v[252:255], a[176:179], v[112:115], v[252:255]
s_waitcnt lgkmcnt(15)
v_cvt_pk_bf16_f32 v155, v158, v159
v_mfma_f32_16x16x32_bf16 a[0:3], a[128:131], v[128:131], a[0:3]
v_mfma_f32_16x16x32_bf16 a[0:3], a[132:135], v[160:163], a[0:3]
v_mfma_f32_16x16x32_bf16 a[32:35], a[132:135], v[168:171], a[32:35]
v_max3_f32 v20, v252, v253, v20
v_max3_f32 v20, v254, v255, v20
v_mfma_f32_16x16x32_bf16 a[32:35], a[128:131], v[136:139], a[32:35]
v_max_f32 v19, v19, v20
v_cmp_lt_f32 vcc, s46, v19
v_mfma_f32_16x16x32_bf16 a[64:67], a[128:131], v[144:147], a[64:67]
v_mfma_f32_16x16x32_bf16 a[64:67], a[132:135], v[176:179], a[64:67]
s_cbranch_vccnz L_r2a
L_r2a_back:
v_exp_f32 v192, v192
v_mfma_f32_16x16x32_bf16 a[96:99], a[132:135], v[184:187], a[96:99]
s_add_u32 m0, s27, 65536
v_exp_f32 v193, v193
v_mfma_f32_16x16x32_bf16 a[96:99], a[128:131], v[152:155], a[96:99]
s_waitcnt lgkmcnt(12)
ds_read_b64_tr_b16 a[168:169], v10 offset:32768
ds_read_b64_tr_b16 a[170:171], v10 offset:36864
v_mfma_f32_16x16x32_bf16 a[4:7], a[136:139], v[128:131], a[4:7]
buffer_load_dwordx4 v17, s[16:19], s44 offen offset:0 nt lds
v_mfma_f32_16x16x32_bf16 a[4:7], a[140:143], v[160:163], a[4:7]
v_exp_f32 v194, v194
v_mfma_f32_16x16x32_bf16 a[36:39], a[140:143], v[168:171], a[36:39]
v_exp_f32 v195, v195
v_mfma_f32_16x16x32_bf16 a[36:39], a[136:139], v[136:139], a[36:39]
ds_read_b64_tr_b16 a[172:173], v10 offset:40960
ds_read_b64_tr_b16 a[174:175], v10 offset:45056
v_mfma_f32_16x16x32_bf16 a[68:71], a[136:139], v[144:147], a[68:71]
v_exp_f32 v196, v196
v_mfma_f32_16x16x32_bf16 a[68:71], a[140:143], v[176:179], a[68:71]
v_exp_f32 v197, v197
v_mfma_f32_16x16x32_bf16 a[100:103], a[140:143], v[184:187], a[100:103]
ds_read_b64_tr_b16 a[176:177], v11 offset:32768
ds_read_b64_tr_b16 a[178:179], v11 offset:36864
v_mfma_f32_16x16x32_bf16 a[100:103], a[136:139], v[152:155], a[100:103]
s_waitcnt lgkmcnt(14)
v_exp_f32 v198, v198
v_mfma_f32_16x16x32_bf16 a[8:11], a[144:147], v[128:131], a[8:11]
v_exp_f32 v199, v199
v_mfma_f32_16x16x32_bf16 a[8:11], a[148:151], v[160:163], a[8:11]
ds_read_b64_tr_b16 a[180:181], v11 offset:40960
ds_read_b64_tr_b16 a[182:183], v11 offset:45056
v_mfma_f32_16x16x32_bf16 a[40:43], a[148:151], v[168:171], a[40:43]
v_exp_f32 v224, v224
v_mfma_f32_16x16x32_bf16 a[40:43], a[144:147], v[136:139], a[40:43]
v_exp_f32 v225, v225
v_mfma_f32_16x16x32_bf16 a[72:75], a[144:147], v[144:147], a[72:75]
ds_read_b64_tr_b16 a[184:185], v12 offset:32768
ds_read_b64_tr_b16 a[186:187], v12 offset:36864
v_mfma_f32_16x16x32_bf16 a[72:75], a[148:151], v[176:179], a[72:75]
v_exp_f32 v226, v226
v_mfma_f32_16x16x32_bf16 a[104:107], a[148:151], v[184:187], a[104:107]
s_add_u32 s92, s44, 129024
buffer_load_dwordx4 v18, s[16:19], s92 offen offset:3072 nt lds
v_mfma_f32_16x16x32_bf16 a[104:107], a[144:147], v[152:155], a[104:107]
s_waitcnt lgkmcnt(14)
ds_read_b64_tr_b16 a[188:189], v12 offset:40960
ds_read_b64_tr_b16 a[190:191], v12 offset:45056
v_mfma_f32_16x16x32_bf16 a[12:15], a[152:155], v[128:131], a[12:15]
v_exp_f32 v227, v227
v_mfma_f32_16x16x32_bf16 a[12:15], a[156:159], v[160:163], a[12:15]
v_exp_f32 v228, v228
v_mfma_f32_16x16x32_bf16 a[44:47], a[156:159], v[168:171], a[44:47]
v_cvt_pk_bf16_f32 v192, v192, v193
v_cvt_pk_bf16_f32 v193, v194, v195
v_mfma_f32_16x16x32_bf16 a[44:47], a[152:155], v[136:139], a[44:47]
v_exp_f32 v229, v229
v_mfma_f32_16x16x32_bf16 a[76:79], a[152:155], v[144:147], a[76:79]
v_exp_f32 v230, v230
v_mfma_f32_16x16x32_bf16 a[76:79], a[156:159], v[176:179], a[76:79]
v_cvt_pk_bf16_f32 v194, v196, v197
v_cvt_pk_bf16_f32 v195, v198, v199
v_mfma_f32_16x16x32_bf16 a[108:111], a[156:159], v[184:187], a[108:111]
v_exp_f32 v231, v231
v_mfma_f32_16x16x32_bf16 a[108:111], a[152:155], v[152:155], a[108:111]
s_waitcnt lgkmcnt(12)
v_exp_f32 v232, v232
v_mfma_f32_16x16x32_bf16 a[16:19], a[160:163], v[128:131], a[16:19]
v_cvt_pk_bf16_f32 v224, v224, v225
v_cvt_pk_bf16_f32 v225, v226, v227
v_mfma_f32_16x16x32_bf16 a[16:19], a[164:167], v[160:163], a[16:19]
v_exp_f32 v233, v233
v_mfma_f32_16x16x32_bf16 a[48:51], a[164:167], v[168:171], a[48:51]
v_exp_f32 v234, v234
v_mfma_f32_16x16x32_bf16 a[48:51], a[160:163], v[136:139], a[48:51]
v_cvt_pk_bf16_f32 v226, v228, v229
v_cvt_pk_bf16_f32 v227, v230, v231
v_mfma_f32_16x16x32_bf16 a[80:83], a[160:163], v[144:147], a[80:83]
buffer_load_dwordx4 v18, s[16:19], s44 offen offset:1024 nt lds
v_mfma_f32_16x16x32_bf16 a[80:83], a[164:167], v[176:179], a[80:83]
v_exp_f32 v235, v235
v_mfma_f32_16x16x32_bf16 a[112:115], a[164:167], v[184:187], a[112:115]
v_cvt_pk_bf16_f32 v232, v232, v233
v_cvt_pk_bf16_f32 v233, v234, v235
v_mfma_f32_16x16x32_bf16 a[112:115], a[160:163], v[152:155], a[112:115]
s_waitcnt lgkmcnt(8)
v_exp_f32 v236, v236
v_mfma_f32_16x16x32_bf16 a[20:23], a[168:171], v[128:131], a[20:23]
v_exp_f32 v237, v237
v_mfma_f32_16x16x32_bf16 a[20:23], a[172:175], v[160:163], a[20:23]
v_cvt_pk_bf16_f32 v234, v236, v237
v_mfma_f32_16x16x32_bf16 a[52:55], a[172:175], v[168:171], a[52:55]
v_exp_f32 v238, v238
v_mfma_f32_16x16x32_bf16 a[52:55], a[168:171], v[136:139], a[52:55]
v_exp_f32 v239, v239
v_mfma_f32_16x16x32_bf16 a[84:87], a[168:171], v[144:147], a[84:87]
v_cvt_pk_bf16_f32 v235, v238, v239
v_mfma_f32_16x16x32_bf16 a[84:87], a[172:175], v[176:179], a[84:87]
v_exp_f32 v200, v200
v_mfma_f32_16x16x32_bf16 a[116:119], a[172:175], v[184:187], a[116:119]
v_exp_f32 v201, v201
v_mfma_f32_16x16x32_bf16 a[116:119], a[168:171], v[152:155], a[116:119]
s_waitcnt lgkmcnt(4)
v_cvt_pk_bf16_f32 v200, v200, v201
v_mfma_f32_16x16x32_bf16 a[24:27], a[176:179], v[128:131], a[24:27]
v_exp_f32 v202, v202
v_mfma_f32_16x16x32_bf16 a[24:27], a[180:183], v[160:163], a[24:27]
v_exp_f32 v203, v203
v_mfma_f32_16x16x32_bf16 a[56:59], a[180:183], v[168:171], a[56:59]
buffer_load_dwordx4 v17, s[16:19], s92 offen offset:2048 nt lds
v_mfma_f32_16x16x32_bf16 a[56:59], a[176:179], v[136:139], a[56:59]
v_cvt_pk_bf16_f32 v201, v202, v203
v_mfma_f32_16x16x32_bf16 a[88:91], a[176:179], v[144:147], a[88:91]
v_exp_f32 v204, v204
v_mfma_f32_16x16x32_bf16 a[88:91], a[180:183], v[176:179], a[88:91]
s_waitcnt vmcnt(8) lgkmcnt(0)
v_exp_f32 v205, v205
v_mfma_f32_16x16x32_bf16 a[120:123], a[180:183], v[184:187], a[120:123]
s_barrier
v_mfma_f32_16x16x32_bf16 a[120:123], a[176:179], v[152:155], a[120:123]
ds_read_b128 a[128:131], v1 offset:0
ds_read_b128 a[132:135], v2 offset:0
v_mfma_f32_16x16x32_bf16 a[28:31], a[184:187], v[128:131], a[28:31]
s_mov_b32 s44, s49
v_exp_f32 v206, v206
v_mfma_f32_16x16x32_bf16 a[28:31], a[188:191], v[160:163], a[28:31]
s_or_b32 s49, s49, 0xffff87ff
ds_read_b128 a[136:139], v3 offset:0
ds_read_b128 a[140:143], v4 offset:0
v_mfma_f32_16x16x32_bf16 a[60:63], a[188:191], v[168:171], a[60:63]
s_add_u32 s49, s49, 1
v_exp_f32 v207, v207
v_mfma_f32_16x16x32_bf16 a[60:63], a[184:187], v[136:139], a[60:63]
s_and_b32 s49, s49, 0x7800
v_exp_f32 v208, v208
v_mfma_f32_16x16x32_bf16 a[92:95], a[184:187], v[144:147], a[92:95]
ds_read_b128 a[144:147], v1 offset:4096
ds_read_b128 a[148:151], v2 offset:4096
v_mfma_f32_16x16x32_bf16 a[92:95], a[188:191], v[176:179], a[92:95]
v_exp_f32 v209, v209
v_mfma_f32_16x16x32_bf16 a[124:127], a[188:191], v[184:187], a[124:127]
v_exp_f32 v210, v210
v_mfma_f32_16x16x32_bf16 a[124:127], a[184:187], v[152:155], a[124:127]
ds_read_b128 a[152:155], v3 offset:4096
ds_read_b128 a[156:159], v4 offset:4096
v_mfma_f32_16x16x32_bf16 v[48:51], v[28:31], v[128:131], v[48:51]
v_exp_f32 v211, v211
v_mfma_f32_16x16x32_bf16 v[48:51], v[28:31], v[160:163], v[48:51]
v_exp_f32 v212, v212
v_mfma_f32_16x16x32_bf16 v[52:55], v[28:31], v[136:139], v[52:55]
ds_read_b128 a[160:163], v1 offset:8192
ds_read_b128 a[164:167], v2 offset:8192
v_mfma_f32_16x16x32_bf16 v[52:55], v[28:31], v[168:171], v[52:55]
v_exp_f32 v213, v213
v_mfma_f32_16x16x32_bf16 v[56:59], v[28:31], v[144:147], v[56:59]
v_exp_f32 v214, v214
v_mfma_f32_16x16x32_bf16 v[56:59], v[28:31], v[176:179], v[56:59]
ds_read_b128 a[168:171], v3 offset:8192
ds_read_b128 a[172:175], v4 offset:8192
v_mfma_f32_16x16x32_bf16 v[60:63], v[28:31], v[152:155], v[60:63]
s_waitcnt lgkmcnt(8)
v_exp_f32 v215, v215
v_mfma_f32_16x16x32_bf16 v[60:63], v[28:31], v[184:187], v[60:63]
s_cbranch_vccnz L_r2b
L_r2b_back:
ds_read_b128 a[176:179], v1 offset:12288
ds_read_b128 a[180:183], v2 offset:12288
v_mfma_f32_16x16x32_bf16 v[128:131], a[128:131], v[64:67], v[32:35]
v_exp_f32 v240, v240
v_mfma_f32_16x16x32_bf16 v[128:131], a[132:135], v[68:71], v[128:131]
ds_read_b128 a[184:187], v3 offset:12288
ds_read_b128 a[188:191], v4 offset:12288
v_mfma_f32_16x16x32_bf16 v[128:131], a[136:139], v[72:75], v[128:131]
v_exp_f32 v241, v241
v_mfma_f32_16x16x32_bf16 v[128:131], a[140:143], v[76:79], v[128:131]
s_add_u32 m0, s27, 32768
v_cvt_pk_bf16_f32 v202, v204, v205
v_cvt_pk_bf16_f32 v203, v206, v207
v_mfma_f32_16x16x32_bf16 v[136:139], a[140:143], v[92:95], v[36:39]
buffer_load_dwordx4 v13, s[12:15], s49 offen offset:0 nt lds
v_mfma_f32_16x16x32_bf16 v[136:139], a[136:139], v[88:91], v[136:139]
v_cvt_pk_bf16_f32 v208, v208, v209
v_cvt_pk_bf16_f32 v209, v210, v211
v_mfma_f32_16x16x32_bf16 v[136:139], a[132:135], v[84:87], v[136:139]
v_exp_f32 v242, v242
v_mfma_f32_16x16x32_bf16 v[136:139], a[128:131], v[80:83], v[136:139]
v_max3_f32 v19, v128, v129, v130
v_max_f32 v19, v131, v19
v_mfma_f32_16x16x32_bf16 v[144:147], a[128:131], v[96:99], v[40:43]
v_exp_f32 v243, v243
v_mfma_f32_16x16x32_bf16 v[144:147], a[132:135], v[100:103], v[144:147]
v_cvt_pk_bf16_f32 v210, v212, v213
v_cvt_pk_bf16_f32 v211, v214, v215
v_mfma_f32_16x16x32_bf16 v[144:147], a[136:139], v[104:107], v[144:147]
v_max3_f32 v20, v136, v137, v138
v_max_f32 v20, v139, v20
v_mfma_f32_16x16x32_bf16 v[144:147], a[140:143], v[108:111], v[144:147]
v_exp_f32 v244, v244
v_mfma_f32_16x16x32_bf16 v[152:155], a[140:143], v[124:127], v[44:47]
v_cvt_pk_bf16_f32 v240, v240, v241
v_cvt_pk_bf16_f32 v241, v242, v243
v_mfma_f32_16x16x32_bf16 v[152:155], a[136:139], v[120:123], v[152:155]
v_exp_f32 v245, v245
v_mfma_f32_16x16x32_bf16 v[152:155], a[132:135], v[116:119], v[152:155]
v_max3_f32 v19, v144, v145, v19
v_max3_f32 v19, v146, v147, v19
v_mfma_f32_16x16x32_bf16 v[152:155], a[128:131], v[112:115], v[152:155]
s_waitcnt lgkmcnt(8)
ds_read_b64_tr_b16 a[128:129], v5 offset:49152
ds_read_b64_tr_b16 a[130:131], v5 offset:53248
v_mfma_f32_16x16x32_bf16 v[132:135], a[144:147], v[64:67], v[32:35]
v_exp_f32 v246, v246
v_mfma_f32_16x16x32_bf16 v[132:135], a[148:151], v[68:71], v[132:135]
ds_read_b64_tr_b16 a[132:133], v5 offset:57344
ds_read_b64_tr_b16 a[134:135], v5 offset:61440
v_mfma_f32_16x16x32_bf16 v[132:135], a[152:155], v[72:75], v[132:135]
buffer_load_dwordx4 v16, s[12:15], s49 offen offset:3072 nt lds
v_mfma_f32_16x16x32_bf16 v[132:135], a[156:159], v[76:79], v[132:135]
v_exp_f32 v247, v247
v_mfma_f32_16x16x32_bf16 v[140:143], a[156:159], v[92:95], v[36:39]
v_max3_f32 v20, v152, v153, v20
v_max3_f32 v20, v154, v155, v20
v_mfma_f32_16x16x32_bf16 v[140:143], a[152:155], v[88:91], v[140:143]
ds_read_b64_tr_b16 a[136:137], v6 offset:49152
ds_read_b64_tr_b16 a[138:139], v6 offset:53248
v_mfma_f32_16x16x32_bf16 v[140:143], a[148:151], v[84:87], v[140:143]
v_exp_f32 v248, v248
v_mfma_f32_16x16x32_bf16 v[140:143], a[144:147], v[80:83], v[140:143]
v_max3_f32 v19, v132, v133, v19
v_max3_f32 v19, v134, v135, v19
v_mfma_f32_16x16x32_bf16 v[148:151], a[144:147], v[96:99], v[40:43]
v_exp_f32 v249, v249
v_mfma_f32_16x16x32_bf16 v[148:151], a[148:151], v[100:103], v[148:151]
ds_read_b64_tr_b16 a[140:141], v6 offset:57344
ds_read_b64_tr_b16 a[142:143], v6 offset:61440
v_mfma_f32_16x16x32_bf16 v[148:151], a[152:155], v[104:107], v[148:151]
v_max3_f32 v20, v140, v141, v20
v_max3_f32 v20, v142, v143, v20
v_mfma_f32_16x16x32_bf16 v[148:151], a[156:159], v[108:111], v[148:151]
v_exp_f32 v250, v250
v_mfma_f32_16x16x32_bf16 v[156:159], a[156:159], v[124:127], v[44:47]
v_cvt_pk_bf16_f32 v242, v244, v245
v_cvt_pk_bf16_f32 v243, v246, v247
v_mfma_f32_16x16x32_bf16 v[156:159], a[152:155], v[120:123], v[156:159]
v_exp_f32 v251, v251
v_mfma_f32_16x16x32_bf16 v[156:159], a[148:151], v[116:119], v[156:159]
v_max3_f32 v19, v148, v149, v19
v_max3_f32 v19, v150, v151, v19
v_mfma_f32_16x16x32_bf16 v[156:159], a[144:147], v[112:115], v[156:159]
s_waitcnt lgkmcnt(12)
ds_read_b64_tr_b16 a[144:145], v7 offset:49152
ds_read_b64_tr_b16 a[146:147], v7 offset:53248
v_mfma_f32_16x16x32_bf16 v[160:163], a[160:163], v[64:67], v[32:35]
buffer_load_dwordx4 v14, s[12:15], s49 offen offset:1024 nt lds
v_mfma_f32_16x16x32_bf16 v[160:163], a[164:167], v[68:71], v[160:163]
v_exp_f32 v252, v252
v_mfma_f32_16x16x32_bf16 v[160:163], a[168:171], v[72:75], v[160:163]
v_max3_f32 v20, v156, v157, v20
v_max3_f32 v20, v158, v159, v20
v_mfma_f32_16x16x32_bf16 v[160:163], a[172:175], v[76:79], v[160:163]
v_exp_f32 v253, v253
v_mfma_f32_16x16x32_bf16 v[168:171], a[172:175], v[92:95], v[36:39]
ds_read_b64_tr_b16 a[148:149], v7 offset:57344
ds_read_b64_tr_b16 a[150:151], v7 offset:61440
v_mfma_f32_16x16x32_bf16 v[168:171], a[168:171], v[88:91], v[168:171]
ds_read_b64_tr_b16 a[152:153], v8 offset:49152
ds_read_b64_tr_b16 a[154:155], v8 offset:53248
v_mfma_f32_16x16x32_bf16 v[168:171], a[164:167], v[84:87], v[168:171]
v_exp_f32 v254, v254
v_mfma_f32_16x16x32_bf16 v[168:171], a[160:163], v[80:83], v[168:171]
v_max3_f32 v19, v160, v161, v19
v_max3_f32 v19, v162, v163, v19
v_mfma_f32_16x16x32_bf16 v[176:179], a[160:163], v[96:99], v[40:43]
v_exp_f32 v255, v255
v_mfma_f32_16x16x32_bf16 v[176:179], a[164:167], v[100:103], v[176:179]
ds_read_b64_tr_b16 a[156:157], v8 offset:57344
v_cvt_pk_bf16_f32 v248, v248, v249
v_mfma_f32_16x16x32_bf16 v[176:179], a[168:171], v[104:107], v[176:179]
v_max3_f32 v20, v168, v169, v20
v_max3_f32 v20, v170, v171, v20
v_mfma_f32_16x16x32_bf16 v[176:179], a[172:175], v[108:111], v[176:179]
v_exp_f32 v216, v216
v_mfma_f32_16x16x32_bf16 v[184:187], a[172:175], v[124:127], v[44:47]
ds_read_b64_tr_b16 a[158:159], v8 offset:61440
v_cvt_pk_bf16_f32 v249, v250, v251
v_mfma_f32_16x16x32_bf16 v[184:187], a[168:171], v[120:123], v[184:187]
v_exp_f32 v217, v217
v_mfma_f32_16x16x32_bf16 v[184:187], a[164:167], v[116:119], v[184:187]
buffer_load_dwordx4 v15, s[12:15], s49 offen offset:2048 nt lds
v_mfma_f32_16x16x32_bf16 v[184:187], a[160:163], v[112:115], v[184:187]
s_waitcnt lgkmcnt(15)
v_max3_f32 v19, v176, v177, v19
v_max3_f32 v19, v178, v179, v19
v_mfma_f32_16x16x32_bf16 v[164:167], a[176:179], v[64:67], v[32:35]
ds_read_b64_tr_b16 a[160:161], v9 offset:49152
v_cvt_pk_bf16_f32 v250, v252, v253
v_mfma_f32_16x16x32_bf16 v[164:167], a[180:183], v[68:71], v[164:167]
v_exp_f32 v218, v218
v_mfma_f32_16x16x32_bf16 v[164:167], a[184:187], v[72:75], v[164:167]
v_max3_f32 v20, v184, v185, v20
v_max3_f32 v20, v186, v187, v20
v_mfma_f32_16x16x32_bf16 v[164:167], a[188:191], v[76:79], v[164:167]
v_exp_f32 v219, v219
v_mfma_f32_16x16x32_bf16 v[172:175], a[188:191], v[92:95], v[36:39]
ds_read_b64_tr_b16 a[162:163], v9 offset:53248
v_cvt_pk_bf16_f32 v251, v254, v255
v_mfma_f32_16x16x32_bf16 v[172:175], a[184:187], v[88:91], v[172:175]
ds_read_b64_tr_b16 a[164:165], v9 offset:57344
v_cvt_pk_bf16_f32 v216, v216, v217
v_mfma_f32_16x16x32_bf16 v[172:175], a[180:183], v[84:87], v[172:175]
v_exp_f32 v220, v220
v_mfma_f32_16x16x32_bf16 v[172:175], a[176:179], v[80:83], v[172:175]
v_max3_f32 v19, v164, v165, v19
v_max3_f32 v19, v166, v167, v19
v_mfma_f32_16x16x32_bf16 v[180:183], a[176:179], v[96:99], v[40:43]
v_exp_f32 v221, v221
v_mfma_f32_16x16x32_bf16 v[180:183], a[180:183], v[100:103], v[180:183]
ds_read_b64_tr_b16 a[166:167], v9 offset:61440
v_cvt_pk_bf16_f32 v217, v218, v219
v_mfma_f32_16x16x32_bf16 v[180:183], a[184:187], v[104:107], v[180:183]
v_max3_f32 v20, v172, v173, v20
v_max3_f32 v20, v174, v175, v20
v_mfma_f32_16x16x32_bf16 v[180:183], a[188:191], v[108:111], v[180:183]
v_exp_f32 v222, v222
v_mfma_f32_16x16x32_bf16 v[188:191], a[188:191], v[124:127], v[44:47]
v_cvt_pk_bf16_f32 v218, v220, v221
v_mfma_f32_16x16x32_bf16 v[188:191], a[184:187], v[120:123], v[188:191]
v_exp_f32 v223, v223
v_mfma_f32_16x16x32_bf16 v[188:191], a[180:183], v[116:119], v[188:191]
v_max3_f32 v19, v180, v181, v19
v_max3_f32 v19, v182, v183, v19
v_mfma_f32_16x16x32_bf16 v[188:191], a[176:179], v[112:115], v[188:191]
s_waitcnt lgkmcnt(15)
v_cvt_pk_bf16_f32 v219, v222, v223
v_mfma_f32_16x16x32_bf16 a[0:3], a[128:131], v[192:195], a[0:3]
v_mfma_f32_16x16x32_bf16 a[0:3], a[132:135], v[224:227], a[0:3]
v_mfma_f32_16x16x32_bf16 a[32:35], a[132:135], v[232:235], a[32:35]
v_max3_f32 v20, v188, v189, v20
v_max3_f32 v20, v190, v191, v20
v_mfma_f32_16x16x32_bf16 a[32:35], a[128:131], v[200:203], a[32:35]
v_max_f32 v19, v19, v20
v_cmp_lt_f32 vcc, s46, v19
v_mfma_f32_16x16x32_bf16 a[64:67], a[128:131], v[208:211], a[64:67]
v_mfma_f32_16x16x32_bf16 a[64:67], a[132:135], v[240:243], a[64:67]
s_cbranch_vccnz L_r3a
L_r3a_back:
v_exp_f32 v128, v128
v_mfma_f32_16x16x32_bf16 a[96:99], a[132:135], v[248:251], a[96:99]
s_add_u32 m0, s27, 81920
v_exp_f32 v129, v129
v_mfma_f32_16x16x32_bf16 a[96:99], a[128:131], v[216:219], a[96:99]
s_waitcnt lgkmcnt(12)
ds_read_b64_tr_b16 a[168:169], v10 offset:49152
ds_read_b64_tr_b16 a[170:171], v10 offset:53248
v_mfma_f32_16x16x32_bf16 a[4:7], a[136:139], v[192:195], a[4:7]
buffer_load_dwordx4 v17, s[16:19], s44 offen offset:0 nt lds
v_mfma_f32_16x16x32_bf16 a[4:7], a[140:143], v[224:227], a[4:7]
v_exp_f32 v130, v130
v_mfma_f32_16x16x32_bf16 a[36:39], a[140:143], v[232:235], a[36:39]
v_exp_f32 v131, v131
v_mfma_f32_16x16x32_bf16 a[36:39], a[136:139], v[200:203], a[36:39]
ds_read_b64_tr_b16 a[172:173], v10 offset:57344
ds_read_b64_tr_b16 a[174:175], v10 offset:61440
v_mfma_f32_16x16x32_bf16 a[68:71], a[136:139], v[208:211], a[68:71]
v_exp_f32 v132, v132
v_mfma_f32_16x16x32_bf16 a[68:71], a[140:143], v[240:243], a[68:71]
v_exp_f32 v133, v133
v_mfma_f32_16x16x32_bf16 a[100:103], a[140:143], v[248:251], a[100:103]
ds_read_b64_tr_b16 a[176:177], v11 offset:49152
ds_read_b64_tr_b16 a[178:179], v11 offset:53248
v_mfma_f32_16x16x32_bf16 a[100:103], a[136:139], v[216:219], a[100:103]
s_waitcnt lgkmcnt(14)
v_exp_f32 v134, v134
v_mfma_f32_16x16x32_bf16 a[8:11], a[144:147], v[192:195], a[8:11]
v_exp_f32 v135, v135
v_mfma_f32_16x16x32_bf16 a[8:11], a[148:151], v[224:227], a[8:11]
ds_read_b64_tr_b16 a[180:181], v11 offset:57344
ds_read_b64_tr_b16 a[182:183], v11 offset:61440
v_mfma_f32_16x16x32_bf16 a[40:43], a[148:151], v[232:235], a[40:43]
v_exp_f32 v160, v160
v_mfma_f32_16x16x32_bf16 a[40:43], a[144:147], v[200:203], a[40:43]
v_exp_f32 v161, v161
v_mfma_f32_16x16x32_bf16 a[72:75], a[144:147], v[208:211], a[72:75]
ds_read_b64_tr_b16 a[184:185], v12 offset:49152
ds_read_b64_tr_b16 a[186:187], v12 offset:53248
v_mfma_f32_16x16x32_bf16 a[72:75], a[148:151], v[240:243], a[72:75]
v_exp_f32 v162, v162
v_mfma_f32_16x16x32_bf16 a[104:107], a[148:151], v[248:251], a[104:107]
s_add_u32 s92, s44, 129024
buffer_load_dwordx4 v18, s[16:19], s92 offen offset:3072 nt lds
v_mfma_f32_16x16x32_bf16 a[104:107], a[144:147], v[216:219], a[104:107]
s_waitcnt lgkmcnt(14)
ds_read_b64_tr_b16 a[188:189], v12 offset:57344
ds_read_b64_tr_b16 a[190:191], v12 offset:61440
v_mfma_f32_16x16x32_bf16 a[12:15], a[152:155], v[192:195], a[12:15]
v_exp_f32 v163, v163
v_mfma_f32_16x16x32_bf16 a[12:15], a[156:159], v[224:227], a[12:15]
v_exp_f32 v164, v164
v_mfma_f32_16x16x32_bf16 a[44:47], a[156:159], v[232:235], a[44:47]
v_cvt_pk_bf16_f32 v128, v128, v129
v_cvt_pk_bf16_f32 v129, v130, v131
v_mfma_f32_16x16x32_bf16 a[44:47], a[152:155], v[200:203], a[44:47]
v_exp_f32 v165, v165
v_mfma_f32_16x16x32_bf16 a[76:79], a[152:155], v[208:211], a[76:79]
v_exp_f32 v166, v166
v_mfma_f32_16x16x32_bf16 a[76:79], a[156:159], v[240:243], a[76:79]
v_cvt_pk_bf16_f32 v130, v132, v133
v_cvt_pk_bf16_f32 v131, v134, v135
v_mfma_f32_16x16x32_bf16 a[108:111], a[156:159], v[248:251], a[108:111]
v_exp_f32 v167, v167
v_mfma_f32_16x16x32_bf16 a[108:111], a[152:155], v[216:219], a[108:111]
s_waitcnt lgkmcnt(12)
v_exp_f32 v168, v168
v_mfma_f32_16x16x32_bf16 a[16:19], a[160:163], v[192:195], a[16:19]
v_cvt_pk_bf16_f32 v160, v160, v161
v_cvt_pk_bf16_f32 v161, v162, v163
v_mfma_f32_16x16x32_bf16 a[16:19], a[164:167], v[224:227], a[16:19]
v_exp_f32 v169, v169
v_mfma_f32_16x16x32_bf16 a[48:51], a[164:167], v[232:235], a[48:51]
v_exp_f32 v170, v170
v_mfma_f32_16x16x32_bf16 a[48:51], a[160:163], v[200:203], a[48:51]
v_cvt_pk_bf16_f32 v162, v164, v165
v_cvt_pk_bf16_f32 v163, v166, v167
v_mfma_f32_16x16x32_bf16 a[80:83], a[160:163], v[208:211], a[80:83]
buffer_load_dwordx4 v18, s[16:19], s44 offen offset:1024 nt lds
v_mfma_f32_16x16x32_bf16 a[80:83], a[164:167], v[240:243], a[80:83]
v_exp_f32 v171, v171
v_mfma_f32_16x16x32_bf16 a[112:115], a[164:167], v[248:251], a[112:115]
v_cvt_pk_bf16_f32 v168, v168, v169
v_cvt_pk_bf16_f32 v169, v170, v171
v_mfma_f32_16x16x32_bf16 a[112:115], a[160:163], v[216:219], a[112:115]
s_waitcnt lgkmcnt(8)
v_exp_f32 v172, v172
v_mfma_f32_16x16x32_bf16 a[20:23], a[168:171], v[192:195], a[20:23]
v_exp_f32 v173, v173
v_mfma_f32_16x16x32_bf16 a[20:23], a[172:175], v[224:227], a[20:23]
v_cvt_pk_bf16_f32 v170, v172, v173
v_mfma_f32_16x16x32_bf16 a[52:55], a[172:175], v[232:235], a[52:55]
v_exp_f32 v174, v174
v_mfma_f32_16x16x32_bf16 a[52:55], a[168:171], v[200:203], a[52:55]
v_exp_f32 v175, v175
v_mfma_f32_16x16x32_bf16 a[84:87], a[168:171], v[208:211], a[84:87]
v_cvt_pk_bf16_f32 v171, v174, v175
v_mfma_f32_16x16x32_bf16 a[84:87], a[172:175], v[240:243], a[84:87]
v_exp_f32 v136, v136
v_mfma_f32_16x16x32_bf16 a[116:119], a[172:175], v[248:251], a[116:119]
v_exp_f32 v137, v137
v_mfma_f32_16x16x32_bf16 a[116:119], a[168:171], v[216:219], a[116:119]
s_waitcnt lgkmcnt(4)
v_cvt_pk_bf16_f32 v136, v136, v137
v_mfma_f32_16x16x32_bf16 a[24:27], a[176:179], v[192:195], a[24:27]
v_exp_f32 v138, v138
v_mfma_f32_16x16x32_bf16 a[24:27], a[180:183], v[224:227], a[24:27]
v_exp_f32 v139, v139
v_mfma_f32_16x16x32_bf16 a[56:59], a[180:183], v[232:235], a[56:59]
buffer_load_dwordx4 v17, s[16:19], s92 offen offset:2048 nt lds
v_mfma_f32_16x16x32_bf16 a[56:59], a[176:179], v[200:203], a[56:59]
v_cvt_pk_bf16_f32 v137, v138, v139
v_mfma_f32_16x16x32_bf16 a[88:91], a[176:179], v[208:211], a[88:91]
v_exp_f32 v140, v140
v_mfma_f32_16x16x32_bf16 a[88:91], a[180:183], v[240:243], a[88:91]
s_waitcnt vmcnt(8) lgkmcnt(0)
v_exp_f32 v141, v141
v_mfma_f32_16x16x32_bf16 a[120:123], a[180:183], v[248:251], a[120:123]
s_barrier
v_mfma_f32_16x16x32_bf16 a[120:123], a[176:179], v[216:219], a[120:123]
ds_read_b128 a[128:131], v1 offset:16384
ds_read_b128 a[132:135], v2 offset:16384
v_mfma_f32_16x16x32_bf16 a[28:31], a[184:187], v[192:195], a[28:31]
s_mov_b32 s44, s49
v_exp_f32 v142, v142
v_mfma_f32_16x16x32_bf16 a[28:31], a[188:191], v[224:227], a[28:31]
s_or_b32 s49, s49, 0xffff87ff
ds_read_b128 a[136:139], v3 offset:16384
ds_read_b128 a[140:143], v4 offset:16384
v_mfma_f32_16x16x32_bf16 a[60:63], a[188:191], v[232:235], a[60:63]
s_add_u32 s49, s49, 1
v_exp_f32 v143, v143
v_mfma_f32_16x16x32_bf16 a[60:63], a[184:187], v[200:203], a[60:63]
s_and_b32 s49, s49, 0x7800
v_exp_f32 v144, v144
v_mfma_f32_16x16x32_bf16 a[92:95], a[184:187], v[208:211], a[92:95]
ds_read_b128 a[144:147], v1 offset:20480
ds_read_b128 a[148:151], v2 offset:20480
v_mfma_f32_16x16x32_bf16 a[92:95], a[188:191], v[240:243], a[92:95]
v_exp_f32 v145, v145
v_mfma_f32_16x16x32_bf16 a[124:127], a[188:191], v[248:251], a[124:127]
v_exp_f32 v146, v146
v_mfma_f32_16x16x32_bf16 a[124:127], a[184:187], v[216:219], a[124:127]
ds_read_b128 a[152:155], v3 offset:20480
ds_read_b128 a[156:159], v4 offset:20480
v_mfma_f32_16x16x32_bf16 v[48:51], v[28:31], v[192:195], v[48:51]
v_exp_f32 v147, v147
v_mfma_f32_16x16x32_bf16 v[48:51], v[28:31], v[224:227], v[48:51]
v_exp_f32 v148, v148
v_mfma_f32_16x16x32_bf16 v[52:55], v[28:31], v[200:203], v[52:55]
ds_read_b128 a[160:163], v1 offset:24576
ds_read_b128 a[164:167], v2 offset:24576
v_mfma_f32_16x16x32_bf16 v[52:55], v[28:31], v[232:235], v[52:55]
v_exp_f32 v149, v149
v_mfma_f32_16x16x32_bf16 v[56:59], v[28:31], v[208:211], v[56:59]
s_add_u32 s45, s45, 1
v_exp_f32 v150, v150
v_mfma_f32_16x16x32_bf16 v[56:59], v[28:31], v[240:243], v[56:59]
s_cmp_lt_u32 s45, 3
ds_read_b128 a[168:171], v3 offset:24576
ds_read_b128 a[172:175], v4 offset:24576
v_mfma_f32_16x16x32_bf16 v[60:63], v[28:31], v[216:219], v[60:63]
s_waitcnt lgkmcnt(8)
v_exp_f32 v151, v151
v_mfma_f32_16x16x32_bf16 v[60:63], v[28:31], v[248:251], v[60:63]
s_cbranch_vccnz L_r3b
L_r3b_back:
ds_read_b128 a[176:179], v1 offset:28672
ds_read_b128 a[180:183], v2 offset:28672
s_cbranch_scc1 L_loop
s_mov_b32 s52, 0xe00fe000
v_cmp_ne_u32 vcc, s52, v22
s_cbranch_vccnz L_cw
L_cw_back:
v_mfma_f32_16x16x32_bf16 v[192:195], a[128:131], v[64:67], v[32:35]
s_add_u32 s4, s70, s64
s_addc_u32 s5, s71, 0
v_exp_f32 v176, v176
v_mfma_f32_16x16x32_bf16 v[192:195], a[132:135], v[68:71], v[192:195]
s_and_b32 s5, s5, 0xffff
ds_read_b128 a[184:187], v3 offset:28672
ds_read_b128 a[188:191], v4 offset:28672
v_mfma_f32_16x16x32_bf16 v[192:195], a[136:139], v[72:75], v[192:195]
s_mov_b32 s6, 77824
v_exp_f32 v177, v177
v_mfma_f32_16x16x32_bf16 v[192:195], a[140:143], v[76:79], v[192:195]
s_add_u32 m0, s27, 49152
v_cvt_pk_bf16_f32 v138, v140, v141
v_cvt_pk_bf16_f32 v139, v142, v143
v_mfma_f32_16x16x32_bf16 v[200:203], a[140:143], v[92:95], v[36:39]
buffer_load_dwordx4 v13, s[12:15], s49 offen offset:0 nt lds
v_mfma_f32_16x16x32_bf16 v[200:203], a[136:139], v[88:91], v[200:203]
s_mov_b32 s7, 0x20000
v_cvt_pk_bf16_f32 v144, v144, v145
v_cvt_pk_bf16_f32 v145, v146, v147
v_mfma_f32_16x16x32_bf16 v[200:203], a[132:135], v[84:87], v[200:203]
s_add_u32 s8, s70, s65
s_addc_u32 s9, s71, 0
v_exp_f32 v178, v178
v_mfma_f32_16x16x32_bf16 v[200:203], a[128:131], v[80:83], v[200:203]
s_and_b32 s9, s9, 0xffff
v_max3_f32 v19, v192, v193, v194
v_max_f32 v19, v195, v19
v_mfma_f32_16x16x32_bf16 v[208:211], a[128:131], v[96:99], v[40:43]
s_mov_b32 s10, 851968
v_exp_f32 v179, v179
v_mfma_f32_16x16x32_bf16 v[208:211], a[132:135], v[100:103], v[208:211]
s_mov_b32 s11, 0x20000
v_cvt_pk_bf16_f32 v146, v148, v149
v_cvt_pk_bf16_f32 v147, v150, v151
v_mfma_f32_16x16x32_bf16 v[208:211], a[136:139], v[104:107], v[208:211]
s_add_u32 s80, s70, s3
s_addc_u32 s81, s71, 0
v_max3_f32 v20, v200, v201, v202
v_max_f32 v20, v203, v20
v_mfma_f32_16x16x32_bf16 v[208:211], a[140:143], v[108:111], v[208:211]
s_and_b32 s81, s81, 0xffff
v_exp_f32 v180, v180
v_mfma_f32_16x16x32_bf16 v[216:219], a[140:143], v[124:127], v[44:47]
s_mov_b32 s82, 1589248
v_cvt_pk_bf16_f32 v176, v176, v177
v_cvt_pk_bf16_f32 v177, v178, v179
v_mfma_f32_16x16x32_bf16 v[216:219], a[136:139], v[120:123], v[216:219]
s_mov_b32 s83, 0x20000
v_exp_f32 v181, v181
v_mfma_f32_16x16x32_bf16 v[216:219], a[132:135], v[116:119], v[216:219]
s_add_u32 s76, s70, s31
s_addc_u32 s77, s71, 0
v_max3_f32 v19, v208, v209, v19
v_max3_f32 v19, v210, v211, v19
v_mfma_f32_16x16x32_bf16 v[216:219], a[128:131], v[112:115], v[216:219]
s_waitcnt lgkmcnt(8)
ds_read_b64_tr_b16 a[128:129], v5 offset:0
ds_read_b64_tr_b16 a[130:131], v5 offset:4096
v_mfma_f32_16x16x32_bf16 v[196:199], a[144:147], v[64:67], v[32:35]
s_and_b32 s77, s77, 0xffff
v_exp_f32 v182, v182
v_mfma_f32_16x16x32_bf16 v[196:199], a[148:151], v[68:71], v[196:199]
ds_read_b64_tr_b16 a[132:133], v5 offset:8192
ds_read_b64_tr_b16 a[134:135], v5 offset:12288
v_mfma_f32_16x16x32_bf16 v[196:199], a[152:155], v[72:75], v[196:199]
buffer_load_dwordx4 v16, s[12:15], s49 offen offset:3072 nt lds
v_mfma_f32_16x16x32_bf16 v[196:199], a[156:159], v[76:79], v[196:199]
s_mov_b32 s78, 4
v_exp_f32 v183, v183
v_mfma_f32_16x16x32_bf16 v[204:207], a[156:159], v[92:95], v[36:39]
s_mov_b32 s79, 0x20000
v_max3_f32 v20, v216, v217, v20
v_max3_f32 v20, v218, v219, v20
v_mfma_f32_16x16x32_bf16 v[204:207], a[152:155], v[88:91], v[204:207]
s_add_u32 s84, s70, s98
s_addc_u32 s85, s71, 0
ds_read_b64_tr_b16 a[136:137], v6 offset:0
ds_read_b64_tr_b16 a[138:139], v6 offset:4096
v_mfma_f32_16x16x32_bf16 v[204:207], a[148:151], v[84:87], v[204:207]
s_and_b32 s85, s85, 0xffff
v_exp_f32 v184, v184
v_mfma_f32_16x16x32_bf16 v[204:207], a[144:147], v[80:83], v[204:207]
s_mov_b32 s86, 65536
v_max3_f32 v19, v196, v197, v19
v_max3_f32 v19, v198, v199, v19
v_mfma_f32_16x16x32_bf16 v[212:215], a[144:147], v[96:99], v[40:43]
s_mov_b32 s87, 0x20000
v_exp_f32 v185, v185
v_mfma_f32_16x16x32_bf16 v[212:215], a[148:151], v[100:103], v[212:215]
ds_read_b64_tr_b16 a[140:141], v6 offset:8192
ds_read_b64_tr_b16 a[142:143], v6 offset:12288
v_mfma_f32_16x16x32_bf16 v[212:215], a[152:155], v[104:107], v[212:215]
v_max3_f32 v20, v204, v205, v20
v_max3_f32 v20, v206, v207, v20
v_mfma_f32_16x16x32_bf16 v[212:215], a[156:159], v[108:111], v[212:215]
v_exp_f32 v186, v186
v_mfma_f32_16x16x32_bf16 v[220:223], a[156:159], v[124:127], v[44:47]
v_cvt_pk_bf16_f32 v178, v180, v181
v_cvt_pk_bf16_f32 v179, v182, v183
v_mfma_f32_16x16x32_bf16 v[220:223], a[152:155], v[120:123], v[220:223]
v_exp_f32 v187, v187
v_mfma_f32_16x16x32_bf16 v[220:223], a[148:151], v[116:119], v[220:223]
v_max3_f32 v19, v212, v213, v19
v_max3_f32 v19, v214, v215, v19
v_mfma_f32_16x16x32_bf16 v[220:223], a[144:147], v[112:115], v[220:223]
s_waitcnt lgkmcnt(12)
ds_read_b64_tr_b16 a[144:145], v7 offset:0
ds_read_b64_tr_b16 a[146:147], v7 offset:4096
v_mfma_f32_16x16x32_bf16 v[224:227], a[160:163], v[64:67], v[32:35]
buffer_load_dwordx4 v14, s[12:15], s49 offen offset:1024 nt lds
v_mfma_f32_16x16x32_bf16 v[224:227], a[164:167], v[68:71], v[224:227]
v_exp_f32 v188, v188
v_mfma_f32_16x16x32_bf16 v[224:227], a[168:171], v[72:75], v[224:227]
v_max3_f32 v20, v220, v221, v20
v_max3_f32 v20, v222, v223, v20
v_mfma_f32_16x16x32_bf16 v[224:227], a[172:175], v[76:79], v[224:227]
v_exp_f32 v189, v189
v_mfma_f32_16x16x32_bf16 v[232:235], a[172:175], v[92:95], v[36:39]
ds_read_b64_tr_b16 a[148:149], v7 offset:8192
ds_read_b64_tr_b16 a[150:151], v7 offset:12288
v_mfma_f32_16x16x32_bf16 v[232:235], a[168:171], v[88:91], v[232:235]
ds_read_b64_tr_b16 a[152:153], v8 offset:0
ds_read_b64_tr_b16 a[154:155], v8 offset:4096
v_mfma_f32_16x16x32_bf16 v[232:235], a[164:167], v[84:87], v[232:235]
v_exp_f32 v190, v190
v_mfma_f32_16x16x32_bf16 v[232:235], a[160:163], v[80:83], v[232:235]
v_max3_f32 v19, v224, v225, v19
v_max3_f32 v19, v226, v227, v19
v_mfma_f32_16x16x32_bf16 v[240:243], a[160:163], v[96:99], v[40:43]
v_exp_f32 v191, v191
v_mfma_f32_16x16x32_bf16 v[240:243], a[164:167], v[100:103], v[240:243]
ds_read_b64_tr_b16 a[156:157], v8 offset:8192
v_cvt_pk_bf16_f32 v184, v184, v185
v_mfma_f32_16x16x32_bf16 v[240:243], a[168:171], v[104:107], v[240:243]
v_max3_f32 v20, v232, v233, v20
v_max3_f32 v20, v234, v235, v20
v_mfma_f32_16x16x32_bf16 v[240:243], a[172:175], v[108:111], v[240:243]
v_exp_f32 v152, v152
v_mfma_f32_16x16x32_bf16 v[248:251], a[172:175], v[124:127], v[44:47]
ds_read_b64_tr_b16 a[158:159], v8 offset:12288
v_cvt_pk_bf16_f32 v185, v186, v187
v_mfma_f32_16x16x32_bf16 v[248:251], a[168:171], v[120:123], v[248:251]
v_exp_f32 v153, v153
v_mfma_f32_16x16x32_bf16 v[248:251], a[164:167], v[116:119], v[248:251]
buffer_load_dwordx4 v15, s[12:15], s49 offen offset:2048 nt lds
v_mfma_f32_16x16x32_bf16 v[248:251], a[160:163], v[112:115], v[248:251]
s_waitcnt lgkmcnt(15)
v_max3_f32 v19, v240, v241, v19
v_max3_f32 v19, v242, v243, v19
v_mfma_f32_16x16x32_bf16 v[228:231], a[176:179], v[64:67], v[32:35]
ds_read_b64_tr_b16 a[160:161], v9 offset:0
v_cvt_pk_bf16_f32 v186, v188, v189
v_mfma_f32_16x16x32_bf16 v[228:231], a[180:183], v[68:71], v[228:231]
v_exp_f32 v154, v154
v_mfma_f32_16x16x32_bf16 v[228:231], a[184:187], v[72:75], v[228:231]
v_max3_f32 v20, v248, v249, v20
v_max3_f32 v20, v250, v251, v20
v_mfma_f32_16x16x32_bf16 v[228:231], a[188:191], v[76:79], v[228:231]
v_exp_f32 v155, v155
v_mfma_f32_16x16x32_bf16 v[236:239], a[188:191], v[92:95], v[36:39]
ds_read_b64_tr_b16 a[162:163], v9 offset:4096
v_cvt_pk_bf16_f32 v187, v190, v191
v_mfma_f32_16x16x32_bf16 v[236:239], a[184:187], v[88:91], v[236:239]
ds_read_b64_tr_b16 a[164:165], v9 offset:8192
v_cvt_pk_bf16_f32 v152, v152, v153
v_mfma_f32_16x16x32_bf16 v[236:239], a[180:183], v[84:87], v[236:239]
v_exp_f32 v156, v156
v_mfma_f32_16x16x32_bf16 v[236:239], a[176:179], v[80:83], v[236:239]
v_max3_f32 v19, v228, v229, v19
v_max3_f32 v19, v230, v231, v19
v_mfma_f32_16x16x32_bf16 v[244:247], a[176:179], v[96:99], v[40:43]
v_exp_f32 v157, v157
v_mfma_f32_16x16x32_bf16 v[244:247], a[180:183], v[100:103], v[244:247]
ds_read_b64_tr_b16 a[166:167], v9 offset:12288
v_cvt_pk_bf16_f32 v153, v154, v155
v_mfma_f32_16x16x32_bf16 v[244:247], a[184:187], v[104:107], v[244:247]
v_max3_f32 v20, v236, v237, v20
v_max3_f32 v20, v238, v239, v20
v_mfma_f32_16x16x32_bf16 v[244:247], a[188:191], v[108:111], v[244:247]
v_exp_f32 v158, v158
v_mfma_f32_16x16x32_bf16 v[252:255], a[188:191], v[124:127], v[44:47]
v_cvt_pk_bf16_f32 v154, v156, v157
v_mfma_f32_16x16x32_bf16 v[252:255], a[184:187], v[120:123], v[252:255]
v_exp_f32 v159, v159
v_mfma_f32_16x16x32_bf16 v[252:255], a[180:183], v[116:119], v[252:255]
v_max3_f32 v19, v244, v245, v19
v_max3_f32 v19, v246, v247, v19
v_mfma_f32_16x16x32_bf16 v[252:255], a[176:179], v[112:115], v[252:255]
s_waitcnt lgkmcnt(15)
v_cvt_pk_bf16_f32 v155, v158, v159
v_mfma_f32_16x16x32_bf16 a[0:3], a[128:131], v[128:131], a[0:3]
v_mfma_f32_16x16x32_bf16 a[0:3], a[132:135], v[160:163], a[0:3]
v_mfma_f32_16x16x32_bf16 a[32:35], a[132:135], v[168:171], a[32:35]
v_max3_f32 v20, v252, v253, v20
v_max3_f32 v20, v254, v255, v20
v_mfma_f32_16x16x32_bf16 a[32:35], a[128:131], v[136:139], a[32:35]
v_max_f32 v19, v19, v20
v_cmp_lt_f32 vcc, s46, v19
v_mfma_f32_16x16x32_bf16 a[64:67], a[128:131], v[144:147], a[64:67]
v_mfma_f32_16x16x32_bf16 a[64:67], a[132:135], v[176:179], a[64:67]
s_cbranch_vccnz L_r12a
L_r12a_back:
v_exp_f32 v192, v192
v_mfma_f32_16x16x32_bf16 a[96:99], a[132:135], v[184:187], a[96:99]
s_add_u32 m0, s27, 98304
v_exp_f32 v193, v193
v_mfma_f32_16x16x32_bf16 a[96:99], a[128:131], v[152:155], a[96:99]
s_waitcnt lgkmcnt(12)
ds_read_b64_tr_b16 a[168:169], v10 offset:0
ds_read_b64_tr_b16 a[170:171], v10 offset:4096
v_mfma_f32_16x16x32_bf16 a[4:7], a[136:139], v[128:131], a[4:7]
buffer_load_dwordx4 v17, s[16:19], s44 offen offset:0 nt lds
v_mfma_f32_16x16x32_bf16 a[4:7], a[140:143], v[160:163], a[4:7]
v_exp_f32 v194, v194
v_mfma_f32_16x16x32_bf16 a[36:39], a[140:143], v[168:171], a[36:39]
v_exp_f32 v195, v195
v_mfma_f32_16x16x32_bf16 a[36:39], a[136:139], v[136:139], a[36:39]
ds_read_b64_tr_b16 a[172:173], v10 offset:8192
ds_read_b64_tr_b16 a[174:175], v10 offset:12288
v_mfma_f32_16x16x32_bf16 a[68:71], a[136:139], v[144:147], a[68:71]
v_exp_f32 v196, v196
v_mfma_f32_16x16x32_bf16 a[68:71], a[140:143], v[176:179], a[68:71]
v_exp_f32 v197, v197
v_mfma_f32_16x16x32_bf16 a[100:103], a[140:143], v[184:187], a[100:103]
ds_read_b64_tr_b16 a[176:177], v11 offset:0
ds_read_b64_tr_b16 a[178:179], v11 offset:4096
v_mfma_f32_16x16x32_bf16 a[100:103], a[136:139], v[152:155], a[100:103]
s_waitcnt lgkmcnt(14)
v_exp_f32 v198, v198
v_mfma_f32_16x16x32_bf16 a[8:11], a[144:147], v[128:131], a[8:11]
v_exp_f32 v199, v199
v_mfma_f32_16x16x32_bf16 a[8:11], a[148:151], v[160:163], a[8:11]
ds_read_b64_tr_b16 a[180:181], v11 offset:8192
ds_read_b64_tr_b16 a[182:183], v11 offset:12288
v_mfma_f32_16x16x32_bf16 a[40:43], a[148:151], v[168:171], a[40:43]
v_exp_f32 v224, v224
v_mfma_f32_16x16x32_bf16 a[40:43], a[144:147], v[136:139], a[40:43]
v_exp_f32 v225, v225
v_mfma_f32_16x16x32_bf16 a[72:75], a[144:147], v[144:147], a[72:75]
ds_read_b64_tr_b16 a[184:185], v12 offset:0
ds_read_b64_tr_b16 a[186:187], v12 offset:4096
v_mfma_f32_16x16x32_bf16 a[72:75], a[148:151], v[176:179], a[72:75]
v_exp_f32 v226, v226
v_mfma_f32_16x16x32_bf16 a[104:107], a[148:151], v[184:187], a[104:107]
s_add_u32 s92, s44, 129024
buffer_load_dwordx4 v18, s[16:19], s92 offen offset:3072 nt lds
v_mfma_f32_16x16x32_bf16 a[104:107], a[144:147], v[152:155], a[104:107]
s_waitcnt lgkmcnt(14)
ds_read_b64_tr_b16 a[188:189], v12 offset:8192
ds_read_b64_tr_b16 a[190:191], v12 offset:12288
v_mfma_f32_16x16x32_bf16 a[12:15], a[152:155], v[128:131], a[12:15]
v_exp_f32 v227, v227
v_mfma_f32_16x16x32_bf16 a[12:15], a[156:159], v[160:163], a[12:15]
v_exp_f32 v228, v228
v_mfma_f32_16x16x32_bf16 a[44:47], a[156:159], v[168:171], a[44:47]
v_cvt_pk_bf16_f32 v192, v192, v193
v_cvt_pk_bf16_f32 v193, v194, v195
v_mfma_f32_16x16x32_bf16 a[44:47], a[152:155], v[136:139], a[44:47]
v_exp_f32 v229, v229
v_mfma_f32_16x16x32_bf16 a[76:79], a[152:155], v[144:147], a[76:79]
v_exp_f32 v230, v230
v_mfma_f32_16x16x32_bf16 a[76:79], a[156:159], v[176:179], a[76:79]
v_cvt_pk_bf16_f32 v194, v196, v197
v_cvt_pk_bf16_f32 v195, v198, v199
v_mfma_f32_16x16x32_bf16 a[108:111], a[156:159], v[184:187], a[108:111]
v_exp_f32 v231, v231
v_mfma_f32_16x16x32_bf16 a[108:111], a[152:155], v[152:155], a[108:111]
s_waitcnt lgkmcnt(12)
v_exp_f32 v232, v232
v_mfma_f32_16x16x32_bf16 a[16:19], a[160:163], v[128:131], a[16:19]
v_cvt_pk_bf16_f32 v224, v224, v225
v_cvt_pk_bf16_f32 v225, v226, v227
v_mfma_f32_16x16x32_bf16 a[16:19], a[164:167], v[160:163], a[16:19]
v_exp_f32 v233, v233
v_mfma_f32_16x16x32_bf16 a[48:51], a[164:167], v[168:171], a[48:51]
v_exp_f32 v234, v234
v_mfma_f32_16x16x32_bf16 a[48:51], a[160:163], v[136:139], a[48:51]
v_cvt_pk_bf16_f32 v226, v228, v229
v_cvt_pk_bf16_f32 v227, v230, v231
v_mfma_f32_16x16x32_bf16 a[80:83], a[160:163], v[144:147], a[80:83]
buffer_load_dwordx4 v18, s[16:19], s44 offen offset:1024 nt lds
v_mfma_f32_16x16x32_bf16 a[80:83], a[164:167], v[176:179], a[80:83]
v_exp_f32 v235, v235
v_mfma_f32_16x16x32_bf16 a[112:115], a[164:167], v[184:187], a[112:115]
v_cvt_pk_bf16_f32 v232, v232, v233
v_cvt_pk_bf16_f32 v233, v234, v235
v_mfma_f32_16x16x32_bf16 a[112:115], a[160:163], v[152:155], a[112:115]
s_waitcnt lgkmcnt(8)
v_exp_f32 v236, v236
v_mfma_f32_16x16x32_bf16 a[20:23], a[168:171], v[128:131], a[20:23]
v_exp_f32 v237, v237
v_mfma_f32_16x16x32_bf16 a[20:23], a[172:175], v[160:163], a[20:23]
v_cvt_pk_bf16_f32 v234, v236, v237
v_mfma_f32_16x16x32_bf16 a[52:55], a[172:175], v[168:171], a[52:55]
v_exp_f32 v238, v238
v_mfma_f32_16x16x32_bf16 a[52:55], a[168:171], v[136:139], a[52:55]
v_exp_f32 v239, v239
v_mfma_f32_16x16x32_bf16 a[84:87], a[168:171], v[144:147], a[84:87]
v_cvt_pk_bf16_f32 v235, v238, v239
v_mfma_f32_16x16x32_bf16 a[84:87], a[172:175], v[176:179], a[84:87]
v_exp_f32 v200, v200
v_mfma_f32_16x16x32_bf16 a[116:119], a[172:175], v[184:187], a[116:119]
v_exp_f32 v201, v201
v_mfma_f32_16x16x32_bf16 a[116:119], a[168:171], v[152:155], a[116:119]
s_waitcnt lgkmcnt(4)
v_cvt_pk_bf16_f32 v200, v200, v201
v_mfma_f32_16x16x32_bf16 a[24:27], a[176:179], v[128:131], a[24:27]
v_exp_f32 v202, v202
v_mfma_f32_16x16x32_bf16 a[24:27], a[180:183], v[160:163], a[24:27]
v_exp_f32 v203, v203
v_mfma_f32_16x16x32_bf16 a[56:59], a[180:183], v[168:171], a[56:59]
buffer_load_dwordx4 v17, s[16:19], s92 offen offset:2048 nt lds
v_mfma_f32_16x16x32_bf16 a[56:59], a[176:179], v[136:139], a[56:59]
v_cvt_pk_bf16_f32 v201, v202, v203
v_mfma_f32_16x16x32_bf16 a[88:91], a[176:179], v[144:147], a[88:91]
v_exp_f32 v204, v204
v_mfma_f32_16x16x32_bf16 a[88:91], a[180:183], v[176:179], a[88:91]
s_waitcnt vmcnt(8) lgkmcnt(0)
v_exp_f32 v205, v205
v_mfma_f32_16x16x32_bf16 a[120:123], a[180:183], v[184:187], a[120:123]
s_barrier
v_mfma_f32_16x16x32_bf16 a[120:123], a[176:179], v[152:155], a[120:123]
ds_read_b128 a[128:131], v1 offset:32768
ds_read_b128 a[132:135], v2 offset:32768
v_mfma_f32_16x16x32_bf16 a[28:31], a[184:187], v[128:131], a[28:31]
s_mov_b32 s44, s49
v_exp_f32 v206, v206
v_mfma_f32_16x16x32_bf16 a[28:31], a[188:191], v[160:163], a[28:31]
s_or_b32 s49, s49, 0xffff87ff
ds_read_b128 a[136:139], v3 offset:32768
ds_read_b128 a[140:143], v4 offset:32768
v_mfma_f32_16x16x32_bf16 a[60:63], a[188:191], v[168:171], a[60:63]
s_add_u32 s49, s49, 1
v_exp_f32 v207, v207
v_mfma_f32_16x16x32_bf16 a[60:63], a[184:187], v[136:139], a[60:63]
s_and_b32 s49, s49, 0x7800
v_exp_f32 v208, v208
v_mfma_f32_16x16x32_bf16 a[92:95], a[184:187], v[144:147], a[92:95]
ds_read_b128 a[144:147], v1 offset:36864
ds_read_b128 a[148:151], v2 offset:36864
v_mfma_f32_16x16x32_bf16 a[92:95], a[188:191], v[176:179], a[92:95]
v_exp_f32 v209, v209
v_mfma_f32_16x16x32_bf16 a[124:127], a[188:191], v[184:187], a[124:127]
v_exp_f32 v210, v210
v_mfma_f32_16x16x32_bf16 a[124:127], a[184:187], v[152:155], a[124:127]
ds_read_b128 a[152:155], v3 offset:36864
ds_read_b128 a[156:159], v4 offset:36864
v_mfma_f32_16x16x32_bf16 v[48:51], v[28:31], v[128:131], v[48:51]
v_exp_f32 v211, v211
v_mfma_f32_16x16x32_bf16 v[48:51], v[28:31], v[160:163], v[48:51]
v_exp_f32 v212, v212
v_mfma_f32_16x16x32_bf16 v[52:55], v[28:31], v[136:139], v[52:55]
ds_read_b128 a[160:163], v1 offset:40960
ds_read_b128 a[164:167], v2 offset:40960
v_mfma_f32_16x16x32_bf16 v[52:55], v[28:31], v[168:171], v[52:55]
v_exp_f32 v213, v213
v_mfma_f32_16x16x32_bf16 v[56:59], v[28:31], v[144:147], v[56:59]
v_exp_f32 v214, v214
v_mfma_f32_16x16x32_bf16 v[56:59], v[28:31], v[176:179], v[56:59]
ds_read_b128 a[168:171], v3 offset:40960
ds_read_b128 a[172:175], v4 offset:40960
v_mfma_f32_16x16x32_bf16 v[60:63], v[28:31], v[152:155], v[60:63]
s_waitcnt lgkmcnt(8)
v_exp_f32 v215, v215
v_mfma_f32_16x16x32_bf16 v[60:63], v[28:31], v[184:187], v[60:63]
s_cbranch_vccnz L_r12b
L_r12b_back:
ds_read_b128 a[176:179], v1 offset:45056
ds_read_b128 a[180:183], v2 offset:45056
v_mfma_f32_16x16x32_bf16 v[128:131], a[128:131], v[64:67], v[32:35]
v_exp_f32 v240, v240
v_mfma_f32_16x16x32_bf16 v[128:131], a[132:135], v[68:71], v[128:131]
s_add_u32 m0, s27, 114688
ds_read_b128 a[184:187], v3 offset:45056
ds_read_b128 a[188:191], v4 offset:45056
v_mfma_f32_16x16x32_bf16 v[128:131], a[136:139], v[72:75], v[128:131]
buffer_load_dwordx4 v17, s[16:19], s44 offen offset:0 nt lds
v_exp_f32 v241, v241
v_mfma_f32_16x16x32_bf16 v[128:131], a[140:143], v[76:79], v[128:131]
v_cvt_pk_bf16_f32 v202, v204, v205
v_cvt_pk_bf16_f32 v203, v206, v207
v_mfma_f32_16x16x32_bf16 v[136:139], a[140:143], v[92:95], v[36:39]
v_mfma_f32_16x16x32_bf16 v[136:139], a[136:139], v[88:91], v[136:139]
v_cvt_pk_bf16_f32 v208, v208, v209
v_cvt_pk_bf16_f32 v209, v210, v211
v_mfma_f32_16x16x32_bf16 v[136:139], a[132:135], v[84:87], v[136:139]
v_exp_f32 v242, v242
v_mfma_f32_16x16x32_bf16 v[136:139], a[128:131], v[80:83], v[136:139]
v_max3_f32 v19, v128, v129, v130
v_max_f32 v19, v131, v19
v_mfma_f32_16x16x32_bf16 v[144:147], a[128:131], v[96:99], v[40:43]
s_add_u32 s92, s44, 129024
buffer_load_dwordx4 v18, s[16:19], s92 offen offset:3072 nt lds
v_exp_f32 v243, v243
v_mfma_f32_16x16x32_bf16 v[144:147], a[132:135], v[100:103], v[144:147]
v_cvt_pk_bf16_f32 v210, v212, v213
v_cvt_pk_bf16_f32 v211, v214, v215
v_mfma_f32_16x16x32_bf16 v[144:147], a[136:139], v[104:107], v[144:147]
v_max3_f32 v20, v136, v137, v138
v_max_f32 v20, v139, v20
v_mfma_f32_16x16x32_bf16 v[144:147], a[140:143], v[108:111], v[144:147]
v_exp_f32 v244, v244
v_mfma_f32_16x16x32_bf16 v[152:155], a[140:143], v[124:127], v[44:47]
v_cvt_pk_bf16_f32 v240, v240, v241
v_cvt_pk_bf16_f32 v241, v242, v243
v_mfma_f32_16x16x32_bf16 v[152:155], a[136:139], v[120:123], v[152:155]
v_exp_f32 v245, v245
v_mfma_f32_16x16x32_bf16 v[152:155], a[132:135], v[116:119], v[152:155]
buffer_load_dwordx4 v18, s[16:19], s44 offen offset:1024 nt lds
v_max3_f32 v19, v144, v145, v19
v_max3_f32 v19, v146, v147, v19
v_mfma_f32_16x16x32_bf16 v[152:155], a[128:131], v[112:115], v[152:155]
s_waitcnt lgkmcnt(8)
ds_read_b64_tr_b16 a[128:129], v5 offset:16384
ds_read_b64_tr_b16 a[130:131], v5 offset:20480
v_mfma_f32_16x16x32_bf16 v[132:135], a[144:147], v[64:67], v[32:35]
v_exp_f32 v246, v246
v_mfma_f32_16x16x32_bf16 v[132:135], a[148:151], v[68:71], v[132:135]
ds_read_b64_tr_b16 a[132:133], v5 offset:24576
ds_read_b64_tr_b16 a[134:135], v5 offset:28672
v_mfma_f32_16x16x32_bf16 v[132:135], a[152:155], v[72:75], v[132:135]
v_mfma_f32_16x16x32_bf16 v[132:135], a[156:159], v[76:79], v[132:135]
v_exp_f32 v247, v247
v_mfma_f32_16x16x32_bf16 v[140:143], a[156:159], v[92:95], v[36:39]
buffer_load_dwordx4 v17, s[16:19], s92 offen offset:2048 nt lds
v_max3_f32 v20, v152, v153, v20
v_max3_f32 v20, v154, v155, v20
v_mfma_f32_16x16x32_bf16 v[140:143], a[152:155], v[88:91], v[140:143]
ds_read_b64_tr_b16 a[136:137], v6 offset:16384
ds_read_b64_tr_b16 a[138:139], v6 offset:20480
v_mfma_f32_16x16x32_bf16 v[140:143], a[148:151], v[84:87], v[140:143]
v_exp_f32 v248, v248
v_mfma_f32_16x16x32_bf16 v[140:143], a[144:147], v[80:83], v[140:143]
v_max3_f32 v19, v132, v133, v19
v_max3_f32 v19, v134, v135, v19
v_mfma_f32_16x16x32_bf16 v[148:151], a[144:147], v[96:99], v[40:43]
s_add_u32 s48, s57, 0
buffer_load_dwordx4 a[224:227], v21, s[4:7], s48 offen offset:0 sc1
v_exp_f32 v249, v249
v_mfma_f32_16x16x32_bf16 v[148:151], a[148:151], v[100:103], v[148:151]
ds_read_b64_tr_b16 a[140:141], v6 offset:24576
ds_read_b64_tr_b16 a[142:143], v6 offset:28672
v_mfma_f32_16x16x32_bf16 v[148:151], a[152:155], v[104:107], v[148:151]
v_max3_f32 v20, v140, v141, v20
v_max3_f32 v20, v142, v143, v20
v_mfma_f32_16x16x32_bf16 v[148:151], a[156:159], v[108:111], v[148:151]
v_exp_f32 v250, v250
v_mfma_f32_16x16x32_bf16 v[156:159], a[156:159], v[124:127], v[44:47]
v_cvt_pk_bf16_f32 v242, v244, v245
v_cvt_pk_bf16_f32 v243, v246, v247
v_mfma_f32_16x16x32_bf16 v[156:159], a[152:155], v[120:123], v[156:159]
v_exp_f32 v251, v251
v_mfma_f32_16x16x32_bf16 v[156:159], a[148:151], v[116:119], v[156:159]
v_max3_f32 v19, v148, v149, v19
v_max3_f32 v19, v150, v151, v19
v_mfma_f32_16x16x32_bf16 v[156:159], a[144:147], v[112:115], v[156:159]
s_waitcnt lgkmcnt(12)
ds_read_b64_tr_b16 a[144:145], v7 offset:16384
ds_read_b64_tr_b16 a[146:147], v7 offset:20480
v_mfma_f32_16x16x32_bf16 v[160:163], a[160:163], v[64:67], v[32:35]
buffer_load_dwordx4 a[228:231], v21, s[4:7], s48 offen offset:1024 sc1
v_mfma_f32_16x16x32_bf16 v[160:163], a[164:167], v[68:71], v[160:163]
v_exp_f32 v252, v252
v_mfma_f32_16x16x32_bf16 v[160:163], a[168:171], v[72:75], v[160:163]
v_max3_f32 v20, v156, v157, v20
v_max3_f32 v20, v158, v159, v20
v_mfma_f32_16x16x32_bf16 v[160:163], a[172:175], v[76:79], v[160:163]
v_exp_f32 v253, v253
v_mfma_f32_16x16x32_bf16 v[168:171], a[172:175], v[92:95], v[36:39]
buffer_load_dwordx4 a[232:235], v21, s[4:7], s48 offen offset:2048 sc1
ds_read_b64_tr_b16 a[148:149], v7 offset:24576
ds_read_b64_tr_b16 a[150:151], v7 offset:28672
v_mfma_f32_16x16x32_bf16 v[168:171], a[168:171], v[88:91], v[168:171]
ds_read_b64_tr_b16 a[152:153], v8 offset:16384
ds_read_b64_tr_b16 a[154:155], v8 offset:20480
v_mfma_f32_16x16x32_bf16 v[168:171], a[164:167], v[84:87], v[168:171]
v_exp_f32 v254, v254
v_mfma_f32_16x16x32_bf16 v[168:171], a[160:163], v[80:83], v[168:171]
v_max3_f32 v19, v160, v161, v19
v_max3_f32 v19, v162, v163, v19
v_mfma_f32_16x16x32_bf16 v[176:179], a[160:163], v[96:99], v[40:43]
v_exp_f32 v255, v255
v_mfma_f32_16x16x32_bf16 v[176:179], a[164:167], v[100:103], v[176:179]
ds_read_b64_tr_b16 a[156:157], v8 offset:24576
v_cvt_pk_bf16_f32 v248, v248, v249
v_mfma_f32_16x16x32_bf16 v[176:179], a[168:171], v[104:107], v[176:179]
v_max3_f32 v20, v168, v169, v20
v_max3_f32 v20, v170, v171, v20
v_mfma_f32_16x16x32_bf16 v[176:179], a[172:175], v[108:111], v[176:179]
v_exp_f32 v216, v216
v_mfma_f32_16x16x32_bf16 v[184:187], a[172:175], v[124:127], v[44:47]
ds_read_b64_tr_b16 a[158:159], v8 offset:28672
v_cvt_pk_bf16_f32 v249, v250, v251
v_mfma_f32_16x16x32_bf16 v[184:187], a[168:171], v[120:123], v[184:187]
v_exp_f32 v217, v217
v_mfma_f32_16x16x32_bf16 v[184:187], a[164:167], v[116:119], v[184:187]
buffer_load_dwordx4 a[236:239], v21, s[4:7], s48 offen offset:3072 sc1
v_mfma_f32_16x16x32_bf16 v[184:187], a[160:163], v[112:115], v[184:187]
s_waitcnt lgkmcnt(15)
v_max3_f32 v19, v176, v177, v19
v_max3_f32 v19, v178, v179, v19
v_mfma_f32_16x16x32_bf16 v[164:167], a[176:179], v[64:67], v[32:35]
ds_read_b64_tr_b16 a[160:161], v9 offset:16384
v_cvt_pk_bf16_f32 v250, v252, v253
v_mfma_f32_16x16x32_bf16 v[164:167], a[180:183], v[68:71], v[164:167]
s_add_u32 s48, s57, 4096
buffer_load_dwordx4 a[240:243], v21, s[4:7], s48 offen offset:0 sc1
v_exp_f32 v218, v218
v_mfma_f32_16x16x32_bf16 v[164:167], a[184:187], v[72:75], v[164:167]
v_max3_f32 v20, v184, v185, v20
v_max3_f32 v20, v186, v187, v20
v_mfma_f32_16x16x32_bf16 v[164:167], a[188:191], v[76:79], v[164:167]
v_exp_f32 v219, v219
v_mfma_f32_16x16x32_bf16 v[172:175], a[188:191], v[92:95], v[36:39]
ds_read_b64_tr_b16 a[162:163], v9 offset:20480
v_cvt_pk_bf16_f32 v251, v254, v255
v_mfma_f32_16x16x32_bf16 v[172:175], a[184:187], v[88:91], v[172:175]
ds_read_b64_tr_b16 a[164:165], v9 offset:24576
v_cvt_pk_bf16_f32 v216, v216, v217
v_mfma_f32_16x16x32_bf16 v[172:175], a[180:183], v[84:87], v[172:175]
v_exp_f32 v220, v220
v_mfma_f32_16x16x32_bf16 v[172:175], a[176:179], v[80:83], v[172:175]
v_max3_f32 v19, v164, v165, v19
v_max3_f32 v19, v166, v167, v19
v_mfma_f32_16x16x32_bf16 v[180:183], a[176:179], v[96:99], v[40:43]
v_exp_f32 v221, v221
v_mfma_f32_16x16x32_bf16 v[180:183], a[180:183], v[100:103], v[180:183]
ds_read_b64_tr_b16 a[166:167], v9 offset:28672
v_cvt_pk_bf16_f32 v217, v218, v219
v_mfma_f32_16x16x32_bf16 v[180:183], a[184:187], v[104:107], v[180:183]
v_max3_f32 v20, v172, v173, v20
v_max3_f32 v20, v174, v175, v20
v_mfma_f32_16x16x32_bf16 v[180:183], a[188:191], v[108:111], v[180:183]
v_exp_f32 v222, v222
v_mfma_f32_16x16x32_bf16 v[188:191], a[188:191], v[124:127], v[44:47]
buffer_load_dwordx4 a[244:247], v21, s[4:7], s48 offen offset:1024 sc1
v_cvt_pk_bf16_f32 v218, v220, v221
v_mfma_f32_16x16x32_bf16 v[188:191], a[184:187], v[120:123], v[188:191]
v_exp_f32 v223, v223
v_mfma_f32_16x16x32_bf16 v[188:191], a[180:183], v[116:119], v[188:191]
v_max3_f32 v19, v180, v181, v19
v_max3_f32 v19, v182, v183, v19
v_mfma_f32_16x16x32_bf16 v[188:191], a[176:179], v[112:115], v[188:191]
s_waitcnt lgkmcnt(15)
v_cvt_pk_bf16_f32 v219, v222, v223
v_mfma_f32_16x16x32_bf16 a[0:3], a[128:131], v[192:195], a[0:3]
buffer_load_dwordx4 a[248:251], v21, s[4:7], s48 offen offset:2048 sc1
v_mfma_f32_16x16x32_bf16 a[0:3], a[132:135], v[224:227], a[0:3]
v_mfma_f32_16x16x32_bf16 a[32:35], a[132:135], v[232:235], a[32:35]
v_max3_f32 v20, v188, v189, v20
v_max3_f32 v20, v190, v191, v20
v_mfma_f32_16x16x32_bf16 a[32:35], a[128:131], v[200:203], a[32:35]
v_max_f32 v19, v19, v20
v_cmp_lt_f32 vcc, s46, v19
v_mfma_f32_16x16x32_bf16 a[64:67], a[128:131], v[208:211], a[64:67]
buffer_load_dwordx4 a[252:255], v21, s[4:7], s48 offen offset:3072 sc1
v_mfma_f32_16x16x32_bf16 a[64:67], a[132:135], v[240:243], a[64:67]
s_cbranch_vccnz L_r13a
L_r13a_back:
v_exp_f32 v128, v128
v_mfma_f32_16x16x32_bf16 a[96:99], a[132:135], v[248:251], a[96:99]
v_exp_f32 v129, v129
v_mfma_f32_16x16x32_bf16 a[96:99], a[128:131], v[216:219], a[96:99]
s_waitcnt lgkmcnt(12)
ds_read_b64_tr_b16 a[168:169], v10 offset:16384
ds_read_b64_tr_b16 a[170:171], v10 offset:20480
v_mfma_f32_16x16x32_bf16 a[4:7], a[136:139], v[192:195], a[4:7]
v_mfma_f32_16x16x32_bf16 a[4:7], a[140:143], v[224:227], a[4:7]
v_exp_f32 v130, v130
v_mfma_f32_16x16x32_bf16 a[36:39], a[140:143], v[232:235], a[36:39]
v_exp_f32 v131, v131
v_mfma_f32_16x16x32_bf16 a[36:39], a[136:139], v[200:203], a[36:39]
ds_read_b64_tr_b16 a[172:173], v10 offset:24576
ds_read_b64_tr_b16 a[174:175], v10 offset:28672
v_mfma_f32_16x16x32_bf16 a[68:71], a[136:139], v[208:211], a[68:71]
v_exp_f32 v132, v132
v_mfma_f32_16x16x32_bf16 a[68:71], a[140:143], v[240:243], a[68:71]
v_exp_f32 v133, v133
v_mfma_f32_16x16x32_bf16 a[100:103], a[140:143], v[248:251], a[100:103]
ds_read_b64_tr_b16 a[176:177], v11 offset:16384
ds_read_b64_tr_b16 a[178:179], v11 offset:20480
v_mfma_f32_16x16x32_bf16 a[100:103], a[136:139], v[216:219], a[100:103]
s_waitcnt lgkmcnt(14)
v_exp_f32 v134, v134
v_mfma_f32_16x16x32_bf16 a[8:11], a[144:147], v[192:195], a[8:11]
v_exp_f32 v135, v135
v_mfma_f32_16x16x32_bf16 a[8:11], a[148:151], v[224:227], a[8:11]
ds_read_b64_tr_b16 a[180:181], v11 offset:24576
ds_read_b64_tr_b16 a[182:183], v11 offset:28672
v_mfma_f32_16x16x32_bf16 a[40:43], a[148:151], v[232:235], a[40:43]
v_exp_f32 v160, v160
v_mfma_f32_16x16x32_bf16 a[40:43], a[144:147], v[200:203], a[40:43]
v_exp_f32 v161, v161
v_mfma_f32_16x16x32_bf16 a[72:75], a[144:147], v[208:211], a[72:75]
ds_read_b64_tr_b16 a[184:185], v12 offset:16384
ds_read_b64_tr_b16 a[186:187], v12 offset:20480
v_mfma_f32_16x16x32_bf16 a[72:75], a[148:151], v[240:243], a[72:75]
v_exp_f32 v162, v162
v_mfma_f32_16x16x32_bf16 a[104:107], a[148:151], v[248:251], a[104:107]
v_mfma_f32_16x16x32_bf16 a[104:107], a[144:147], v[216:219], a[104:107]
s_waitcnt lgkmcnt(14)
ds_read_b64_tr_b16 a[188:189], v12 offset:24576
ds_read_b64_tr_b16 a[190:191], v12 offset:28672
v_mfma_f32_16x16x32_bf16 a[12:15], a[152:155], v[192:195], a[12:15]
v_exp_f32 v163, v163
v_mfma_f32_16x16x32_bf16 a[12:15], a[156:159], v[224:227], a[12:15]
v_exp_f32 v164, v164
v_mfma_f32_16x16x32_bf16 a[44:47], a[156:159], v[232:235], a[44:47]
v_cvt_pk_bf16_f32 v128, v128, v129
v_cvt_pk_bf16_f32 v129, v130, v131
v_mfma_f32_16x16x32_bf16 a[44:47], a[152:155], v[200:203], a[44:47]
v_exp_f32 v165, v165
v_mfma_f32_16x16x32_bf16 a[76:79], a[152:155], v[208:211], a[76:79]
v_exp_f32 v166, v166
v_mfma_f32_16x16x32_bf16 a[76:79], a[156:159], v[240:243], a[76:79]
v_cvt_pk_bf16_f32 v130, v132, v133
v_cvt_pk_bf16_f32 v131, v134, v135
v_mfma_f32_16x16x32_bf16 a[108:111], a[156:159], v[248:251], a[108:111]
v_exp_f32 v167, v167
v_mfma_f32_16x16x32_bf16 a[108:111], a[152:155], v[216:219], a[108:111]
s_waitcnt lgkmcnt(12)
v_exp_f32 v168, v168
v_mfma_f32_16x16x32_bf16 a[16:19], a[160:163], v[192:195], a[16:19]
v_cvt_pk_bf16_f32 v160, v160, v161
v_cvt_pk_bf16_f32 v161, v162, v163
v_mfma_f32_16x16x32_bf16 a[16:19], a[164:167], v[224:227], a[16:19]
v_exp_f32 v169, v169
v_mfma_f32_16x16x32_bf16 a[48:51], a[164:167], v[232:235], a[48:51]
v_exp_f32 v170, v170
v_mfma_f32_16x16x32_bf16 a[48:51], a[160:163], v[200:203], a[48:51]
v_cvt_pk_bf16_f32 v162, v164, v165
v_cvt_pk_bf16_f32 v163, v166, v167
v_mfma_f32_16x16x32_bf16 a[80:83], a[160:163], v[208:211], a[80:83]
v_mfma_f32_16x16x32_bf16 a[80:83], a[164:167], v[240:243], a[80:83]
v_exp_f32 v171, v171
v_mfma_f32_16x16x32_bf16 a[112:115], a[164:167], v[248:251], a[112:115]
v_cvt_pk_bf16_f32 v168, v168, v169
v_cvt_pk_bf16_f32 v169, v170, v171
v_mfma_f32_16x16x32_bf16 a[112:115], a[160:163], v[216:219], a[112:115]
s_waitcnt lgkmcnt(8)
v_exp_f32 v172, v172
v_mfma_f32_16x16x32_bf16 a[20:23], a[168:171], v[192:195], a[20:23]
v_exp_f32 v173, v173
v_mfma_f32_16x16x32_bf16 a[20:23], a[172:175], v[224:227], a[20:23]
v_cvt_pk_bf16_f32 v170, v172, v173
v_mfma_f32_16x16x32_bf16 a[52:55], a[172:175], v[232:235], a[52:55]
v_exp_f32 v174, v174
v_mfma_f32_16x16x32_bf16 a[52:55], a[168:171], v[200:203], a[52:55]
v_exp_f32 v175, v175
v_mfma_f32_16x16x32_bf16 a[84:87], a[168:171], v[208:211], a[84:87]
v_cvt_pk_bf16_f32 v171, v174, v175
v_mfma_f32_16x16x32_bf16 a[84:87], a[172:175], v[240:243], a[84:87]
v_exp_f32 v136, v136
v_mfma_f32_16x16x32_bf16 a[116:119], a[172:175], v[248:251], a[116:119]
v_exp_f32 v137, v137
v_mfma_f32_16x16x32_bf16 a[116:119], a[168:171], v[216:219], a[116:119]
s_waitcnt lgkmcnt(4)
v_cvt_pk_bf16_f32 v136, v136, v137
v_mfma_f32_16x16x32_bf16 a[24:27], a[176:179], v[192:195], a[24:27]
v_exp_f32 v138, v138
v_mfma_f32_16x16x32_bf16 a[24:27], a[180:183], v[224:227], a[24:27]
v_exp_f32 v139, v139
v_mfma_f32_16x16x32_bf16 a[56:59], a[180:183], v[232:235], a[56:59]
v_mfma_f32_16x16x32_bf16 a[56:59], a[176:179], v[200:203], a[56:59]
v_cvt_pk_bf16_f32 v137, v138, v139
v_mfma_f32_16x16x32_bf16 a[88:91], a[176:179], v[208:211], a[88:91]
v_exp_f32 v140, v140
v_mfma_f32_16x16x32_bf16 a[88:91], a[180:183], v[240:243], a[88:91]
s_waitcnt vmcnt(12) lgkmcnt(0)
v_exp_f32 v141, v141
v_mfma_f32_16x16x32_bf16 a[120:123], a[180:183], v[248:251], a[120:123]
s_barrier
v_mfma_f32_16x16x32_bf16 a[120:123], a[176:179], v[216:219], a[120:123]
ds_read_b128 a[128:131], v1 offset:49152
ds_read_b128 a[132:135], v2 offset:49152
v_mfma_f32_16x16x32_bf16 a[28:31], a[184:187], v[192:195], a[28:31]
s_mov_b32 s44, s49
v_exp_f32 v142, v142
v_mfma_f32_16x16x32_bf16 a[28:31], a[188:191], v[224:227], a[28:31]
s_or_b32 s49, s49, 0xffff87ff
ds_read_b128 a[136:139], v3 offset:49152
ds_read_b128 a[140:143], v4 offset:49152
v_mfma_f32_16x16x32_bf16 a[60:63], a[188:191], v[232:235], a[60:63]
s_add_u32 s49, s49, 1
v_exp_f32 v143, v143
v_mfma_f32_16x16x32_bf16 a[60:63], a[184:187], v[200:203], a[60:63]
s_and_b32 s49, s49, 0x7800
v_exp_f32 v144, v144
v_mfma_f32_16x16x32_bf16 a[92:95], a[184:187], v[208:211], a[92:95]
ds_read_b128 a[144:147], v1 offset:53248
ds_read_b128 a[148:151], v2 offset:53248
v_mfma_f32_16x16x32_bf16 a[92:95], a[188:191], v[240:243], a[92:95]
v_exp_f32 v145, v145
v_mfma_f32_16x16x32_bf16 a[124:127], a[188:191], v[248:251], a[124:127]
v_exp_f32 v146, v146
v_mfma_f32_16x16x32_bf16 a[124:127], a[184:187], v[216:219], a[124:127]
ds_read_b128 a[152:155], v3 offset:53248
ds_read_b128 a[156:159], v4 offset:53248
v_mfma_f32_16x16x32_bf16 v[48:51], v[28:31], v[192:195], v[48:51]
v_exp_f32 v147, v147
v_mfma_f32_16x16x32_bf16 v[48:51], v[28:31], v[224:227], v[48:51]
v_exp_f32 v148, v148
v_mfma_f32_16x16x32_bf16 v[52:55], v[28:31], v[200:203], v[52:55]
ds_read_b128 a[160:163], v1 offset:57344
ds_read_b128 a[164:167], v2 offset:57344
v_mfma_f32_16x16x32_bf16 v[52:55], v[28:31], v[232:235], v[52:55]
v_exp_f32 v149, v149
v_mfma_f32_16x16x32_bf16 v[56:59], v[28:31], v[208:211], v[56:59]
v_exp_f32 v150, v150
v_mfma_f32_16x16x32_bf16 v[56:59], v[28:31], v[240:243], v[56:59]
ds_read_b128 a[168:171], v3 offset:57344
ds_read_b128 a[172:175], v4 offset:57344
v_mfma_f32_16x16x32_bf16 v[60:63], v[28:31], v[216:219], v[60:63]
s_waitcnt lgkmcnt(8)
v_exp_f32 v151, v151
v_mfma_f32_16x16x32_bf16 v[60:63], v[28:31], v[248:251], v[60:63]
s_cbranch_vccnz L_r13b
L_r13b_back:
ds_read_b128 a[176:179], v1 offset:61440
ds_read_b128 a[180:183], v2 offset:61440
v_mfma_f32_16x16x32_bf16 v[192:195], a[128:131], v[64:67], v[32:35]
v_exp_f32 v176, v176
v_mfma_f32_16x16x32_bf16 v[192:195], a[132:135], v[68:71], v[192:195]
ds_read_b128 a[184:187], v3 offset:61440
ds_read_b128 a[188:191], v4 offset:61440
v_mfma_f32_16x16x32_bf16 v[192:195], a[136:139], v[72:75], v[192:195]
v_exp_f32 v177, v177
v_mfma_f32_16x16x32_bf16 v[192:195], a[140:143], v[76:79], v[192:195]
v_cvt_pk_bf16_f32 v138, v140, v141
v_cvt_pk_bf16_f32 v139, v142, v143
v_mfma_f32_16x16x32_bf16 v[200:203], a[140:143], v[92:95], v[36:39]
s_add_u32 s48, s56, 0
buffer_load_dwordx4 a[192:195], v21, s[4:7], s48 offen offset:0 sc1
v_mfma_f32_16x16x32_bf16 v[200:203], a[136:139], v[88:91], v[200:203]
v_cvt_pk_bf16_f32 v144, v144, v145
v_cvt_pk_bf16_f32 v145, v146, v147
v_mfma_f32_16x16x32_bf16 v[200:203], a[132:135], v[84:87], v[200:203]
v_exp_f32 v178, v178
v_mfma_f32_16x16x32_bf16 v[200:203], a[128:131], v[80:83], v[200:203]
v_max3_f32 v19, v192, v193, v194
v_max_f32 v19, v195, v19
v_mfma_f32_16x16x32_bf16 v[208:211], a[128:131], v[96:99], v[40:43]
buffer_load_dwordx4 a[196:199], v21, s[4:7], s48 offen offset:1024 sc1
v_exp_f32 v179, v179
v_mfma_f32_16x16x32_bf16 v[208:211], a[132:135], v[100:103], v[208:211]
v_cvt_pk_bf16_f32 v146, v148, v149
v_cvt_pk_bf16_f32 v147, v150, v151
v_mfma_f32_16x16x32_bf16 v[208:211], a[136:139], v[104:107], v[208:211]
v_max3_f32 v20, v200, v201, v202
v_max_f32 v20, v203, v20
v_mfma_f32_16x16x32_bf16 v[208:211], a[140:143], v[108:111], v[208:211]
v_exp_f32 v180, v180
v_mfma_f32_16x16x32_bf16 v[216:219], a[140:143], v[124:127], v[44:47]
v_cvt_pk_bf16_f32 v176, v176, v177
v_cvt_pk_bf16_f32 v177, v178, v179
v_mfma_f32_16x16x32_bf16 v[216:219], a[136:139], v[120:123], v[216:219]
v_exp_f32 v181, v181
v_mfma_f32_16x16x32_bf16 v[216:219], a[132:135], v[116:119], v[216:219]
v_max3_f32 v19, v208, v209, v19
v_max3_f32 v19, v210, v211, v19
v_mfma_f32_16x16x32_bf16 v[216:219], a[128:131], v[112:115], v[216:219]
s_waitcnt lgkmcnt(8)
ds_read_b64_tr_b16 a[128:129], v5 offset:32768
ds_read_b64_tr_b16 a[130:131], v5 offset:36864
v_mfma_f32_16x16x32_bf16 v[196:199], a[144:147], v[64:67], v[32:35]
v_exp_f32 v182, v182
v_mfma_f32_16x16x32_bf16 v[196:199], a[148:151], v[68:71], v[196:199]
ds_read_b64_tr_b16 a[132:133], v5 offset:40960
ds_read_b64_tr_b16 a[134:135], v5 offset:45056
v_mfma_f32_16x16x32_bf16 v[196:199], a[152:155], v[72:75], v[196:199]
buffer_load_dwordx4 a[200:203], v21, s[4:7], s48 offen offset:2048 sc1
v_mfma_f32_16x16x32_bf16 v[196:199], a[156:159], v[76:79], v[196:199]
v_exp_f32 v183, v183
v_mfma_f32_16x16x32_bf16 v[204:207], a[156:159], v[92:95], v[36:39]
v_max3_f32 v20, v216, v217, v20
v_max3_f32 v20, v218, v219, v20
v_mfma_f32_16x16x32_bf16 v[204:207], a[152:155], v[88:91], v[204:207]
ds_read_b64_tr_b16 a[136:137], v6 offset:32768
ds_read_b64_tr_b16 a[138:139], v6 offset:36864
v_mfma_f32_16x16x32_bf16 v[204:207], a[148:151], v[84:87], v[204:207]
v_exp_f32 v184, v184
v_mfma_f32_16x16x32_bf16 v[204:207], a[144:147], v[80:83], v[204:207]
v_max3_f32 v19, v196, v197, v19
v_max3_f32 v19, v198, v199, v19
v_mfma_f32_16x16x32_bf16 v[212:215], a[144:147], v[96:99], v[40:43]
buffer_load_dwordx4 a[204:207], v21, s[4:7], s48 offen offset:3072 sc1
v_exp_f32 v185, v185
v_mfma_f32_16x16x32_bf16 v[212:215], a[148:151], v[100:103], v[212:215]
ds_read_b64_tr_b16 a[140:141], v6 offset:40960
ds_read_b64_tr_b16 a[142:143], v6 offset:45056
v_mfma_f32_16x16x32_bf16 v[212:215], a[152:155], v[104:107], v[212:215]
v_max3_f32 v20, v204, v205, v20
v_max3_f32 v20, v206, v207, v20
v_mfma_f32_16x16x32_bf16 v[212:215], a[156:159], v[108:111], v[212:215]
v_exp_f32 v186, v186
v_mfma_f32_16x16x32_bf16 v[220:223], a[156:159], v[124:127], v[44:47]
v_cvt_pk_bf16_f32 v178, v180, v181
v_cvt_pk_bf16_f32 v179, v182, v183
v_mfma_f32_16x16x32_bf16 v[220:223], a[152:155], v[120:123], v[220:223]
v_exp_f32 v187, v187
v_mfma_f32_16x16x32_bf16 v[220:223], a[148:151], v[116:119], v[220:223]
v_max3_f32 v19, v212, v213, v19
v_max3_f32 v19, v214, v215, v19
v_mfma_f32_16x16x32_bf16 v[220:223], a[144:147], v[112:115], v[220:223]
s_waitcnt lgkmcnt(12)
ds_read_b64_tr_b16 a[144:145], v7 offset:32768
ds_read_b64_tr_b16 a[146:147], v7 offset:36864
v_mfma_f32_16x16x32_bf16 v[224:227], a[160:163], v[64:67], v[32:35]
s_add_u32 s48, s56, 4096
buffer_load_dwordx4 a[208:211], v21, s[4:7], s48 offen offset:0 sc1
v_mfma_f32_16x16x32_bf16 v[224:227], a[164:167], v[68:71], v[224:227]
v_exp_f32 v188, v188
v_mfma_f32_16x16x32_bf16 v[224:227], a[168:171], v[72:75], v[224:227]
v_max3_f32 v20, v220, v221, v20
v_max3_f32 v20, v222, v223, v20
v_mfma_f32_16x16x32_bf16 v[224:227], a[172:175], v[76:79], v[224:227]
v_exp_f32 v189, v189
v_mfma_f32_16x16x32_bf16 v[232:235], a[172:175], v[92:95], v[36:39]
ds_read_b64_tr_b16 a[148:149], v7 offset:40960
ds_read_b64_tr_b16 a[150:151], v7 offset:45056
v_mfma_f32_16x16x32_bf16 v[232:235], a[168:171], v[88:91], v[232:235]
ds_read_b64_tr_b16 a[152:153], v8 offset:32768
ds_read_b64_tr_b16 a[154:155], v8 offset:36864
v_mfma_f32_16x16x32_bf16 v[232:235], a[164:167], v[84:87], v[232:235]
v_exp_f32 v190, v190
v_mfma_f32_16x16x32_bf16 v[232:235], a[160:163], v[80:83], v[232:235]
v_max3_f32 v19, v224, v225, v19
v_max3_f32 v19, v226, v227, v19
v_mfma_f32_16x16x32_bf16 v[240:243], a[160:163], v[96:99], v[40:43]
v_exp_f32 v191, v191
v_mfma_f32_16x16x32_bf16 v[240:243], a[164:167], v[100:103], v[240:243]
ds_read_b64_tr_b16 a[156:157], v8 offset:40960
v_cvt_pk_bf16_f32 v184, v184, v185
v_mfma_f32_16x16x32_bf16 v[240:243], a[168:171], v[104:107], v[240:243]
v_max3_f32 v20, v232, v233, v20
v_max3_f32 v20, v234, v235, v20
v_mfma_f32_16x16x32_bf16 v[240:243], a[172:175], v[108:111], v[240:243]
v_exp_f32 v152, v152
v_mfma_f32_16x16x32_bf16 v[248:251], a[172:175], v[124:127], v[44:47]
ds_read_b64_tr_b16 a[158:159], v8 offset:45056
v_cvt_pk_bf16_f32 v185, v186, v187
v_mfma_f32_16x16x32_bf16 v[248:251], a[168:171], v[120:123], v[248:251]
v_exp_f32 v153, v153
v_mfma_f32_16x16x32_bf16 v[248:251], a[164:167], v[116:119], v[248:251]
buffer_load_dwordx4 a[212:215], v21, s[4:7], s48 offen offset:1024 sc1
v_mfma_f32_16x16x32_bf16 v[248:251], a[160:163], v[112:115], v[248:251]
s_waitcnt lgkmcnt(15)
v_max3_f32 v19, v240, v241, v19
v_max3_f32 v19, v242, v243, v19
v_mfma_f32_16x16x32_bf16 v[228:231], a[176:179], v[64:67], v[32:35]
buffer_load_dwordx4 a[216:219], v21, s[4:7], s48 offen offset:2048 sc1
ds_read_b64_tr_b16 a[160:161], v9 offset:32768
v_cvt_pk_bf16_f32 v186, v188, v189
v_mfma_f32_16x16x32_bf16 v[228:231], a[180:183], v[68:71], v[228:231]
v_exp_f32 v154, v154
v_mfma_f32_16x16x32_bf16 v[228:231], a[184:187], v[72:75], v[228:231]
v_max3_f32 v20, v248, v249, v20
v_max3_f32 v20, v250, v251, v20
v_mfma_f32_16x16x32_bf16 v[228:231], a[188:191], v[76:79], v[228:231]
v_exp_f32 v155, v155
v_mfma_f32_16x16x32_bf16 v[236:239], a[188:191], v[92:95], v[36:39]
ds_read_b64_tr_b16 a[162:163], v9 offset:36864
v_cvt_pk_bf16_f32 v187, v190, v191
v_mfma_f32_16x16x32_bf16 v[236:239], a[184:187], v[88:91], v[236:239]
ds_read_b64_tr_b16 a[164:165], v9 offset:40960
v_cvt_pk_bf16_f32 v152, v152, v153
v_mfma_f32_16x16x32_bf16 v[236:239], a[180:183], v[84:87], v[236:239]
v_exp_f32 v156, v156
v_mfma_f32_16x16x32_bf16 v[236:239], a[176:179], v[80:83], v[236:239]
v_max3_f32 v19, v228, v229, v19
v_max3_f32 v19, v230, v231, v19
v_mfma_f32_16x16x32_bf16 v[244:247], a[176:179], v[96:99], v[40:43]
v_exp_f32 v157, v157
v_mfma_f32_16x16x32_bf16 v[244:247], a[180:183], v[100:103], v[244:247]
ds_read_b64_tr_b16 a[166:167], v9 offset:45056
v_cvt_pk_bf16_f32 v153, v154, v155
v_mfma_f32_16x16x32_bf16 v[244:247], a[184:187], v[104:107], v[244:247]
v_max3_f32 v20, v236, v237, v20
v_max3_f32 v20, v238, v239, v20
v_mfma_f32_16x16x32_bf16 v[244:247], a[188:191], v[108:111], v[244:247]
v_exp_f32 v158, v158
v_mfma_f32_16x16x32_bf16 v[252:255], a[188:191], v[124:127], v[44:47]
buffer_load_dwordx4 a[220:223], v21, s[4:7], s48 offen offset:3072 sc1
v_cvt_pk_bf16_f32 v154, v156, v157
v_mfma_f32_16x16x32_bf16 v[252:255], a[184:187], v[120:123], v[252:255]
v_exp_f32 v159, v159
v_mfma_f32_16x16x32_bf16 v[252:255], a[180:183], v[116:119], v[252:255]
v_max3_f32 v19, v244, v245, v19
v_max3_f32 v19, v246, v247, v19
v_mfma_f32_16x16x32_bf16 v[252:255], a[176:179], v[112:115], v[252:255]
s_waitcnt lgkmcnt(15)
v_cvt_pk_bf16_f32 v155, v158, v159
v_mfma_f32_16x16x32_bf16 a[0:3], a[128:131], v[128:131], a[0:3]
s_add_u32 s48, s58, 0
buffer_load_dwordx4 v[64:67], v21, s[4:7], s48 offen offset:0 sc1
v_mfma_f32_16x16x32_bf16 a[0:3], a[132:135], v[160:163], a[0:3]
v_mfma_f32_16x16x32_bf16 a[32:35], a[132:135], v[168:171], a[32:35]
v_max3_f32 v20, v252, v253, v20
v_max3_f32 v20, v254, v255, v20
v_mfma_f32_16x16x32_bf16 a[32:35], a[128:131], v[136:139], a[32:35]
v_max_f32 v19, v19, v20
v_cmp_lt_f32 vcc, s46, v19
v_mfma_f32_16x16x32_bf16 a[64:67], a[128:131], v[144:147], a[64:67]
buffer_load_dwordx4 v[68:71], v21, s[4:7], s48 offen offset:1024 sc1
v_mfma_f32_16x16x32_bf16 a[64:67], a[132:135], v[176:179], a[64:67]
s_cbranch_vccnz L_r14a
L_r14a_back:
v_exp_f32 v192, v192
v_mfma_f32_16x16x32_bf16 a[96:99], a[132:135], v[184:187], a[96:99]
v_exp_f32 v193, v193
v_mfma_f32_16x16x32_bf16 a[96:99], a[128:131], v[152:155], a[96:99]
s_waitcnt lgkmcnt(12)
ds_read_b64_tr_b16 a[168:169], v10 offset:32768
ds_read_b64_tr_b16 a[170:171], v10 offset:36864
v_mfma_f32_16x16x32_bf16 a[4:7], a[136:139], v[128:131], a[4:7]
buffer_load_dwordx4 v[72:75], v21, s[4:7], s48 offen offset:2048 sc1
v_mfma_f32_16x16x32_bf16 a[4:7], a[140:143], v[160:163], a[4:7]
v_exp_f32 v194, v194
v_mfma_f32_16x16x32_bf16 a[36:39], a[140:143], v[168:171], a[36:39]
v_exp_f32 v195, v195
v_mfma_f32_16x16x32_bf16 a[36:39], a[136:139], v[136:139], a[36:39]
buffer_load_dwordx4 v[76:79], v21, s[4:7], s48 offen offset:3072 sc1
ds_read_b64_tr_b16 a[172:173], v10 offset:40960
ds_read_b64_tr_b16 a[174:175], v10 offset:45056
v_mfma_f32_16x16x32_bf16 a[68:71], a[136:139], v[144:147], a[68:71]
v_exp_f32 v196, v196
v_mfma_f32_16x16x32_bf16 a[68:71], a[140:143], v[176:179], a[68:71]
v_exp_f32 v197, v197
v_mfma_f32_16x16x32_bf16 a[100:103], a[140:143], v[184:187], a[100:103]
s_add_u32 s48, s58, 4096
buffer_load_dwordx4 v[80:83], v21, s[4:7], s48 offen offset:0 sc1
ds_read_b64_tr_b16 a[176:177], v11 offset:32768
ds_read_b64_tr_b16 a[178:179], v11 offset:36864
v_mfma_f32_16x16x32_bf16 a[100:103], a[136:139], v[152:155], a[100:103]
s_waitcnt lgkmcnt(14)
v_exp_f32 v198, v198
v_mfma_f32_16x16x32_bf16 a[8:11], a[144:147], v[128:131], a[8:11]
v_exp_f32 v199, v199
v_mfma_f32_16x16x32_bf16 a[8:11], a[148:151], v[160:163], a[8:11]
ds_read_b64_tr_b16 a[180:181], v11 offset:40960
ds_read_b64_tr_b16 a[182:183], v11 offset:45056
v_mfma_f32_16x16x32_bf16 a[40:43], a[148:151], v[168:171], a[40:43]
buffer_load_dwordx4 v[84:87], v21, s[4:7], s48 offen offset:1024 sc1
v_exp_f32 v224, v224
v_mfma_f32_16x16x32_bf16 a[40:43], a[144:147], v[136:139], a[40:43]
v_exp_f32 v225, v225
v_mfma_f32_16x16x32_bf16 a[72:75], a[144:147], v[144:147], a[72:75]
ds_read_b64_tr_b16 a[184:185], v12 offset:32768
ds_read_b64_tr_b16 a[186:187], v12 offset:36864
v_mfma_f32_16x16x32_bf16 a[72:75], a[148:151], v[176:179], a[72:75]
v_exp_f32 v226, v226
v_mfma_f32_16x16x32_bf16 a[104:107], a[148:151], v[184:187], a[104:107]
buffer_load_dwordx4 v[88:91], v21, s[4:7], s48 offen offset:2048 sc1
v_mfma_f32_16x16x32_bf16 a[104:107], a[144:147], v[152:155], a[104:107]
s_waitcnt lgkmcnt(14)
ds_read_b64_tr_b16 a[188:189], v12 offset:40960
ds_read_b64_tr_b16 a[190:191], v12 offset:45056
v_mfma_f32_16x16x32_bf16 a[12:15], a[152:155], v[128:131], a[12:15]
buffer_load_dwordx4 v[92:95], v21, s[4:7], s48 offen offset:3072 sc1
v_exp_f32 v227, v227
v_mfma_f32_16x16x32_bf16 a[12:15], a[156:159], v[160:163], a[12:15]
v_exp_f32 v228, v228
v_mfma_f32_16x16x32_bf16 a[44:47], a[156:159], v[168:171], a[44:47]
v_cvt_pk_bf16_f32 v192, v192, v193
v_cvt_pk_bf16_f32 v193, v194, v195
v_mfma_f32_16x16x32_bf16 a[44:47], a[152:155], v[136:139], a[44:47]
v_exp_f32 v229, v229
v_mfma_f32_16x16x32_bf16 a[76:79], a[152:155], v[144:147], a[76:79]
s_add_u32 s48, s59, 0
buffer_load_dwordx4 v[96:99], v21, s[4:7], s48 offen offset:0 sc1
v_exp_f32 v230, v230
v_mfma_f32_16x16x32_bf16 a[76:79], a[156:159], v[176:179], a[76:79]
v_cvt_pk_bf16_f32 v194, v196, v197
v_cvt_pk_bf16_f32 v195, v198, v199
v_mfma_f32_16x16x32_bf16 a[108:111], a[156:159], v[184:187], a[108:111]
v_exp_f32 v231, v231
v_mfma_f32_16x16x32_bf16 a[108:111], a[152:155], v[152:155], a[108:111]
s_waitcnt lgkmcnt(12)
buffer_load_dwordx4 v[100:103], v21, s[4:7], s48 offen offset:1024 sc1
v_exp_f32 v232, v232
v_mfma_f32_16x16x32_bf16 a[16:19], a[160:163], v[128:131], a[16:19]
v_cvt_pk_bf16_f32 v224, v224, v225
v_cvt_pk_bf16_f32 v225, v226, v227
v_mfma_f32_16x16x32_bf16 a[16:19], a[164:167], v[160:163], a[16:19]
v_exp_f32 v233, v233
v_mfma_f32_16x16x32_bf16 a[48:51], a[164:167], v[168:171], a[48:51]
v_exp_f32 v234, v234
v_mfma_f32_16x16x32_bf16 a[48:51], a[160:163], v[136:139], a[48:51]
v_cvt_pk_bf16_f32 v226, v228, v229
v_cvt_pk_bf16_f32 v227, v230, v231
v_mfma_f32_16x16x32_bf16 a[80:83], a[160:163], v[144:147], a[80:83]
buffer_load_dwordx4 v[104:107], v21, s[4:7], s48 offen offset:2048 sc1
v_mfma_f32_16x16x32_bf16 a[80:83], a[164:167], v[176:179], a[80:83]
v_exp_f32 v235, v235
v_mfma_f32_16x16x32_bf16 a[112:115], a[164:167], v[184:187], a[112:115]
buffer_load_dwordx4 v[108:111], v21, s[4:7], s48 offen offset:3072 sc1
v_cvt_pk_bf16_f32 v232, v232, v233
v_cvt_pk_bf16_f32 v233, v234, v235
v_mfma_f32_16x16x32_bf16 a[112:115], a[160:163], v[152:155], a[112:115]
s_waitcnt lgkmcnt(8)
v_exp_f32 v236, v236
v_mfma_f32_16x16x32_bf16 a[20:23], a[168:171], v[128:131], a[20:23]
v_exp_f32 v237, v237
v_mfma_f32_16x16x32_bf16 a[20:23], a[172:175], v[160:163], a[20:23]
s_add_u32 s48, s59, 4096
buffer_load_dwordx4 v[112:115], v21, s[4:7], s48 offen offset:0 sc1
v_cvt_pk_bf16_f32 v234, v236, v237
v_mfma_f32_16x16x32_bf16 a[52:55], a[172:175], v[168:171], a[52:55]
v_exp_f32 v238, v238
v_mfma_f32_16x16x32_bf16 a[52:55], a[168:171], v[136:139], a[52:55]
v_exp_f32 v239, v239
v_mfma_f32_16x16x32_bf16 a[84:87], a[168:171], v[144:147], a[84:87]
v_cvt_pk_bf16_f32 v235, v238, v239
v_mfma_f32_16x16x32_bf16 a[84:87], a[172:175], v[176:179], a[84:87]
v_exp_f32 v200, v200
v_mfma_f32_16x16x32_bf16 a[116:119], a[172:175], v[184:187], a[116:119]
v_exp_f32 v201, v201
v_mfma_f32_16x16x32_bf16 a[116:119], a[168:171], v[152:155], a[116:119]
s_waitcnt lgkmcnt(4)
buffer_load_dwordx4 v[116:119], v21, s[4:7], s48 offen offset:1024 sc1
v_cvt_pk_bf16_f32 v200, v200, v201
v_mfma_f32_16x16x32_bf16 a[24:27], a[176:179], v[128:131], a[24:27]
v_exp_f32 v202, v202
v_mfma_f32_16x16x32_bf16 a[24:27], a[180:183], v[160:163], a[24:27]
v_exp_f32 v203, v203
v_mfma_f32_16x16x32_bf16 a[56:59], a[180:183], v[168:171], a[56:59]
buffer_load_dwordx4 v[120:123], v21, s[4:7], s48 offen offset:2048 sc1
v_mfma_f32_16x16x32_bf16 a[56:59], a[176:179], v[136:139], a[56:59]
v_cvt_pk_bf16_f32 v201, v202, v203
v_mfma_f32_16x16x32_bf16 a[88:91], a[176:179], v[144:147], a[88:91]
v_exp_f32 v204, v204
v_mfma_f32_16x16x32_bf16 a[88:91], a[180:183], v[176:179], a[88:91]
s_waitcnt vmcnt(31) lgkmcnt(0)
v_exp_f32 v205, v205
v_mfma_f32_16x16x32_bf16 a[120:123], a[180:183], v[184:187], a[120:123]
s_barrier
v_mfma_f32_16x16x32_bf16 a[120:123], a[176:179], v[152:155], a[120:123]
buffer_load_dwordx4 v[124:127], v21, s[4:7], s48 offen offset:3072 sc1
v_mfma_f32_16x16x32_bf16 a[28:31], a[184:187], v[128:131], a[28:31]
s_mov_b32 s44, s49
v_exp_f32 v206, v206
v_mfma_f32_16x16x32_bf16 a[28:31], a[188:191], v[160:163], a[28:31]
s_or_b32 s49, s49, 0xffff87ff
s_add_u32 s48, s60, 0
s_nop 0
buffer_load_dwordx4 v[32:35], v21, s[4:7], s48 offen offset:0 sc1
v_mfma_f32_16x16x32_bf16 a[60:63], a[188:191], v[168:171], a[60:63]
s_add_u32 s49, s49, 1
v_exp_f32 v207, v207
v_mfma_f32_16x16x32_bf16 a[60:63], a[184:187], v[136:139], a[60:63]
s_and_b32 s49, s49, 0x7800
v_exp_f32 v208, v208
v_mfma_f32_16x16x32_bf16 a[92:95], a[184:187], v[144:147], a[92:95]
buffer_load_dwordx4 v[36:39], v21, s[4:7], s48 offen offset:1024 sc1
v_mfma_f32_16x16x32_bf16 a[92:95], a[188:191], v[176:179], a[92:95]
v_exp_f32 v209, v209
v_mfma_f32_16x16x32_bf16 a[124:127], a[188:191], v[184:187], a[124:127]
v_exp_f32 v210, v210
v_mfma_f32_16x16x32_bf16 a[124:127], a[184:187], v[152:155], a[124:127]
v_mfma_f32_16x16x32_bf16 v[48:51], v[28:31], v[128:131], v[48:51]
v_exp_f32 v211, v211
v_mfma_f32_16x16x32_bf16 v[48:51], v[28:31], v[160:163], v[48:51]
v_exp_f32 v212, v212
v_mfma_f32_16x16x32_bf16 v[52:55], v[28:31], v[136:139], v[52:55]
buffer_load_dwordx4 v[40:43], v21, s[4:7], s48 offen offset:2048 sc1
v_mfma_f32_16x16x32_bf16 v[52:55], v[28:31], v[168:171], v[52:55]
v_exp_f32 v213, v213
v_mfma_f32_16x16x32_bf16 v[56:59], v[28:31], v[144:147], v[56:59]
v_exp_f32 v214, v214
v_mfma_f32_16x16x32_bf16 v[56:59], v[28:31], v[176:179], v[56:59]
buffer_load_dwordx4 v[44:47], v21, s[4:7], s48 offen offset:3072 sc1
v_mfma_f32_16x16x32_bf16 v[60:63], v[28:31], v[152:155], v[60:63]
v_exp_f32 v215, v215
v_mfma_f32_16x16x32_bf16 v[60:63], v[28:31], v[184:187], v[60:63]
s_cbranch_vccnz L_r14b
L_r14b_back:
ds_read_b64_tr_b16 a[128:129], v5 offset:49152
ds_read_b64_tr_b16 a[130:131], v5 offset:53248
ds_read_b64_tr_b16 a[132:133], v5 offset:57344
ds_read_b64_tr_b16 a[134:135], v5 offset:61440
ds_read_b64_tr_b16 a[136:137], v6 offset:49152
ds_read_b64_tr_b16 a[138:139], v6 offset:53248
ds_read_b64_tr_b16 a[140:141], v6 offset:57344
ds_read_b64_tr_b16 a[142:143], v6 offset:61440
ds_read_b64_tr_b16 a[144:145], v7 offset:49152
ds_read_b64_tr_b16 a[146:147], v7 offset:53248
ds_read_b64_tr_b16 a[148:149], v7 offset:57344
ds_read_b64_tr_b16 a[150:151], v7 offset:61440
v_mfma_f32_16x16x32_bf16 v[48:51], v[28:31], v[192:195], v[48:51]
ds_read_b64_tr_b16 a[152:153], v8 offset:49152
ds_read_b64_tr_b16 a[154:155], v8 offset:53248
v_mfma_f32_16x16x32_bf16 v[48:51], v[28:31], v[224:227], v[48:51]
ds_read_b64_tr_b16 a[156:157], v8 offset:57344
ds_read_b64_tr_b16 a[158:159], v8 offset:61440
s_waitcnt lgkmcnt(12)
v_mfma_f32_16x16x32_bf16 a[0:3], a[128:131], v[192:195], a[0:3]
ds_read_b64_tr_b16 a[160:161], v9 offset:49152
ds_read_b64_tr_b16 a[162:163], v9 offset:53248
v_mfma_f32_16x16x32_bf16 a[0:3], a[132:135], v[224:227], a[0:3]
ds_read_b64_tr_b16 a[164:165], v9 offset:57344
ds_read_b64_tr_b16 a[166:167], v9 offset:61440
s_waitcnt lgkmcnt(12)
v_mfma_f32_16x16x32_bf16 a[4:7], a[140:143], v[224:227], a[4:7]
ds_read_b64_tr_b16 a[168:169], v10 offset:49152
ds_read_b64_tr_b16 a[170:171], v10 offset:53248
v_mfma_f32_16x16x32_bf16 a[4:7], a[136:139], v[192:195], a[4:7]
ds_read_b64_tr_b16 a[172:173], v10 offset:57344
ds_read_b64_tr_b16 a[174:175], v10 offset:61440
s_waitcnt lgkmcnt(12)
v_mfma_f32_16x16x32_bf16 a[8:11], a[144:147], v[192:195], a[8:11]
ds_read_b64_tr_b16 a[176:177], v11 offset:49152
ds_read_b64_tr_b16 a[178:179], v11 offset:53248
v_mfma_f32_16x16x32_bf16 a[8:11], a[148:151], v[224:227], a[8:11]
ds_read_b64_tr_b16 a[180:181], v11 offset:57344
ds_read_b64_tr_b16 a[182:183], v11 offset:61440
s_waitcnt lgkmcnt(12)
v_mfma_f32_16x16x32_bf16 a[12:15], a[156:159], v[224:227], a[12:15]
ds_read_b64_tr_b16 a[184:185], v12 offset:49152
ds_read_b64_tr_b16 a[186:187], v12 offset:53248
v_mfma_f32_16x16x32_bf16 a[12:15], a[152:155], v[192:195], a[12:15]
ds_read_b64_tr_b16 a[188:189], v12 offset:57344
ds_read_b64_tr_b16 a[190:191], v12 offset:61440
s_waitcnt lgkmcnt(12)
v_mfma_f32_16x16x32_bf16 a[16:19], a[160:163], v[192:195], a[16:19]
v_and_b32 v22, 0x3ff, v21
s_nop 0
v_cvt_pk_bf16_f32 v202, v204, v205
v_mfma_f32_16x16x32_bf16 a[16:19], a[164:167], v[224:227], a[16:19]
v_cvt_pk_bf16_f32 v203, v206, v207
s_waitcnt lgkmcnt(8)
v_mfma_f32_16x16x32_bf16 a[20:23], a[172:175], v[224:227], a[20:23]
v_exp_f32 v240, v240
v_mfma_f32_16x16x32_bf16 a[20:23], a[168:171], v[192:195], a[20:23]
v_exp_f32 v241, v241
s_waitcnt lgkmcnt(4)
v_mfma_f32_16x16x32_bf16 a[24:27], a[176:179], v[192:195], a[24:27]
v_cvt_pk_bf16_f32 v208, v208, v209
v_cvt_pk_bf16_f32 v209, v210, v211
v_mfma_f32_16x16x32_bf16 a[24:27], a[180:183], v[224:227], a[24:27]
v_exp_f32 v242, v242
s_waitcnt lgkmcnt(0)
v_mfma_f32_16x16x32_bf16 a[28:31], a[188:191], v[224:227], a[28:31]
v_exp_f32 v243, v243
s_nop 0
v_mfma_f32_16x16x32_bf16 a[28:31], a[184:187], v[192:195], a[28:31]
v_mov_b32 v24, v48
v_mov_b32 v19, v24
s_nop 1
s_nop 1
v_mfma_f32_16x16x32_bf16 v[52:55], v[28:31], v[200:203], v[52:55]
v_permlane32_swap_b32 v24, v19
s_nop 1
v_mfma_f32_16x16x32_bf16 v[52:55], v[28:31], v[232:235], v[52:55]
v_add_f32 v24, v24, v19
v_mov_b32 v19, v24
s_nop 1
v_mfma_f32_16x16x32_bf16 a[32:35], a[128:131], v[200:203], a[32:35]
v_permlane16_swap_b32 v24, v19
s_nop 1
v_mfma_f32_16x16x32_bf16 a[32:35], a[132:135], v[232:235], a[32:35]
v_add_f32 v24, v24, v19
v_mfma_f32_16x16x32_bf16 a[36:39], a[140:143], v[232:235], a[36:39]
v_rcp_f32 v24, v24
v_mfma_f32_16x16x32_bf16 a[36:39], a[136:139], v[200:203], a[36:39]
v_accvgpr_read_b32 v2, a0
v_accvgpr_read_b32 v3, a1
v_mfma_f32_16x16x32_bf16 a[40:43], a[144:147], v[200:203], a[40:43]
v_accvgpr_read_b32 v4, a2
v_accvgpr_read_b32 v5, a3
v_mfma_f32_16x16x32_bf16 a[40:43], a[148:151], v[232:235], a[40:43]
v_accvgpr_read_b32 v6, a4
v_accvgpr_read_b32 v7, a5
v_mfma_f32_16x16x32_bf16 a[44:47], a[156:159], v[232:235], a[44:47]
v_accvgpr_read_b32 v8, a6
v_accvgpr_read_b32 v9, a7
v_mfma_f32_16x16x32_bf16 a[44:47], a[152:155], v[200:203], a[44:47]
v_mul_f32 v2, v2, v24
v_mul_f32 v3, v3, v24
v_mfma_f32_16x16x32_bf16 a[48:51], a[160:163], v[200:203], a[48:51]
v_mul_f32 v4, v4, v24
v_mul_f32 v5, v5, v24
v_mfma_f32_16x16x32_bf16 a[48:51], a[164:167], v[232:235], a[48:51]
v_mul_f32 v6, v6, v24
v_mul_f32 v7, v7, v24
v_mfma_f32_16x16x32_bf16 a[52:55], a[172:175], v[232:235], a[52:55]
v_mul_f32 v8, v8, v24
v_mul_f32 v9, v9, v24
v_mfma_f32_16x16x32_bf16 a[52:55], a[168:171], v[200:203], a[52:55]
v_cvt_pk_bf16_f32 v196, v2, v3
v_cvt_pk_bf16_f32 v197, v4, v5
v_mfma_f32_16x16x32_bf16 a[56:59], a[176:179], v[200:203], a[56:59]
v_cvt_pk_bf16_f32 v198, v6, v7
v_cvt_pk_bf16_f32 v199, v8, v9
s_mov_b32 s52, 0
v_mfma_f32_16x16x32_bf16 a[56:59], a[180:183], v[232:235], a[56:59]
buffer_store_dwordx4 v[196:199], v22, s[20:23], s52 offen offset:0 sc1
v_mfma_f32_16x16x32_bf16 a[60:63], a[188:191], v[232:235], a[60:63]
v_accvgpr_read_b32 v10, a8
v_accvgpr_read_b32 v11, a9
v_mfma_f32_16x16x32_bf16 a[60:63], a[184:187], v[200:203], a[60:63]
v_accvgpr_read_b32 v12, a10
v_accvgpr_read_b32 v13, a11
v_accvgpr_read_b32 v14, a12
v_accvgpr_read_b32 v15, a13
v_accvgpr_read_b32 v16, a14
v_accvgpr_read_b32 v17, a15
v_pk_mul_f32 v[10:11], v[10:11], v[24:25] op_sel_hi:[1,0]
v_pk_mul_f32 v[12:13], v[12:13], v[24:25] op_sel_hi:[1,0]
v_pk_mul_f32 v[14:15], v[14:15], v[24:25] op_sel_hi:[1,0]
v_pk_mul_f32 v[16:17], v[16:17], v[24:25] op_sel_hi:[1,0]
v_cvt_pk_bf16_f32 v192, v10, v11
v_cvt_pk_bf16_f32 v193, v12, v13
v_cvt_pk_bf16_f32 v194, v14, v15
v_cvt_pk_bf16_f32 v195, v16, v17
s_mov_b32 s52, 0
buffer_store_dwordx4 v[192:195], v22, s[20:23], s52 offen offset:2048 sc1
v_accvgpr_read_b32 v2, a16
v_accvgpr_read_b32 v3, a17
v_accvgpr_read_b32 v4, a18
v_accvgpr_read_b32 v5, a19
v_accvgpr_read_b32 v6, a20
v_accvgpr_read_b32 v7, a21
v_accvgpr_read_b32 v8, a22
v_accvgpr_read_b32 v9, a23
v_pk_mul_f32 v[2:3], v[2:3], v[24:25] op_sel_hi:[1,0]
v_pk_mul_f32 v[4:5], v[4:5], v[24:25] op_sel_hi:[1,0]
v_pk_mul_f32 v[6:7], v[6:7], v[24:25] op_sel_hi:[1,0]
v_pk_mul_f32 v[8:9], v[8:9], v[24:25] op_sel_hi:[1,0]
v_cvt_pk_bf16_f32 v228, v2, v3
v_cvt_pk_bf16_f32 v229, v4, v5
v_cvt_pk_bf16_f32 v230, v6, v7
v_cvt_pk_bf16_f32 v231, v8, v9
s_mov_b32 s52, 4096
buffer_store_dwordx4 v[228:231], v22, s[20:23], s52 offen offset:0 sc1
v_accvgpr_read_b32 v10, a24
v_accvgpr_read_b32 v11, a25
v_accvgpr_read_b32 v12, a26
v_accvgpr_read_b32 v13, a27
v_accvgpr_read_b32 v14, a28
v_accvgpr_read_b32 v15, a29
v_accvgpr_read_b32 v16, a30
v_accvgpr_read_b32 v17, a31
v_pk_mul_f32 v[10:11], v[10:11], v[24:25] op_sel_hi:[1,0]
v_pk_mul_f32 v[12:13], v[12:13], v[24:25] op_sel_hi:[1,0]
v_pk_mul_f32 v[14:15], v[14:15], v[24:25] op_sel_hi:[1,0]
v_pk_mul_f32 v[16:17], v[16:17], v[24:25] op_sel_hi:[1,0]
v_cvt_pk_bf16_f32 v224, v10, v11
v_cvt_pk_bf16_f32 v225, v12, v13
v_cvt_pk_bf16_f32 v226, v14, v15
v_cvt_pk_bf16_f32 v227, v16, v17
s_mov_b32 s52, 4096
buffer_store_dwordx4 v[224:227], v22, s[20:23], s52 offen offset:2048 sc1
v_cvt_pk_bf16_f32 v210, v212, v213
v_cvt_pk_bf16_f32 v211, v214, v215
v_exp_f32 v244, v244
s_nop 0
v_cvt_pk_bf16_f32 v240, v240, v241
v_cvt_pk_bf16_f32 v241, v242, v243
v_exp_f32 v245, v245
v_exp_f32 v246, v246
v_exp_f32 v247, v247
s_nop 0
v_cvt_pk_bf16_f32 v242, v244, v245
v_cvt_pk_bf16_f32 v243, v246, v247
s_nop 1
v_mfma_f32_16x16x32_bf16 v[56:59], v[28:31], v[208:211], v[56:59]
v_mov_b32 v25, v52
v_mov_b32 v19, v25
s_nop 1
v_mfma_f32_16x16x32_bf16 v[56:59], v[28:31], v[240:243], v[56:59]
v_permlane32_swap_b32 v25, v19
s_nop 1
v_mfma_f32_16x16x32_bf16 a[64:67], a[128:131], v[208:211], a[64:67]
v_add_f32 v25, v25, v19
v_mov_b32 v19, v25
s_nop 1
v_mfma_f32_16x16x32_bf16 a[64:67], a[132:135], v[240:243], a[64:67]
v_permlane16_swap_b32 v25, v19
s_nop 1
v_mfma_f32_16x16x32_bf16 a[68:71], a[140:143], v[240:243], a[68:71]
v_add_f32 v25, v25, v19
v_mfma_f32_16x16x32_bf16 a[68:71], a[136:139], v[208:211], a[68:71]
v_rcp_f32 v25, v25
v_mfma_f32_16x16x32_bf16 a[72:75], a[144:147], v[208:211], a[72:75]
v_accvgpr_read_b32 v2, a32
v_accvgpr_read_b32 v3, a33
v_mfma_f32_16x16x32_bf16 a[72:75], a[148:151], v[240:243], a[72:75]
v_accvgpr_read_b32 v4, a34
v_accvgpr_read_b32 v5, a35
v_mfma_f32_16x16x32_bf16 a[76:79], a[156:159], v[240:243], a[76:79]
v_accvgpr_read_b32 v6, a36
v_accvgpr_read_b32 v7, a37
v_mfma_f32_16x16x32_bf16 a[76:79], a[152:155], v[208:211], a[76:79]
v_accvgpr_read_b32 v8, a38
v_accvgpr_read_b32 v9, a39
v_mfma_f32_16x16x32_bf16 a[80:83], a[160:163], v[208:211], a[80:83]
v_mul_f32 v2, v2, v25
v_mul_f32 v3, v3, v25
v_mfma_f32_16x16x32_bf16 a[80:83], a[164:167], v[240:243], a[80:83]
v_mul_f32 v4, v4, v25
v_mul_f32 v5, v5, v25
v_mfma_f32_16x16x32_bf16 a[84:87], a[172:175], v[240:243], a[84:87]
v_mul_f32 v6, v6, v25
v_mul_f32 v7, v7, v25
v_mfma_f32_16x16x32_bf16 a[84:87], a[168:171], v[208:211], a[84:87]
v_mul_f32 v8, v8, v25
v_mul_f32 v9, v9, v25
v_mfma_f32_16x16x32_bf16 a[88:91], a[176:179], v[208:211], a[88:91]
v_cvt_pk_bf16_f32 v204, v2, v3
v_cvt_pk_bf16_f32 v205, v4, v5
v_mfma_f32_16x16x32_bf16 a[88:91], a[180:183], v[240:243], a[88:91]
v_cvt_pk_bf16_f32 v206, v6, v7
v_cvt_pk_bf16_f32 v207, v8, v9
s_mov_b32 s52, 0
v_mfma_f32_16x16x32_bf16 a[92:95], a[188:191], v[240:243], a[92:95]
buffer_store_dwordx4 v[204:207], v22, s[20:23], s52 offen offset:1024 sc1
v_mfma_f32_16x16x32_bf16 a[92:95], a[184:187], v[208:211], a[92:95]
v_accvgpr_read_b32 v10, a40
v_accvgpr_read_b32 v11, a41
v_accvgpr_read_b32 v12, a42
v_accvgpr_read_b32 v13, a43
v_accvgpr_read_b32 v14, a44
v_accvgpr_read_b32 v15, a45
v_accvgpr_read_b32 v16, a46
v_accvgpr_read_b32 v17, a47
v_pk_mul_f32 v[10:11], v[10:11], v[24:25] op_sel:[0,1] op_sel_hi:[1,1]
v_pk_mul_f32 v[12:13], v[12:13], v[24:25] op_sel:[0,1] op_sel_hi:[1,1]
v_pk_mul_f32 v[14:15], v[14:15], v[24:25] op_sel:[0,1] op_sel_hi:[1,1]
v_pk_mul_f32 v[16:17], v[16:17], v[24:25] op_sel:[0,1] op_sel_hi:[1,1]
v_cvt_pk_bf16_f32 v200, v10, v11
v_cvt_pk_bf16_f32 v201, v12, v13
v_cvt_pk_bf16_f32 v202, v14, v15
v_cvt_pk_bf16_f32 v203, v16, v17
s_mov_b32 s52, 0
buffer_store_dwordx4 v[200:203], v22, s[20:23], s52 offen offset:3072 sc1
v_accvgpr_read_b32 v2, a48
v_accvgpr_read_b32 v3, a49
v_accvgpr_read_b32 v4, a50
v_accvgpr_read_b32 v5, a51
v_accvgpr_read_b32 v6, a52
v_accvgpr_read_b32 v7, a53
v_accvgpr_read_b32 v8, a54
v_accvgpr_read_b32 v9, a55
v_pk_mul_f32 v[2:3], v[2:3], v[24:25] op_sel:[0,1] op_sel_hi:[1,1]
v_pk_mul_f32 v[4:5], v[4:5], v[24:25] op_sel:[0,1] op_sel_hi:[1,1]
v_pk_mul_f32 v[6:7], v[6:7], v[24:25] op_sel:[0,1] op_sel_hi:[1,1]
v_pk_mul_f32 v[8:9], v[8:9], v[24:25] op_sel:[0,1] op_sel_hi:[1,1]
v_cvt_pk_bf16_f32 v236, v2, v3
v_cvt_pk_bf16_f32 v237, v4, v5
v_cvt_pk_bf16_f32 v238, v6, v7
v_cvt_pk_bf16_f32 v239, v8, v9
s_mov_b32 s52, 4096
buffer_store_dwordx4 v[236:239], v22, s[20:23], s52 offen offset:1024 sc1
v_accvgpr_read_b32 v10, a56
v_accvgpr_read_b32 v11, a57
v_accvgpr_read_b32 v12, a58
v_accvgpr_read_b32 v13, a59
v_accvgpr_read_b32 v14, a60
v_accvgpr_read_b32 v15, a61
v_accvgpr_read_b32 v16, a62
v_accvgpr_read_b32 v17, a63
v_pk_mul_f32 v[10:11], v[10:11], v[24:25] op_sel:[0,1] op_sel_hi:[1,1]
v_pk_mul_f32 v[12:13], v[12:13], v[24:25] op_sel:[0,1] op_sel_hi:[1,1]
v_pk_mul_f32 v[14:15], v[14:15], v[24:25] op_sel:[0,1] op_sel_hi:[1,1]
v_pk_mul_f32 v[16:17], v[16:17], v[24:25] op_sel:[0,1] op_sel_hi:[1,1]
v_cvt_pk_bf16_f32 v232, v10, v11
v_cvt_pk_bf16_f32 v233, v12, v13
v_cvt_pk_bf16_f32 v234, v14, v15
v_cvt_pk_bf16_f32 v235, v16, v17
s_mov_b32 s52, 4096
buffer_store_dwordx4 v[232:235], v22, s[20:23], s52 offen offset:3072 sc1
v_exp_f32 v248, v248
v_exp_f32 v249, v249
v_exp_f32 v250, v250
v_exp_f32 v251, v251
v_exp_f32 v252, v252
v_exp_f32 v253, v253
v_exp_f32 v254, v254
v_exp_f32 v255, v255
s_nop 0
v_cvt_pk_bf16_f32 v248, v248, v249
v_exp_f32 v216, v216
s_nop 0
v_cvt_pk_bf16_f32 v249, v250, v251
v_exp_f32 v217, v217
s_nop 0
v_cvt_pk_bf16_f32 v250, v252, v253
v_exp_f32 v218, v218
v_exp_f32 v219, v219
s_nop 0
v_cvt_pk_bf16_f32 v251, v254, v255
v_cvt_pk_bf16_f32 v216, v216, v217
v_exp_f32 v220, v220
v_exp_f32 v221, v221
s_nop 0
v_cvt_pk_bf16_f32 v217, v218, v219
v_exp_f32 v222, v222
s_nop 0
v_cvt_pk_bf16_f32 v218, v220, v221
v_exp_f32 v223, v223
s_nop 0
v_cvt_pk_bf16_f32 v219, v222, v223
s_nop 1
v_mfma_f32_16x16x32_bf16 v[60:63], v[28:31], v[216:219], v[60:63]
v_mov_b32 v26, v56
v_mov_b32 v19, v26
s_nop 1
v_mfma_f32_16x16x32_bf16 v[60:63], v[28:31], v[248:251], v[60:63]
v_permlane32_swap_b32 v26, v19
s_nop 1
v_mfma_f32_16x16x32_bf16 a[96:99], a[128:131], v[216:219], a[96:99]
v_add_f32 v26, v26, v19
v_mov_b32 v19, v26
s_nop 1
v_mfma_f32_16x16x32_bf16 a[96:99], a[132:135], v[248:251], a[96:99]
v_permlane16_swap_b32 v26, v19
s_nop 1
v_mfma_f32_16x16x32_bf16 a[100:103], a[140:143], v[248:251], a[100:103]
v_add_f32 v26, v26, v19
v_mfma_f32_16x16x32_bf16 a[100:103], a[136:139], v[216:219], a[100:103]
v_rcp_f32 v26, v26
v_mfma_f32_16x16x32_bf16 a[104:107], a[144:147], v[216:219], a[104:107]
v_accvgpr_read_b32 v2, a64
v_accvgpr_read_b32 v3, a65
v_mfma_f32_16x16x32_bf16 a[104:107], a[148:151], v[248:251], a[104:107]
v_accvgpr_read_b32 v4, a66
v_accvgpr_read_b32 v5, a67
v_mfma_f32_16x16x32_bf16 a[108:111], a[156:159], v[248:251], a[108:111]
v_accvgpr_read_b32 v6, a68
v_accvgpr_read_b32 v7, a69
v_mfma_f32_16x16x32_bf16 a[108:111], a[152:155], v[216:219], a[108:111]
v_accvgpr_read_b32 v8, a70
v_accvgpr_read_b32 v9, a71
v_mfma_f32_16x16x32_bf16 a[112:115], a[160:163], v[216:219], a[112:115]
v_mul_f32 v2, v2, v26
v_mul_f32 v3, v3, v26
v_mfma_f32_16x16x32_bf16 a[112:115], a[164:167], v[248:251], a[112:115]
v_mul_f32 v4, v4, v26
v_mul_f32 v5, v5, v26
v_mfma_f32_16x16x32_bf16 a[116:119], a[172:175], v[248:251], a[116:119]
v_mul_f32 v6, v6, v26
v_mul_f32 v7, v7, v26
v_mfma_f32_16x16x32_bf16 a[116:119], a[168:171], v[216:219], a[116:119]
v_mul_f32 v8, v8, v26
v_mul_f32 v9, v9, v26
v_mfma_f32_16x16x32_bf16 a[120:123], a[176:179], v[216:219], a[120:123]
v_cvt_pk_bf16_f32 v212, v2, v3
v_cvt_pk_bf16_f32 v213, v4, v5
v_mfma_f32_16x16x32_bf16 a[120:123], a[180:183], v[248:251], a[120:123]
v_cvt_pk_bf16_f32 v214, v6, v7
v_cvt_pk_bf16_f32 v215, v8, v9
s_mov_b32 s52, 262144
v_mfma_f32_16x16x32_bf16 a[124:127], a[188:191], v[248:251], a[124:127]
buffer_store_dwordx4 v[212:215], v22, s[20:23], s52 offen offset:0 sc1
v_mfma_f32_16x16x32_bf16 a[124:127], a[184:187], v[216:219], a[124:127]
v_accvgpr_read_b32 v10, a72
v_accvgpr_read_b32 v11, a73
s_nop 7
v_accvgpr_read_b32 v12, a74
v_accvgpr_read_b32 v13, a75
v_accvgpr_read_b32 v14, a76
v_accvgpr_read_b32 v15, a77
v_accvgpr_read_b32 v16, a78
v_accvgpr_read_b32 v17, a79
v_pk_mul_f32 v[10:11], v[10:11], v[26:27] op_sel_hi:[1,0]
v_pk_mul_f32 v[12:13], v[12:13], v[26:27] op_sel_hi:[1,0]
v_pk_mul_f32 v[14:15], v[14:15], v[26:27] op_sel_hi:[1,0]
v_pk_mul_f32 v[16:17], v[16:17], v[26:27] op_sel_hi:[1,0]
v_cvt_pk_bf16_f32 v208, v10, v11
v_cvt_pk_bf16_f32 v209, v12, v13
v_cvt_pk_bf16_f32 v210, v14, v15
v_cvt_pk_bf16_f32 v211, v16, v17
s_mov_b32 s52, 262144
buffer_store_dwordx4 v[208:211], v22, s[20:23], s52 offen offset:2048 sc1
v_accvgpr_read_b32 v2, a80
v_accvgpr_read_b32 v3, a81
v_accvgpr_read_b32 v4, a82
v_accvgpr_read_b32 v5, a83
v_accvgpr_read_b32 v6, a84
v_accvgpr_read_b32 v7, a85
v_accvgpr_read_b32 v8, a86
v_accvgpr_read_b32 v9, a87
v_pk_mul_f32 v[2:3], v[2:3], v[26:27] op_sel_hi:[1,0]
v_pk_mul_f32 v[4:5], v[4:5], v[26:27] op_sel_hi:[1,0]
v_pk_mul_f32 v[6:7], v[6:7], v[26:27] op_sel_hi:[1,0]
v_pk_mul_f32 v[8:9], v[8:9], v[26:27] op_sel_hi:[1,0]
v_cvt_pk_bf16_f32 v244, v2, v3
v_cvt_pk_bf16_f32 v245, v4, v5
v_cvt_pk_bf16_f32 v246, v6, v7
v_cvt_pk_bf16_f32 v247, v8, v9
s_mov_b32 s52, 266240
buffer_store_dwordx4 v[244:247], v22, s[20:23], s52 offen offset:0 sc1
v_accvgpr_read_b32 v10, a88
v_accvgpr_read_b32 v11, a89
v_accvgpr_read_b32 v12, a90
v_accvgpr_read_b32 v13, a91
v_accvgpr_read_b32 v14, a92
v_accvgpr_read_b32 v15, a93
v_accvgpr_read_b32 v16, a94
v_accvgpr_read_b32 v17, a95
v_pk_mul_f32 v[10:11], v[10:11], v[26:27] op_sel_hi:[1,0]
v_pk_mul_f32 v[12:13], v[12:13], v[26:27] op_sel_hi:[1,0]
v_pk_mul_f32 v[14:15], v[14:15], v[26:27] op_sel_hi:[1,0]
v_pk_mul_f32 v[16:17], v[16:17], v[26:27] op_sel_hi:[1,0]
v_cvt_pk_bf16_f32 v240, v10, v11
v_cvt_pk_bf16_f32 v241, v12, v13
v_cvt_pk_bf16_f32 v242, v14, v15
v_cvt_pk_bf16_f32 v243, v16, v17
s_mov_b32 s52, 266240
buffer_store_dwordx4 v[240:243], v22, s[20:23], s52 offen offset:2048 sc1
v_mov_b32 v27, v60
v_mov_b32 v19, v27
s_nop 1
v_permlane32_swap_b32 v27, v19
s_nop 1
v_add_f32 v27, v27, v19
v_mov_b32 v19, v27
s_nop 1
v_permlane16_swap_b32 v27, v19
s_nop 1
v_add_f32 v27, v27, v19
v_rcp_f32 v27, v27
v_accvgpr_read_b32 v2, a96
v_accvgpr_read_b32 v3, a97
v_accvgpr_read_b32 v4, a98
v_accvgpr_read_b32 v5, a99
v_accvgpr_read_b32 v6, a100
v_accvgpr_read_b32 v7, a101
v_accvgpr_read_b32 v8, a102
v_accvgpr_read_b32 v9, a103
v_pk_mul_f32 v[2:3], v[2:3], v[26:27] op_sel:[0,1] op_sel_hi:[1,1]
v_pk_mul_f32 v[4:5], v[4:5], v[26:27] op_sel:[0,1] op_sel_hi:[1,1]
v_pk_mul_f32 v[6:7], v[6:7], v[26:27] op_sel:[0,1] op_sel_hi:[1,1]
v_pk_mul_f32 v[8:9], v[8:9], v[26:27] op_sel:[0,1] op_sel_hi:[1,1]
v_cvt_pk_bf16_f32 v220, v2, v3
v_cvt_pk_bf16_f32 v221, v4, v5
v_cvt_pk_bf16_f32 v222, v6, v7
v_cvt_pk_bf16_f32 v223, v8, v9
s_mov_b32 s52, 262144
buffer_store_dwordx4 v[220:223], v22, s[20:23], s52 offen offset:1024 sc1
v_accvgpr_read_b32 v10, a104
v_accvgpr_read_b32 v11, a105
v_accvgpr_read_b32 v12, a106
v_accvgpr_read_b32 v13, a107
v_accvgpr_read_b32 v14, a108
v_accvgpr_read_b32 v15, a109
v_accvgpr_read_b32 v16, a110
v_accvgpr_read_b32 v17, a111
v_pk_mul_f32 v[10:11], v[10:11], v[26:27] op_sel:[0,1] op_sel_hi:[1,1]
v_pk_mul_f32 v[12:13], v[12:13], v[26:27] op_sel:[0,1] op_sel_hi:[1,1]
v_pk_mul_f32 v[14:15], v[14:15], v[26:27] op_sel:[0,1] op_sel_hi:[1,1]
v_pk_mul_f32 v[16:17], v[16:17], v[26:27] op_sel:[0,1] op_sel_hi:[1,1]
v_cvt_pk_bf16_f32 v216, v10, v11
v_cvt_pk_bf16_f32 v217, v12, v13
v_cvt_pk_bf16_f32 v218, v14, v15
v_cvt_pk_bf16_f32 v219, v16, v17
s_mov_b32 s52, 262144
buffer_store_dwordx4 v[216:219], v22, s[20:23], s52 offen offset:3072 sc1
v_accvgpr_read_b32 v2, a112
v_accvgpr_read_b32 v3, a113
v_accvgpr_read_b32 v4, a114
v_accvgpr_read_b32 v5, a115
v_accvgpr_read_b32 v6, a116
v_accvgpr_read_b32 v7, a117
v_accvgpr_read_b32 v8, a118
v_accvgpr_read_b32 v9, a119
v_pk_mul_f32 v[2:3], v[2:3], v[26:27] op_sel:[0,1] op_sel_hi:[1,1]
v_pk_mul_f32 v[4:5], v[4:5], v[26:27] op_sel:[0,1] op_sel_hi:[1,1]
v_pk_mul_f32 v[6:7], v[6:7], v[26:27] op_sel:[0,1] op_sel_hi:[1,1]
v_pk_mul_f32 v[8:9], v[8:9], v[26:27] op_sel:[0,1] op_sel_hi:[1,1]
v_cvt_pk_bf16_f32 v252, v2, v3
v_cvt_pk_bf16_f32 v253, v4, v5
v_cvt_pk_bf16_f32 v254, v6, v7
v_cvt_pk_bf16_f32 v255, v8, v9
s_mov_b32 s52, 266240
buffer_store_dwordx4 v[252:255], v22, s[20:23], s52 offen offset:1024 sc1
v_accvgpr_read_b32 v10, a120
v_accvgpr_read_b32 v11, a121
v_accvgpr_read_b32 v12, a122
v_accvgpr_read_b32 v13, a123
v_accvgpr_read_b32 v14, a124
v_accvgpr_read_b32 v15, a125
v_accvgpr_read_b32 v16, a126
v_accvgpr_read_b32 v17, a127
v_pk_mul_f32 v[10:11], v[10:11], v[26:27] op_sel:[0,1] op_sel_hi:[1,1]
v_pk_mul_f32 v[12:13], v[12:13], v[26:27] op_sel:[0,1] op_sel_hi:[1,1]
v_pk_mul_f32 v[14:15], v[14:15], v[26:27] op_sel:[0,1] op_sel_hi:[1,1]
v_pk_mul_f32 v[16:17], v[16:17], v[26:27] op_sel:[0,1] op_sel_hi:[1,1]
v_cvt_pk_bf16_f32 v248, v10, v11
v_cvt_pk_bf16_f32 v249, v12, v13
v_cvt_pk_bf16_f32 v250, v14, v15
v_cvt_pk_bf16_f32 v251, v16, v17
s_mov_b32 s52, 266240
buffer_store_dwordx4 v[248:251], v22, s[20:23], s52 offen offset:3072 sc1
v_mov_b32 v19, 1
v_and_b32 v24, 7, v0
v_lshlrev_b32 v24, 7, v24
v_add_u32 v1, 0x10000, v22
s_mov_b32 s45, 0
s_lshl_b32 s52, s24, 14
v_add_u32 v10, s52, v22
ds_write_b128 v10, v[196:199] offset:0
ds_write_b128 v10, v[192:195] offset:2048
ds_write_b128 v10, v[228:231] offset:4096
ds_write_b128 v10, v[224:227] offset:6144
ds_write_b128 v10, v[204:207] offset:1024
ds_write_b128 v10, v[200:203] offset:3072
ds_write_b128 v10, v[236:239] offset:5120
ds_write_b128 v10, v[232:235] offset:7168
ds_write_b128 v10, v[212:215] offset:8192
ds_write_b128 v10, v[208:211] offset:10240
ds_write_b128 v10, v[244:247] offset:12288
ds_write_b128 v10, v[240:243] offset:14336
ds_write_b128 v10, v[220:223] offset:9216
ds_write_b128 v10, v[216:219] offset:11264
ds_write_b128 v10, v[252:255] offset:13312
ds_write_b128 v10, v[248:251] offset:15360
s_and_b32 s53, s26, 1
s_lshl_b32 s53, s53, 15
s_add_u32 s52, s29, 1
s_and_b32 s52, s52, 3
s_lshl_b32 s52, s52, 13
s_add_u32 s52, s52, s53
v_add_u32 v11, s52, v22
s_add_u32 s52, s29, 2
s_and_b32 s52, s52, 3
s_lshl_b32 s52, s52, 13
s_add_u32 s52, s52, s53
v_add_u32 v12, s52, v22
s_add_u32 s52, s29, 3
s_and_b32 s52, s52, 3
s_lshl_b32 s52, s52, 13
s_add_u32 s52, s52, s53
v_add_u32 v13, s52, v22
s_add_u32 s52, s29, 4
s_and_b32 s52, s52, 3
s_lshl_b32 s52, s52, 13
s_add_u32 s52, s52, s53
v_add_u32 v14, s52, v22
s_waitcnt vmcnt(36) lgkmcnt(0)
s_barrier
ds_read_b128 a[0:3], v11 offset:0
ds_read_b128 a[8:11], v11 offset:2048
ds_read_b128 a[16:19], v11 offset:4096
ds_read_b128 a[24:27], v11 offset:6144
ds_read_b128 a[4:7], v11 offset:1024
ds_read_b128 a[12:15], v11 offset:3072
ds_read_b128 a[20:23], v11 offset:5120
ds_read_b128 a[28:31], v11 offset:7168
s_waitcnt lgkmcnt(4)
v_mfma_f32_16x16x32_bf16 v[192:195], a[192:195], a[0:3], 0
ds_read_b128 a[32:35], v12 offset:0
ds_read_b128 a[40:43], v12 offset:2048
v_mfma_f32_16x16x32_bf16 v[192:195], a[200:203], a[8:11], v[192:195]
v_mfma_f32_16x16x32_bf16 v[192:195], a[208:211], a[16:19], v[192:195]
ds_read_b128 a[48:51], v12 offset:4096
ds_read_b128 a[56:59], v12 offset:6144
v_mfma_f32_16x16x32_bf16 v[192:195], a[216:219], a[24:27], v[192:195]
v_mfma_f32_16x16x32_bf16 v[196:199], a[220:223], a[24:27], 0
ds_read_b128 a[36:39], v12 offset:1024
ds_read_b128 a[44:47], v12 offset:3072
v_mfma_f32_16x16x32_bf16 v[196:199], a[212:215], a[16:19], v[196:199]
v_mfma_f32_16x16x32_bf16 v[196:199], a[204:207], a[8:11], v[196:199]
ds_read_b128 a[52:55], v12 offset:5120
ds_read_b128 a[60:63], v12 offset:7168
v_mfma_f32_16x16x32_bf16 v[196:199], a[196:199], a[0:3], v[196:199]
s_waitcnt lgkmcnt(8)
v_mfma_f32_16x16x32_bf16 v[204:207], a[196:199], a[4:7], 0
v_mfma_f32_16x16x32_bf16 v[204:207], a[204:207], a[12:15], v[204:207]
v_mfma_f32_16x16x32_bf16 v[204:207], a[212:215], a[20:23], v[204:207]
v_mfma_f32_16x16x32_bf16 v[204:207], a[220:223], a[28:31], v[204:207]
v_mfma_f32_16x16x32_bf16 v[200:203], a[216:219], a[28:31], 0
v_mfma_f32_16x16x32_bf16 v[200:203], a[208:211], a[20:23], v[200:203]
v_mfma_f32_16x16x32_bf16 v[200:203], a[200:203], a[12:15], v[200:203]
v_mfma_f32_16x16x32_bf16 v[200:203], a[192:195], a[4:7], v[200:203]
s_waitcnt lgkmcnt(4)
v_mfma_f32_16x16x32_bf16 v[208:211], a[192:195], a[32:35], 0
ds_read_b128 a[0:3], v13 offset:0
ds_read_b128 a[8:11], v13 offset:2048
v_mfma_f32_16x16x32_bf16 v[208:211], a[200:203], a[40:43], v[208:211]
v_mfma_f32_16x16x32_bf16 v[208:211], a[208:211], a[48:51], v[208:211]
ds_read_b128 a[16:19], v13 offset:4096
ds_read_b128 a[24:27], v13 offset:6144
v_mfma_f32_16x16x32_bf16 v[208:211], a[216:219], a[56:59], v[208:211]
v_mfma_f32_16x16x32_bf16 v[212:215], a[220:223], a[56:59], 0
ds_read_b128 a[4:7], v13 offset:1024
ds_read_b128 a[12:15], v13 offset:3072
v_mfma_f32_16x16x32_bf16 v[212:215], a[212:215], a[48:51], v[212:215]
v_mfma_f32_16x16x32_bf16 v[212:215], a[204:207], a[40:43], v[212:215]
ds_read_b128 a[20:23], v13 offset:5120
ds_read_b128 a[28:31], v13 offset:7168
v_mfma_f32_16x16x32_bf16 v[212:215], a[196:199], a[32:35], v[212:215]
s_waitcnt lgkmcnt(8)
v_mfma_f32_16x16x32_bf16 v[220:223], a[196:199], a[36:39], 0
v_mfma_f32_16x16x32_bf16 v[220:223], a[204:207], a[44:47], v[220:223]
v_mfma_f32_16x16x32_bf16 v[220:223], a[212:215], a[52:55], v[220:223]
v_mfma_f32_16x16x32_bf16 v[220:223], a[220:223], a[60:63], v[220:223]
v_mfma_f32_16x16x32_bf16 v[216:219], a[216:219], a[60:63], 0
v_mfma_f32_16x16x32_bf16 v[216:219], a[208:211], a[52:55], v[216:219]
v_mfma_f32_16x16x32_bf16 v[216:219], a[200:203], a[44:47], v[216:219]
v_mfma_f32_16x16x32_bf16 v[216:219], a[192:195], a[36:39], v[216:219]
s_waitcnt vmcnt(0)
s_barrier
buffer_atomic_add v19, v21, s[36:39], 0 offen sc1
s_waitcnt lgkmcnt(4)
v_mfma_f32_16x16x32_bf16 v[224:227], a[192:195], a[0:3], 0
ds_read_b128 a[32:35], v14 offset:0
ds_read_b128 a[40:43], v14 offset:2048
v_mfma_f32_16x16x32_bf16 v[224:227], a[200:203], a[8:11], v[224:227]
s_add_u32 s48, s60, 4096
buffer_load_dwordx4 v[132:135], v21, s[4:7], s48 offen offset:0 sc1
v_mfma_f32_16x16x32_bf16 v[224:227], a[208:211], a[16:19], v[224:227]
ds_read_b128 a[48:51], v14 offset:4096
ds_read_b128 a[56:59], v14 offset:6144
v_mfma_f32_16x16x32_bf16 v[224:227], a[216:219], a[24:27], v[224:227]
buffer_load_dwordx4 v[140:143], v21, s[4:7], s48 offen offset:1024 sc1
v_mfma_f32_16x16x32_bf16 v[228:231], a[220:223], a[24:27], 0
ds_read_b128 a[36:39], v14 offset:1024
ds_read_b128 a[44:47], v14 offset:3072
v_mfma_f32_16x16x32_bf16 v[228:231], a[212:215], a[16:19], v[228:231]
buffer_load_dwordx4 v[148:151], v21, s[4:7], s48 offen offset:2048 sc1
v_mfma_f32_16x16x32_bf16 v[228:231], a[204:207], a[8:11], v[228:231]
ds_read_b128 a[52:55], v14 offset:5120
ds_read_b128 a[60:63], v14 offset:7168
v_mfma_f32_16x16x32_bf16 v[228:231], a[196:199], a[0:3], v[228:231]
s_waitcnt lgkmcnt(8)
v_mfma_f32_16x16x32_bf16 v[236:239], a[196:199], a[4:7], 0
v_mfma_f32_16x16x32_bf16 v[236:239], a[204:207], a[12:15], v[236:239]
buffer_load_dwordx4 v[156:159], v21, s[4:7], s48 offen offset:3072 sc1
v_mfma_f32_16x16x32_bf16 v[236:239], a[212:215], a[20:23], v[236:239]
s_add_u32 s48, s61, 0
buffer_load_dwordx4 v[164:167], v21, s[4:7], s48 offen offset:0 sc1
v_mfma_f32_16x16x32_bf16 v[236:239], a[220:223], a[28:31], v[236:239]
buffer_load_dwordx4 v[172:175], v21, s[4:7], s48 offen offset:1024 sc1
v_mfma_f32_16x16x32_bf16 v[232:235], a[216:219], a[28:31], 0
v_mfma_f32_16x16x32_bf16 v[232:235], a[208:211], a[20:23], v[232:235]
buffer_load_dwordx4 v[180:183], v21, s[4:7], s48 offen offset:2048 sc1
v_mfma_f32_16x16x32_bf16 v[232:235], a[200:203], a[12:15], v[232:235]
buffer_load_dwordx4 v[188:191], v21, s[4:7], s48 offen offset:3072 sc1
v_mfma_f32_16x16x32_bf16 v[232:235], a[192:195], a[4:7], v[232:235]
s_waitcnt lgkmcnt(4)
v_mfma_f32_16x16x32_bf16 v[240:243], a[192:195], a[32:35], 0
v_mfma_f32_16x16x32_bf16 v[240:243], a[200:203], a[40:43], v[240:243]
s_add_u32 s48, s61, 4096
buffer_load_dwordx4 v[128:131], v21, s[4:7], s48 offen offset:0 sc1
v_mfma_f32_16x16x32_bf16 v[240:243], a[208:211], a[48:51], v[240:243]
v_mfma_f32_16x16x32_bf16 v[240:243], a[216:219], a[56:59], v[240:243]
buffer_load_dwordx4 v[136:139], v21, s[4:7], s48 offen offset:1024 sc1
v_mfma_f32_16x16x32_bf16 v[244:247], a[220:223], a[56:59], 0
v_mfma_f32_16x16x32_bf16 v[244:247], a[212:215], a[48:51], v[244:247]
buffer_load_dwordx4 v[144:147], v21, s[4:7], s48 offen offset:2048 sc1
v_mfma_f32_16x16x32_bf16 v[244:247], a[204:207], a[40:43], v[244:247]
v_mfma_f32_16x16x32_bf16 v[244:247], a[196:199], a[32:35], v[244:247]
s_waitcnt lgkmcnt(0)
v_mfma_f32_16x16x32_bf16 v[252:255], a[196:199], a[36:39], 0
v_mfma_f32_16x16x32_bf16 v[252:255], a[204:207], a[44:47], v[252:255]
buffer_load_dwordx4 v[152:155], v21, s[4:7], s48 offen offset:3072 sc1
v_mfma_f32_16x16x32_bf16 v[252:255], a[212:215], a[52:55], v[252:255]
s_add_u32 s48, s62, 0
buffer_load_dwordx4 v[160:163], v21, s[4:7], s48 offen offset:0 sc1
v_mfma_f32_16x16x32_bf16 v[252:255], a[220:223], a[60:63], v[252:255]
buffer_load_dwordx4 v[168:171], v21, s[4:7], s48 offen offset:1024 sc1
v_mfma_f32_16x16x32_bf16 v[248:251], a[216:219], a[60:63], 0
v_mfma_f32_16x16x32_bf16 v[248:251], a[208:211], a[52:55], v[248:251]
buffer_load_dwordx4 v[176:179], v21, s[4:7], s48 offen offset:2048 sc1
v_mfma_f32_16x16x32_bf16 v[248:251], a[200:203], a[44:47], v[248:251]
buffer_load_dwordx4 v[184:187], v21, s[4:7], s48 offen offset:3072 sc1
v_mfma_f32_16x16x32_bf16 v[248:251], a[192:195], a[36:39], v[248:251]
s_add_u32 s48, s62, 4096
buffer_load_dwordx4 a[128:131], v21, s[4:7], s48 offen offset:0 sc1
buffer_load_dwordx4 a[132:135], v21, s[4:7], s48 offen offset:1024 sc1
buffer_load_dwordx4 a[136:139], v21, s[4:7], s48 offen offset:2048 sc1
buffer_load_dwordx4 a[140:143], v21, s[4:7], s48 offen offset:3072 sc1
s_add_u32 s48, s63, 0
buffer_load_dwordx4 a[144:147], v21, s[4:7], s48 offen offset:0 sc1
buffer_load_dwordx4 a[148:151], v21, s[4:7], s48 offen offset:1024 sc1
buffer_load_dwordx4 a[152:155], v21, s[4:7], s48 offen offset:2048 sc1
buffer_load_dwordx4 a[156:159], v21, s[4:7], s48 offen offset:3072 sc1
s_add_u32 s48, s63, 4096
buffer_load_dwordx4 a[160:163], v21, s[4:7], s48 offen offset:0 sc1
buffer_load_dwordx4 a[164:167], v21, s[4:7], s48 offen offset:1024 sc1
buffer_load_dwordx4 a[168:171], v21, s[4:7], s48 offen offset:2048 sc1
buffer_load_dwordx4 a[172:175], v21, s[4:7], s48 offen offset:3072 sc1
s_cmp_lg_u32 s24, 1
s_cbranch_scc1 L_go
L_poll:
buffer_load_dword v24, off, s[36:39], 0 sc1
s_waitcnt vmcnt(0)
v_cmp_ne_u32 vcc, 8, v24
s_cbranch_vccz L_go
s_add_u32 s45, s45, 1
s_cmp_lt_u32 s45, 200000
s_cbranch_scc1 L_poll
L_go:
s_barrier
L_acq_back:
s_add_u32 s30, s29, 1
s_and_b32 s30, s30, 3
s_lshl_b32 s30, s30, 18
s_add_u32 s30, s30, s96
s_add_u32 s48, s30, s57
s_add_u32 m0, s96, 65536
s_nop 0
buffer_load_dwordx4 v22, s[8:11], s48 offen offset:0 sc1 lds
buffer_load_dwordx4 v22, s[8:11], s48 offen offset:1024 sc1 lds
s_add_u32 s48, s30, s58
s_add_u32 m0, s96, 73728
s_nop 0
buffer_load_dwordx4 v22, s[8:11], s48 offen offset:0 sc1 lds
buffer_load_dwordx4 v22, s[8:11], s48 offen offset:1024 sc1 lds
s_add_u32 s48, s30, s59
s_add_u32 m0, s96, 81920
s_nop 0
buffer_load_dwordx4 v22, s[8:11], s48 offen offset:0 sc1 lds
buffer_load_dwordx4 v22, s[8:11], s48 offen offset:1024 sc1 lds
s_add_u32 s48, s30, s60
s_add_u32 m0, s96, 90112
s_nop 0
buffer_load_dwordx4 v22, s[8:11], s48 offen offset:0 sc1 lds
buffer_load_dwordx4 v22, s[8:11], s48 offen offset:1024 sc1 lds
s_add_u32 s48, s30, s61
s_add_u32 m0, s96, 98304
s_nop 0
buffer_load_dwordx4 v22, s[8:11], s48 offen offset:0 sc1 lds
buffer_load_dwordx4 v22, s[8:11], s48 offen offset:1024 sc1 lds
s_add_u32 s48, s30, s62
s_add_u32 m0, s96, 106496
s_nop 0
buffer_load_dwordx4 v22, s[8:11], s48 offen offset:0 sc1 lds
buffer_load_dwordx4 v22, s[8:11], s48 offen offset:1024 sc1 lds
s_add_u32 s48, s30, s63
s_add_u32 m0, s96, 114688
s_nop 0
buffer_load_dwordx4 v22, s[8:11], s48 offen offset:0 sc1 lds
buffer_load_dwordx4 v22, s[8:11], s48 offen offset:1024 sc1 lds
s_add_u32 s30, s29, 2
s_and_b32 s30, s30, 3
s_lshl_b32 s30, s30, 18
s_add_u32 s30, s30, s96
s_add_u32 s48, s30, s57
s_add_u32 m0, s96, 122880
s_nop 0
buffer_load_dwordx4 v22, s[8:11], s48 offen offset:0 sc1 lds
buffer_load_dwordx4 v22, s[8:11], s48 offen offset:1024 sc1 lds
s_waitcnt vmcnt(12)
s_barrier
ds_read_b128 a[0:3], v1 offset:0
ds_read_b128 a[8:11], v1 offset:2048
ds_read_b128 a[16:19], v1 offset:4096
ds_read_b128 a[24:27], v1 offset:6144
ds_read_b128 a[4:7], v1 offset:1024
ds_read_b128 a[12:15], v1 offset:3072
ds_read_b128 a[20:23], v1 offset:5120
ds_read_b128 a[28:31], v1 offset:7168
s_waitcnt lgkmcnt(4)
v_mfma_f32_16x16x32_bf16 v[192:195], a[224:227], a[0:3], v[192:195]
v_mfma_f32_16x16x32_bf16 v[192:195], a[232:235], a[8:11], v[192:195]
ds_read_b128 a[32:35], v1 offset:8192
ds_read_b128 a[40:43], v1 offset:10240
v_mfma_f32_16x16x32_bf16 v[192:195], a[240:243], a[16:19], v[192:195]
v_mfma_f32_16x16x32_bf16 v[192:195], a[248:251], a[24:27], v[192:195]
s_add_u32 s48, s30, s58
ds_read_b128 a[48:51], v1 offset:12288
ds_read_b128 a[56:59], v1 offset:14336
v_mfma_f32_16x16x32_bf16 v[196:199], a[252:255], a[24:27], v[196:199]
s_add_u32 m0, s96, 0
v_mfma_f32_16x16x32_bf16 v[196:199], a[244:247], a[16:19], v[196:199]
buffer_load_dwordx4 v22, s[8:11], s48 offen offset:0 sc1 lds
v_mfma_f32_16x16x32_bf16 v[196:199], a[236:239], a[8:11], v[196:199]
ds_read_b128 a[36:39], v1 offset:9216
ds_read_b128 a[44:47], v1 offset:11264
v_mfma_f32_16x16x32_bf16 v[196:199], a[228:231], a[0:3], v[196:199]
s_waitcnt lgkmcnt(6)
v_mfma_f32_16x16x32_bf16 v[204:207], a[228:231], a[4:7], v[204:207]
ds_read_b128 a[52:55], v1 offset:13312
ds_read_b128 a[60:63], v1 offset:15360
v_mfma_f32_16x16x32_bf16 v[204:207], a[236:239], a[12:15], v[204:207]
v_mfma_f32_16x16x32_bf16 v[204:207], a[244:247], a[20:23], v[204:207]
v_mfma_f32_16x16x32_bf16 v[204:207], a[252:255], a[28:31], v[204:207]
v_mfma_f32_16x16x32_bf16 v[200:203], a[248:251], a[28:31], v[200:203]
buffer_load_dwordx4 v22, s[8:11], s48 offen offset:1024 sc1 lds
v_mfma_f32_16x16x32_bf16 v[200:203], a[240:243], a[20:23], v[200:203]
v_mfma_f32_16x16x32_bf16 v[200:203], a[232:235], a[12:15], v[200:203]
v_mfma_f32_16x16x32_bf16 v[200:203], a[224:227], a[4:7], v[200:203]
s_waitcnt lgkmcnt(4)
s_waitcnt vmcnt(10)
v_mfma_f32_16x16x32_bf16 v[192:195], v[64:67], a[32:35], v[192:195]
s_barrier
v_mfma_f32_16x16x32_bf16 v[192:195], v[72:75], a[40:43], v[192:195]
ds_read_b128 a[0:3], v1 offset:16384
ds_read_b128 a[8:11], v1 offset:18432
v_mfma_f32_16x16x32_bf16 v[192:195], v[80:83], a[48:51], v[192:195]
v_mfma_f32_16x16x32_bf16 v[192:195], v[88:91], a[56:59], v[192:195]
s_add_u32 s48, s30, s59
ds_read_b128 a[16:19], v1 offset:20480
ds_read_b128 a[24:27], v1 offset:22528
v_mfma_f32_16x16x32_bf16 v[196:199], v[92:95], a[56:59], v[196:199]
s_add_u32 m0, s96, 8192
v_and_b32 v10, 15, v0
v_lshrrev_b32 v11, 4, v0
v_mfma_f32_16x16x32_bf16 v[196:199], v[84:87], a[48:51], v[196:199]
buffer_load_dwordx4 v22, s[8:11], s48 offen offset:0 sc1 lds
v_mfma_f32_16x16x32_bf16 v[196:199], v[76:79], a[40:43], v[196:199]
ds_read_b128 a[4:7], v1 offset:17408
ds_read_b128 a[12:15], v1 offset:19456
v_mfma_f32_16x16x32_bf16 v[196:199], v[68:71], a[32:35], v[196:199]
s_waitcnt lgkmcnt(6)
v_lshlrev_b32 v11, 4, v11
v_lshl_add_u32 v18, v10, 10, v11
v_mfma_f32_16x16x32_bf16 v[204:207], v[68:71], a[36:39], v[204:207]
ds_read_b128 a[20:23], v1 offset:21504
ds_read_b128 a[28:31], v1 offset:23552
v_mfma_f32_16x16x32_bf16 v[204:207], v[76:79], a[44:47], v[204:207]
v_mfma_f32_16x16x32_bf16 v[204:207], v[84:87], a[52:55], v[204:207]
v_mfma_f32_16x16x32_bf16 v[204:207], v[92:95], a[60:63], v[204:207]
v_mfma_f32_16x16x32_bf16 v[200:203], v[88:91], a[60:63], v[200:203]
buffer_load_dwordx4 v22, s[8:11], s48 offen offset:1024 sc1 lds
v_mfma_f32_16x16x32_bf16 v[200:203], v[80:83], a[52:55], v[200:203]
v_mfma_f32_16x16x32_bf16 v[200:203], v[72:75], a[44:47], v[200:203]
v_mfma_f32_16x16x32_bf16 v[200:203], v[64:67], a[36:39], v[200:203]
s_waitcnt lgkmcnt(4)
v_mfma_f32_16x16x32_bf16 v[192:195], v[96:99], a[0:3], v[192:195]
v_mfma_f32_16x16x32_bf16 v[192:195], v[104:107], a[8:11], v[192:195]
ds_read_b128 a[32:35], v1 offset:24576
ds_read_b128 a[40:43], v1 offset:26624
v_mfma_f32_16x16x32_bf16 v[192:195], v[112:115], a[16:19], v[192:195]
v_mfma_f32_16x16x32_bf16 v[192:195], v[120:123], a[24:27], v[192:195]
s_add_u32 s48, s30, s60
ds_read_b128 a[48:51], v1 offset:28672
ds_read_b128 a[56:59], v1 offset:30720
v_mfma_f32_16x16x32_bf16 v[196:199], v[124:127], a[24:27], v[196:199]
s_add_u32 m0, s96, 16384
v_mfma_f32_16x16x32_bf16 v[196:199], v[116:119], a[16:19], v[196:199]
buffer_load_dwordx4 v22, s[8:11], s48 offen offset:0 sc1 lds
v_mfma_f32_16x16x32_bf16 v[196:199], v[108:111], a[8:11], v[196:199]
ds_read_b128 a[36:39], v1 offset:25600
ds_read_b128 a[44:47], v1 offset:27648
v_mfma_f32_16x16x32_bf16 v[196:199], v[100:103], a[0:3], v[196:199]
s_waitcnt lgkmcnt(6)
v_mfma_f32_16x16x32_bf16 v[204:207], v[100:103], a[4:7], v[204:207]
ds_read_b128 a[52:55], v1 offset:29696
ds_read_b128 a[60:63], v1 offset:31744
v_mfma_f32_16x16x32_bf16 v[204:207], v[108:111], a[12:15], v[204:207]
v_mfma_f32_16x16x32_bf16 v[204:207], v[116:119], a[20:23], v[204:207]
v_mfma_f32_16x16x32_bf16 v[204:207], v[124:127], a[28:31], v[204:207]
v_mfma_f32_16x16x32_bf16 v[200:203], v[120:123], a[28:31], v[200:203]
buffer_load_dwordx4 v22, s[8:11], s48 offen offset:1024 sc1 lds
v_mfma_f32_16x16x32_bf16 v[200:203], v[112:115], a[20:23], v[200:203]
v_mfma_f32_16x16x32_bf16 v[200:203], v[104:107], a[12:15], v[200:203]
v_mfma_f32_16x16x32_bf16 v[200:203], v[96:99], a[4:7], v[200:203]
s_waitcnt lgkmcnt(4)
s_waitcnt vmcnt(10)
v_mfma_f32_16x16x32_bf16 v[192:195], v[32:35], a[32:35], v[192:195]
s_barrier
v_mfma_f32_16x16x32_bf16 v[192:195], v[40:43], a[40:43], v[192:195]
ds_read_b128 a[0:3], v1 offset:32768
ds_read_b128 a[8:11], v1 offset:34816
v_mfma_f32_16x16x32_bf16 v[192:195], v[132:135], a[48:51], v[192:195]
v_mfma_f32_16x16x32_bf16 v[192:195], v[148:151], a[56:59], v[192:195]
s_add_u32 s48, s30, s61
ds_read_b128 a[16:19], v1 offset:36864
ds_read_b128 a[24:27], v1 offset:38912
v_mfma_f32_16x16x32_bf16 v[196:199], v[156:159], a[56:59], v[196:199]
s_add_u32 m0, s96, 24576
v_mfma_f32_16x16x32_bf16 v[196:199], v[140:143], a[48:51], v[196:199]
buffer_load_dwordx4 v22, s[8:11], s48 offen offset:0 sc1 lds
v_mfma_f32_16x16x32_bf16 v[196:199], v[44:47], a[40:43], v[196:199]
ds_read_b128 a[4:7], v1 offset:33792
ds_read_b128 a[12:15], v1 offset:35840
v_mfma_f32_16x16x32_bf16 v[196:199], v[36:39], a[32:35], v[196:199]
s_waitcnt lgkmcnt(6)
v_mfma_f32_16x16x32_bf16 v[204:207], v[36:39], a[36:39], v[204:207]
ds_read_b128 a[20:23], v1 offset:37888
ds_read_b128 a[28:31], v1 offset:39936
v_mfma_f32_16x16x32_bf16 v[204:207], v[44:47], a[44:47], v[204:207]
v_mfma_f32_16x16x32_bf16 v[204:207], v[140:143], a[52:55], v[204:207]
v_mfma_f32_16x16x32_bf16 v[204:207], v[156:159], a[60:63], v[204:207]
v_mfma_f32_16x16x32_bf16 v[200:203], v[148:151], a[60:63], v[200:203]
buffer_load_dwordx4 v22, s[8:11], s48 offen offset:1024 sc1 lds
v_mfma_f32_16x16x32_bf16 v[200:203], v[132:135], a[52:55], v[200:203]
v_mfma_f32_16x16x32_bf16 v[200:203], v[40:43], a[44:47], v[200:203]
v_mfma_f32_16x16x32_bf16 v[200:203], v[32:35], a[36:39], v[200:203]
s_waitcnt lgkmcnt(4)
v_mfma_f32_16x16x32_bf16 v[192:195], v[164:167], a[0:3], v[192:195]
v_mfma_f32_16x16x32_bf16 v[192:195], v[180:183], a[8:11], v[192:195]
ds_read_b128 a[32:35], v1 offset:40960
ds_read_b128 a[40:43], v1 offset:43008
v_mfma_f32_16x16x32_bf16 v[192:195], v[128:131], a[16:19], v[192:195]
v_mfma_f32_16x16x32_bf16 v[192:195], v[144:147], a[24:27], v[192:195]
s_add_u32 s48, s30, s62
ds_read_b128 a[48:51], v1 offset:45056
ds_read_b128 a[56:59], v1 offset:47104
v_mfma_f32_16x16x32_bf16 v[196:199], v[152:155], a[24:27], v[196:199]
s_add_u32 m0, s96, 32768
v_mfma_f32_16x16x32_bf16 v[196:199], v[136:139], a[16:19], v[196:199]
buffer_load_dwordx4 v22, s[8:11], s48 offen offset:0 sc1 lds
v_mfma_f32_16x16x32_bf16 v[196:199], v[188:191], a[8:11], v[196:199]
ds_read_b128 a[36:39], v1 offset:41984
ds_read_b128 a[44:47], v1 offset:44032
v_mfma_f32_16x16x32_bf16 v[196:199], v[172:175], a[0:3], v[196:199]
s_waitcnt lgkmcnt(6)
v_mfma_f32_16x16x32_bf16 v[204:207], v[172:175], a[4:7], v[204:207]
ds_read_b128 a[52:55], v1 offset:46080
ds_read_b128 a[60:63], v1 offset:48128
v_mfma_f32_16x16x32_bf16 v[204:207], v[188:191], a[12:15], v[204:207]
v_mfma_f32_16x16x32_bf16 v[204:207], v[136:139], a[20:23], v[204:207]
v_mfma_f32_16x16x32_bf16 v[204:207], v[152:155], a[28:31], v[204:207]
v_mfma_f32_16x16x32_bf16 v[200:203], v[144:147], a[28:31], v[200:203]
buffer_load_dwordx4 v22, s[8:11], s48 offen offset:1024 sc1 lds
v_mfma_f32_16x16x32_bf16 v[200:203], v[128:131], a[20:23], v[200:203]
v_mfma_f32_16x16x32_bf16 v[200:203], v[180:183], a[12:15], v[200:203]
v_mfma_f32_16x16x32_bf16 v[200:203], v[164:167], a[4:7], v[200:203]
s_waitcnt lgkmcnt(4)
s_waitcnt vmcnt(10)
v_mfma_f32_16x16x32_bf16 v[192:195], v[160:163], a[32:35], v[192:195]
s_barrier
v_mfma_f32_16x16x32_bf16 v[192:195], v[176:179], a[40:43], v[192:195]
ds_read_b128 a[0:3], v1 offset:49152
ds_read_b128 a[8:11], v1 offset:51200
v_mfma_f32_16x16x32_bf16 v[192:195], a[128:131], a[48:51], v[192:195]
v_mfma_f32_16x16x32_bf16 v[192:195], a[136:139], a[56:59], v[192:195]
s_add_u32 s48, s30, s63
ds_read_b128 a[16:19], v1 offset:53248
ds_read_b128 a[24:27], v1 offset:55296
v_mfma_f32_16x16x32_bf16 v[196:199], a[140:143], a[56:59], v[196:199]
s_add_u32 m0, s96, 40960
v_mfma_f32_16x16x32_bf16 v[196:199], a[132:135], a[48:51], v[196:199]
buffer_load_dwordx4 v22, s[8:11], s48 offen offset:0 sc1 lds
v_mfma_f32_16x16x32_bf16 v[196:199], v[184:187], a[40:43], v[196:199]
ds_read_b128 a[4:7], v1 offset:50176
ds_read_b128 a[12:15], v1 offset:52224
v_mfma_f32_16x16x32_bf16 v[196:199], v[168:171], a[32:35], v[196:199]
s_waitcnt lgkmcnt(6)
v_mfma_f32_16x16x32_bf16 v[204:207], v[168:171], a[36:39], v[204:207]
ds_read_b128 a[20:23], v1 offset:54272
ds_read_b128 a[28:31], v1 offset:56320
v_mfma_f32_16x16x32_bf16 v[204:207], v[184:187], a[44:47], v[204:207]
v_mfma_f32_16x16x32_bf16 v[204:207], a[132:135], a[52:55], v[204:207]
v_mfma_f32_16x16x32_bf16 v[204:207], a[140:143], a[60:63], v[204:207]
v_mfma_f32_16x16x32_bf16 v[200:203], a[136:139], a[60:63], v[200:203]
buffer_load_dwordx4 v22, s[8:11], s48 offen offset:1024 sc1 lds
v_mfma_f32_16x16x32_bf16 v[200:203], a[128:131], a[52:55], v[200:203]
v_mfma_f32_16x16x32_bf16 v[200:203], v[176:179], a[44:47], v[200:203]
s_add_u32 s30, s29, 3
v_mfma_f32_16x16x32_bf16 v[200:203], v[160:163], a[36:39], v[200:203]
s_waitcnt lgkmcnt(4)
v_mfma_f32_16x16x32_bf16 v[192:195], a[144:147], a[0:3], v[192:195]
s_and_b32 s30, s30, 3
v_mfma_f32_16x16x32_bf16 v[192:195], a[152:155], a[8:11], v[192:195]
s_lshl_b32 s30, s30, 18
ds_read_b128 a[32:35], v1 offset:57344
ds_read_b128 a[40:43], v1 offset:59392
v_mfma_f32_16x16x32_bf16 v[192:195], a[160:163], a[16:19], v[192:195]
s_add_u32 s30, s30, s96
v_mfma_f32_16x16x32_bf16 v[192:195], a[168:171], a[24:27], v[192:195]
s_add_u32 s48, s30, s57
ds_read_b128 a[48:51], v1 offset:61440
ds_read_b128 a[56:59], v1 offset:63488
v_mfma_f32_16x16x32_bf16 v[196:199], a[172:175], a[24:27], v[196:199]
s_add_u32 m0, s96, 49152
v_mfma_f32_16x16x32_bf16 v[196:199], a[164:167], a[16:19], v[196:199]
buffer_load_dwordx4 v22, s[8:11], s48 offen offset:0 sc1 lds
v_mfma_f32_16x16x32_bf16 v[196:199], a[156:159], a[8:11], v[196:199]
ds_read_b128 a[36:39], v1 offset:58368
ds_read_b128 a[44:47], v1 offset:60416
v_mfma_f32_16x16x32_bf16 v[196:199], a[148:151], a[0:3], v[196:199]
s_waitcnt lgkmcnt(6)
v_mfma_f32_16x16x32_bf16 v[204:207], a[148:151], a[4:7], v[204:207]
ds_read_b128 a[52:55], v1 offset:62464
ds_read_b128 a[60:63], v1 offset:64512
v_mfma_f32_16x16x32_bf16 v[204:207], a[156:159], a[12:15], v[204:207]
v_mfma_f32_16x16x32_bf16 v[204:207], a[164:167], a[20:23], v[204:207]
v_cvt_pk_bf16_f32 v2, v192, v193
v_cvt_pk_bf16_f32 v3, v194, v195
v_mfma_f32_16x16x32_bf16 v[204:207], a[172:175], a[28:31], v[204:207]
v_cvt_pk_bf16_f32 v4, v196, v197
v_cvt_pk_bf16_f32 v5, v198, v199
v_mfma_f32_16x16x32_bf16 v[200:203], a[168:171], a[28:31], v[200:203]
buffer_load_dwordx4 v22, s[8:11], s48 offen offset:1024 sc1 lds
v_mfma_f32_16x16x32_bf16 v[200:203], a[160:163], a[20:23], v[200:203]
s_add_u32 s49, s29, 1
s_and_b32 s49, s49, 3
s_lshl_b32 s49, s49, 19
s_nop 0
buffer_store_dwordx4 v[2:5], v21, s[80:83], s49 offen offset:0 sc1
v_mfma_f32_16x16x32_bf16 v[200:203], a[152:155], a[12:15], v[200:203]
v_mfma_f32_16x16x32_bf16 v[200:203], a[144:147], a[4:7], v[200:203]
s_waitcnt lgkmcnt(4)
s_waitcnt vmcnt(11)
v_mfma_f32_16x16x32_bf16 v[208:211], a[224:227], a[32:35], v[208:211]
s_barrier
v_mfma_f32_16x16x32_bf16 v[208:211], a[232:235], a[40:43], v[208:211]
ds_read_b128 a[0:3], v22 offset:0
ds_read_b128 a[8:11], v22 offset:2048
v_mfma_f32_16x16x32_bf16 v[208:211], a[240:243], a[48:51], v[208:211]
v_cvt_pk_bf16_f32 v6, v200, v201
v_cvt_pk_bf16_f32 v7, v202, v203
v_mfma_f32_16x16x32_bf16 v[208:211], a[248:251], a[56:59], v[208:211]
s_add_u32 s48, s30, s58
ds_read_b128 a[16:19], v22 offset:4096
ds_read_b128 a[24:27], v22 offset:6144
v_mfma_f32_16x16x32_bf16 v[212:215], a[252:255], a[56:59], v[212:215]
s_add_u32 m0, s96, 57344
v_cvt_pk_bf16_f32 v8, v204, v205
v_cvt_pk_bf16_f32 v9, v206, v207
v_mfma_f32_16x16x32_bf16 v[212:215], a[244:247], a[48:51], v[212:215]
buffer_load_dwordx4 v22, s[8:11], s48 offen offset:0 sc1 lds
v_mfma_f32_16x16x32_bf16 v[212:215], a[236:239], a[40:43], v[212:215]
ds_read_b128 a[4:7], v22 offset:1024
ds_read_b128 a[12:15], v22 offset:3072
v_mfma_f32_16x16x32_bf16 v[212:215], a[228:231], a[32:35], v[212:215]
s_waitcnt lgkmcnt(6)
buffer_store_dwordx4 v[6:9], v21, s[80:83], s49 offen offset:1024 sc1
v_mfma_f32_16x16x32_bf16 v[220:223], a[228:231], a[36:39], v[220:223]
ds_read_b128 a[20:23], v22 offset:5120
ds_read_b128 a[28:31], v22 offset:7168
v_mfma_f32_16x16x32_bf16 v[220:223], a[236:239], a[44:47], v[220:223]
v_mfma_f32_16x16x32_bf16 v[220:223], a[244:247], a[52:55], v[220:223]
v_mfma_f32_16x16x32_bf16 v[220:223], a[252:255], a[60:63], v[220:223]
v_mfma_f32_16x16x32_bf16 v[216:219], a[248:251], a[60:63], v[216:219]
buffer_load_dwordx4 v22, s[8:11], s48 offen offset:1024 sc1 lds
v_mfma_f32_16x16x32_bf16 v[216:219], a[240:243], a[52:55], v[216:219]
v_mfma_f32_16x16x32_bf16 v[216:219], a[232:235], a[44:47], v[216:219]
v_mfma_f32_16x16x32_bf16 v[216:219], a[224:227], a[36:39], v[216:219]
s_waitcnt lgkmcnt(4)
v_mfma_f32_16x16x32_bf16 v[208:211], v[64:67], a[0:3], v[208:211]
v_mfma_f32_16x16x32_bf16 v[208:211], v[72:75], a[8:11], v[208:211]
ds_read_b128 a[32:35], v22 offset:8192
ds_read_b128 a[40:43], v22 offset:10240
v_mfma_f32_16x16x32_bf16 v[208:211], v[80:83], a[16:19], v[208:211]
v_mfma_f32_16x16x32_bf16 v[208:211], v[88:91], a[24:27], v[208:211]
s_add_u32 s48, s30, s59
ds_read_b128 a[48:51], v22 offset:12288
ds_read_b128 a[56:59], v22 offset:14336
v_mfma_f32_16x16x32_bf16 v[212:215], v[92:95], a[24:27], v[212:215]
s_add_u32 m0, s96, 65536
v_mfma_f32_16x16x32_bf16 v[212:215], v[84:87], a[16:19], v[212:215]
buffer_load_dwordx4 v22, s[8:11], s48 offen offset:0 sc1 lds
v_mfma_f32_16x16x32_bf16 v[212:215], v[76:79], a[8:11], v[212:215]
ds_read_b128 a[36:39], v22 offset:9216
ds_read_b128 a[44:47], v22 offset:11264
v_mfma_f32_16x16x32_bf16 v[212:215], v[68:71], a[0:3], v[212:215]
s_waitcnt lgkmcnt(6)
v_mfma_f32_16x16x32_bf16 v[220:223], v[68:71], a[4:7], v[220:223]
ds_read_b128 a[52:55], v22 offset:13312
ds_read_b128 a[60:63], v22 offset:15360
v_mfma_f32_16x16x32_bf16 v[220:223], v[76:79], a[12:15], v[220:223]
v_mfma_f32_16x16x32_bf16 v[220:223], v[84:87], a[20:23], v[220:223]
v_mfma_f32_16x16x32_bf16 v[220:223], v[92:95], a[28:31], v[220:223]
v_mfma_f32_16x16x32_bf16 v[216:219], v[88:91], a[28:31], v[216:219]
buffer_load_dwordx4 v22, s[8:11], s48 offen offset:1024 sc1 lds
v_mfma_f32_16x16x32_bf16 v[216:219], v[80:83], a[20:23], v[216:219]
v_mfma_f32_16x16x32_bf16 v[216:219], v[72:75], a[12:15], v[216:219]
v_mfma_f32_16x16x32_bf16 v[216:219], v[64:67], a[4:7], v[216:219]
s_waitcnt lgkmcnt(4)
s_waitcnt vmcnt(12)
v_mfma_f32_16x16x32_bf16 v[208:211], v[96:99], a[32:35], v[208:211]
s_barrier
v_mfma_f32_16x16x32_bf16 v[208:211], v[104:107], a[40:43], v[208:211]
ds_read_b128 a[0:3], v22 offset:16384
ds_read_b128 a[8:11], v22 offset:18432
v_mfma_f32_16x16x32_bf16 v[208:211], v[112:115], a[48:51], v[208:211]
v_mfma_f32_16x16x32_bf16 v[208:211], v[120:123], a[56:59], v[208:211]
s_add_u32 s48, s30, s60
ds_read_b128 a[16:19], v22 offset:20480
ds_read_b128 a[24:27], v22 offset:22528
v_mfma_f32_16x16x32_bf16 v[212:215], v[124:127], a[56:59], v[212:215]
s_add_u32 m0, s96, 73728
v_mfma_f32_16x16x32_bf16 v[212:215], v[116:119], a[48:51], v[212:215]
buffer_load_dwordx4 v22, s[8:11], s48 offen offset:0 sc1 lds
v_mfma_f32_16x16x32_bf16 v[212:215], v[108:111], a[40:43], v[212:215]
ds_read_b128 a[4:7], v22 offset:17408
ds_read_b128 a[12:15], v22 offset:19456
v_mfma_f32_16x16x32_bf16 v[212:215], v[100:103], a[32:35], v[212:215]
s_waitcnt lgkmcnt(6)
v_mfma_f32_16x16x32_bf16 v[220:223], v[100:103], a[36:39], v[220:223]
ds_read_b128 a[20:23], v22 offset:21504
ds_read_b128 a[28:31], v22 offset:23552
v_mfma_f32_16x16x32_bf16 v[220:223], v[108:111], a[44:47], v[220:223]
v_mfma_f32_16x16x32_bf16 v[220:223], v[116:119], a[52:55], v[220:223]
v_mfma_f32_16x16x32_bf16 v[220:223], v[124:127], a[60:63], v[220:223]
v_mfma_f32_16x16x32_bf16 v[216:219], v[120:123], a[60:63], v[216:219]
buffer_load_dwordx4 v22, s[8:11], s48 offen offset:1024 sc1 lds
v_mfma_f32_16x16x32_bf16 v[216:219], v[112:115], a[52:55], v[216:219]
v_mfma_f32_16x16x32_bf16 v[216:219], v[104:107], a[44:47], v[216:219]
v_mfma_f32_16x16x32_bf16 v[216:219], v[96:99], a[36:39], v[216:219]
s_waitcnt lgkmcnt(4)
v_mfma_f32_16x16x32_bf16 v[208:211], v[32:35], a[0:3], v[208:211]
v_mfma_f32_16x16x32_bf16 v[208:211], v[40:43], a[8:11], v[208:211]
ds_read_b128 a[32:35], v22 offset:24576
ds_read_b128 a[40:43], v22 offset:26624
v_mfma_f32_16x16x32_bf16 v[208:211], v[132:135], a[16:19], v[208:211]
v_mfma_f32_16x16x32_bf16 v[208:211], v[148:151], a[24:27], v[208:211]
s_add_u32 s48, s30, s61
ds_read_b128 a[48:51], v22 offset:28672
ds_read_b128 a[56:59], v22 offset:30720
v_mfma_f32_16x16x32_bf16 v[212:215], v[156:159], a[24:27], v[212:215]
s_add_u32 m0, s96, 81920
v_mfma_f32_16x16x32_bf16 v[212:215], v[140:143], a[16:19], v[212:215]
buffer_load_dwordx4 v22, s[8:11], s48 offen offset:0 sc1 lds
v_mfma_f32_16x16x32_bf16 v[212:215], v[44:47], a[8:11], v[212:215]
ds_read_b128 a[36:39], v22 offset:25600
ds_read_b128 a[44:47], v22 offset:27648
v_mfma_f32_16x16x32_bf16 v[212:215], v[36:39], a[0:3], v[212:215]
s_waitcnt lgkmcnt(6)
v_mfma_f32_16x16x32_bf16 v[220:223], v[36:39], a[4:7], v[220:223]
ds_read_b128 a[52:55], v22 offset:29696
ds_read_b128 a[60:63], v22 offset:31744
v_mfma_f32_16x16x32_bf16 v[220:223], v[44:47], a[12:15], v[220:223]
v_mfma_f32_16x16x32_bf16 v[220:223], v[140:143], a[20:23], v[220:223]
v_mfma_f32_16x16x32_bf16 v[220:223], v[156:159], a[28:31], v[220:223]
v_mfma_f32_16x16x32_bf16 v[216:219], v[148:151], a[28:31], v[216:219]
buffer_load_dwordx4 v22, s[8:11], s48 offen offset:1024 sc1 lds
v_mfma_f32_16x16x32_bf16 v[216:219], v[132:135], a[20:23], v[216:219]
v_mfma_f32_16x16x32_bf16 v[216:219], v[40:43], a[12:15], v[216:219]
v_mfma_f32_16x16x32_bf16 v[216:219], v[32:35], a[4:7], v[216:219]
s_waitcnt lgkmcnt(4)
s_waitcnt vmcnt(7)
v_mfma_f32_16x16x32_bf16 v[208:211], v[164:167], a[32:35], v[208:211]
s_barrier
v_mfma_f32_16x16x32_bf16 v[208:211], v[180:183], a[40:43], v[208:211]
s_add_u32 s52, s29, 1
s_and_b32 s52, s52, 3
s_lshl_b32 s52, s52, 10
s_add_u32 s78, s52, 4
ds_read_b128 a[0:3], v22 offset:32768
ds_read_b128 a[8:11], v22 offset:34816
v_mfma_f32_16x16x32_bf16 v[208:211], v[128:131], a[48:51], v[208:211]
buffer_store_dword v19, v21, s[76:79], s52 offen sc1
v_mfma_f32_16x16x32_bf16 v[208:211], v[144:147], a[56:59], v[208:211]
s_add_u32 s48, s30, s62
ds_read_b128 a[16:19], v22 offset:36864
ds_read_b128 a[24:27], v22 offset:38912
v_mfma_f32_16x16x32_bf16 v[212:215], v[152:155], a[56:59], v[212:215]
s_add_u32 m0, s96, 90112
v_mfma_f32_16x16x32_bf16 v[212:215], v[136:139], a[48:51], v[212:215]
buffer_load_dwordx4 v22, s[8:11], s48 offen offset:0 sc1 lds
v_mfma_f32_16x16x32_bf16 v[212:215], v[188:191], a[40:43], v[212:215]
ds_read_b128 a[4:7], v22 offset:33792
ds_read_b128 a[12:15], v22 offset:35840
v_mfma_f32_16x16x32_bf16 v[212:215], v[172:175], a[32:35], v[212:215]
s_waitcnt lgkmcnt(6)
v_mfma_f32_16x16x32_bf16 v[220:223], v[172:175], a[36:39], v[220:223]
ds_read_b128 a[20:23], v22 offset:37888
ds_read_b128 a[28:31], v22 offset:39936
v_mfma_f32_16x16x32_bf16 v[220:223], v[188:191], a[44:47], v[220:223]
v_mfma_f32_16x16x32_bf16 v[220:223], v[136:139], a[52:55], v[220:223]
v_mfma_f32_16x16x32_bf16 v[220:223], v[152:155], a[60:63], v[220:223]
v_mfma_f32_16x16x32_bf16 v[216:219], v[144:147], a[60:63], v[216:219]
buffer_load_dwordx4 v22, s[8:11], s48 offen offset:1024 sc1 lds
v_mfma_f32_16x16x32_bf16 v[216:219], v[128:131], a[52:55], v[216:219]
v_mfma_f32_16x16x32_bf16 v[216:219], v[180:183], a[44:47], v[216:219]
v_mfma_f32_16x16x32_bf16 v[216:219], v[164:167], a[36:39], v[216:219]
s_waitcnt lgkmcnt(4)
v_mfma_f32_16x16x32_bf16 v[208:211], v[160:163], a[0:3], v[208:211]
v_mfma_f32_16x16x32_bf16 v[208:211], v[176:179], a[8:11], v[208:211]
ds_read_b128 a[32:35], v22 offset:40960
ds_read_b128 a[40:43], v22 offset:43008
v_mfma_f32_16x16x32_bf16 v[208:211], a[128:131], a[16:19], v[208:211]
v_mfma_f32_16x16x32_bf16 v[208:211], a[136:139], a[24:27], v[208:211]
s_add_u32 s48, s30, s63
ds_read_b128 a[48:51], v22 offset:45056
ds_read_b128 a[56:59], v22 offset:47104
v_mfma_f32_16x16x32_bf16 v[212:215], a[140:143], a[24:27], v[212:215]
s_add_u32 m0, s96, 98304
v_mfma_f32_16x16x32_bf16 v[212:215], a[132:135], a[16:19], v[212:215]
buffer_load_dwordx4 v22, s[8:11], s48 offen offset:0 sc1 lds
v_mfma_f32_16x16x32_bf16 v[212:215], v[184:187], a[8:11], v[212:215]
ds_read_b128 a[36:39], v22 offset:41984
ds_read_b128 a[44:47], v22 offset:44032
v_mfma_f32_16x16x32_bf16 v[212:215], v[168:171], a[0:3], v[212:215]
s_waitcnt lgkmcnt(6)
v_mfma_f32_16x16x32_bf16 v[220:223], v[168:171], a[4:7], v[220:223]
ds_read_b128 a[52:55], v22 offset:46080
ds_read_b128 a[60:63], v22 offset:48128
v_mfma_f32_16x16x32_bf16 v[220:223], v[184:187], a[12:15], v[220:223]
v_mfma_f32_16x16x32_bf16 v[220:223], a[132:135], a[20:23], v[220:223]
v_mfma_f32_16x16x32_bf16 v[220:223], a[140:143], a[28:31], v[220:223]
v_mfma_f32_16x16x32_bf16 v[216:219], a[136:139], a[28:31], v[216:219]
buffer_load_dwordx4 v22, s[8:11], s48 offen offset:1024 sc1 lds
v_mfma_f32_16x16x32_bf16 v[216:219], a[128:131], a[20:23], v[216:219]
s_add_u32 s30, s29, 4
v_mfma_f32_16x16x32_bf16 v[216:219], v[176:179], a[12:15], v[216:219]
s_and_b32 s30, s30, 3
v_mfma_f32_16x16x32_bf16 v[216:219], v[160:163], a[4:7], v[216:219]
s_waitcnt lgkmcnt(4)
s_waitcnt vmcnt(11)
v_mfma_f32_16x16x32_bf16 v[208:211], a[144:147], a[32:35], v[208:211]
s_barrier
v_mfma_f32_16x16x32_bf16 v[208:211], a[152:155], a[40:43], v[208:211]
s_lshl_b32 s30, s30, 18
ds_read_b128 a[0:3], v22 offset:49152
ds_read_b128 a[8:11], v22 offset:51200
v_mfma_f32_16x16x32_bf16 v[208:211], a[160:163], a[48:51], v[208:211]
s_add_u32 s30, s30, s96
v_mfma_f32_16x16x32_bf16 v[208:211], a[168:171], a[56:59], v[208:211]
s_add_u32 s48, s30, s57
ds_read_b128 a[16:19], v22 offset:53248
ds_read_b128 a[24:27], v22 offset:55296
v_mfma_f32_16x16x32_bf16 v[212:215], a[172:175], a[56:59], v[212:215]
s_add_u32 m0, s96, 106496
v_mfma_f32_16x16x32_bf16 v[212:215], a[164:167], a[48:51], v[212:215]
buffer_load_dwordx4 v22, s[8:11], s48 offen offset:0 sc1 lds
v_mfma_f32_16x16x32_bf16 v[212:215], a[156:159], a[40:43], v[212:215]
ds_read_b128 a[4:7], v22 offset:50176
ds_read_b128 a[12:15], v22 offset:52224
v_mfma_f32_16x16x32_bf16 v[212:215], a[148:151], a[32:35], v[212:215]
s_waitcnt lgkmcnt(6)
v_mfma_f32_16x16x32_bf16 v[220:223], a[148:151], a[36:39], v[220:223]
ds_read_b128 a[20:23], v22 offset:54272
ds_read_b128 a[28:31], v22 offset:56320
v_mfma_f32_16x16x32_bf16 v[220:223], a[156:159], a[44:47], v[220:223]
v_mfma_f32_16x16x32_bf16 v[220:223], a[164:167], a[52:55], v[220:223]
v_cvt_pk_bf16_f32 v2, v208, v209
v_cvt_pk_bf16_f32 v3, v210, v211
v_mfma_f32_16x16x32_bf16 v[220:223], a[172:175], a[60:63], v[220:223]
v_cvt_pk_bf16_f32 v4, v212, v213
v_cvt_pk_bf16_f32 v5, v214, v215
v_mfma_f32_16x16x32_bf16 v[216:219], a[168:171], a[60:63], v[216:219]
buffer_load_dwordx4 v22, s[8:11], s48 offen offset:1024 sc1 lds
v_mfma_f32_16x16x32_bf16 v[216:219], a[160:163], a[52:55], v[216:219]
s_add_u32 s49, s29, 2
s_and_b32 s49, s49, 3
s_lshl_b32 s49, s49, 19
s_nop 0
buffer_store_dwordx4 v[2:5], v21, s[80:83], s49 offen offset:0 sc1
v_mfma_f32_16x16x32_bf16 v[216:219], a[152:155], a[44:47], v[216:219]
v_mfma_f32_16x16x32_bf16 v[216:219], a[144:147], a[36:39], v[216:219]
s_waitcnt lgkmcnt(4)
v_mfma_f32_16x16x32_bf16 v[224:227], a[224:227], a[0:3], v[224:227]
v_mfma_f32_16x16x32_bf16 v[224:227], a[232:235], a[8:11], v[224:227]
ds_read_b128 a[32:35], v22 offset:57344
ds_read_b128 a[40:43], v22 offset:59392
v_mfma_f32_16x16x32_bf16 v[224:227], a[240:243], a[16:19], v[224:227]
v_cvt_pk_bf16_f32 v6, v216, v217
v_cvt_pk_bf16_f32 v7, v218, v219
v_mfma_f32_16x16x32_bf16 v[224:227], a[248:251], a[24:27], v[224:227]
s_add_u32 s48, s30, s58
ds_read_b128 a[48:51], v22 offset:61440
ds_read_b128 a[56:59], v22 offset:63488
v_mfma_f32_16x16x32_bf16 v[228:231], a[252:255], a[24:27], v[228:231]
s_add_u32 m0, s96, 114688
v_cvt_pk_bf16_f32 v8, v220, v221
v_cvt_pk_bf16_f32 v9, v222, v223
v_mfma_f32_16x16x32_bf16 v[228:231], a[244:247], a[16:19], v[228:231]
buffer_load_dwordx4 v22, s[8:11], s48 offen offset:0 sc1 lds
v_mfma_f32_16x16x32_bf16 v[228:231], a[236:239], a[8:11], v[228:231]
ds_read_b128 a[36:39], v22 offset:58368
ds_read_b128 a[44:47], v22 offset:60416
v_mfma_f32_16x16x32_bf16 v[228:231], a[228:231], a[0:3], v[228:231]
s_waitcnt lgkmcnt(6)
buffer_store_dwordx4 v[6:9], v21, s[80:83], s49 offen offset:1024 sc1
v_mfma_f32_16x16x32_bf16 v[236:239], a[228:231], a[4:7], v[236:239]
s_add_u32 s44, s29, 3
s_and_b32 s44, s44, 3
s_lshl_b32 s44, s44, 2
ds_read_b128 a[52:55], v22 offset:62464
ds_read_b128 a[60:63], v22 offset:64512
v_mfma_f32_16x16x32_bf16 v[236:239], a[236:239], a[12:15], v[236:239]
buffer_load_dword v25, off, s[72:75], s44 offset:16 sc1
v_mfma_f32_16x16x32_bf16 v[236:239], a[244:247], a[20:23], v[236:239]
v_mfma_f32_16x16x32_bf16 v[236:239], a[252:255], a[28:31], v[236:239]
v_mfma_f32_16x16x32_bf16 v[232:235], a[248:251], a[28:31], v[232:235]
buffer_load_dwordx4 v22, s[8:11], s48 offen offset:1024 sc1 lds
v_mfma_f32_16x16x32_bf16 v[232:235], a[240:243], a[20:23], v[232:235]
v_mfma_f32_16x16x32_bf16 v[232:235], a[232:235], a[12:15], v[232:235]
v_mfma_f32_16x16x32_bf16 v[232:235], a[224:227], a[4:7], v[232:235]
s_waitcnt lgkmcnt(4)
s_waitcnt vmcnt(14)
v_mfma_f32_16x16x32_bf16 v[224:227], v[64:67], a[32:35], v[224:227]
s_barrier
v_mfma_f32_16x16x32_bf16 v[224:227], v[72:75], a[40:43], v[224:227]
ds_read_b128 a[0:3], v1 offset:0
ds_read_b128 a[8:11], v1 offset:2048
v_mfma_f32_16x16x32_bf16 v[224:227], v[80:83], a[48:51], v[224:227]
v_mfma_f32_16x16x32_bf16 v[224:227], v[88:91], a[56:59], v[224:227]
s_add_u32 s48, s30, s59
ds_read_b128 a[16:19], v1 offset:4096
ds_read_b128 a[24:27], v1 offset:6144
v_mfma_f32_16x16x32_bf16 v[228:231], v[92:95], a[56:59], v[228:231]
s_add_u32 m0, s96, 122880
v_mfma_f32_16x16x32_bf16 v[228:231], v[84:87], a[48:51], v[228:231]
buffer_load_dwordx4 v22, s[8:11], s48 offen offset:0 sc1 lds
v_mfma_f32_16x16x32_bf16 v[228:231], v[76:79], a[40:43], v[228:231]
ds_read_b128 a[4:7], v1 offset:1024
ds_read_b128 a[12:15], v1 offset:3072
v_mfma_f32_16x16x32_bf16 v[228:231], v[68:71], a[32:35], v[228:231]
s_waitcnt lgkmcnt(6)
v_mfma_f32_16x16x32_bf16 v[236:239], v[68:71], a[36:39], v[236:239]
ds_read_b128 a[20:23], v1 offset:5120
ds_read_b128 a[28:31], v1 offset:7168
v_mfma_f32_16x16x32_bf16 v[236:239], v[76:79], a[44:47], v[236:239]
v_mfma_f32_16x16x32_bf16 v[236:239], v[84:87], a[52:55], v[236:239]
v_mfma_f32_16x16x32_bf16 v[236:239], v[92:95], a[60:63], v[236:239]
v_mfma_f32_16x16x32_bf16 v[232:235], v[88:91], a[60:63], v[232:235]
buffer_load_dwordx4 v22, s[8:11], s48 offen offset:1024 sc1 lds
v_mfma_f32_16x16x32_bf16 v[232:235], v[80:83], a[52:55], v[232:235]
v_mfma_f32_16x16x32_bf16 v[232:235], v[72:75], a[44:47], v[232:235]
v_mfma_f32_16x16x32_bf16 v[232:235], v[64:67], a[36:39], v[232:235]
s_waitcnt lgkmcnt(4)
v_mfma_f32_16x16x32_bf16 v[224:227], v[96:99], a[0:3], v[224:227]
v_mfma_f32_16x16x32_bf16 v[224:227], v[104:107], a[8:11], v[224:227]
ds_read_b128 a[32:35], v1 offset:8192
ds_read_b128 a[40:43], v1 offset:10240
v_mfma_f32_16x16x32_bf16 v[224:227], v[112:115], a[16:19], v[224:227]
v_mfma_f32_16x16x32_bf16 v[224:227], v[120:123], a[24:27], v[224:227]
s_add_u32 s48, s30, s60
ds_read_b128 a[48:51], v1 offset:12288
ds_read_b128 a[56:59], v1 offset:14336
v_mfma_f32_16x16x32_bf16 v[228:231], v[124:127], a[24:27], v[228:231]
s_add_u32 m0, s96, 0
v_mfma_f32_16x16x32_bf16 v[228:231], v[116:119], a[16:19], v[228:231]
buffer_load_dwordx4 v22, s[8:11], s48 offen offset:0 sc1 lds
v_mfma_f32_16x16x32_bf16 v[228:231], v[108:111], a[8:11], v[228:231]
ds_read_b128 a[36:39], v1 offset:9216
ds_read_b128 a[44:47], v1 offset:11264
v_mfma_f32_16x16x32_bf16 v[228:231], v[100:103], a[0:3], v[228:231]
s_waitcnt lgkmcnt(6)
v_mfma_f32_16x16x32_bf16 v[236:239], v[100:103], a[4:7], v[236:239]
ds_read_b128 a[52:55], v1 offset:13312
ds_read_b128 a[60:63], v1 offset:15360
v_mfma_f32_16x16x32_bf16 v[236:239], v[108:111], a[12:15], v[236:239]
v_mfma_f32_16x16x32_bf16 v[236:239], v[116:119], a[20:23], v[236:239]
v_mfma_f32_16x16x32_bf16 v[236:239], v[124:127], a[28:31], v[236:239]
v_mfma_f32_16x16x32_bf16 v[232:235], v[120:123], a[28:31], v[232:235]
buffer_load_dwordx4 v22, s[8:11], s48 offen offset:1024 sc1 lds
v_mfma_f32_16x16x32_bf16 v[232:235], v[112:115], a[20:23], v[232:235]
v_mfma_f32_16x16x32_bf16 v[232:235], v[104:107], a[12:15], v[232:235]
v_mfma_f32_16x16x32_bf16 v[232:235], v[96:99], a[4:7], v[232:235]
s_waitcnt lgkmcnt(4)
s_waitcnt vmcnt(6)
v_mfma_f32_16x16x32_bf16 v[224:227], v[32:35], a[32:35], v[224:227]
s_barrier
v_mfma_f32_16x16x32_bf16 v[224:227], v[40:43], a[40:43], v[224:227]
s_add_u32 s52, s29, 2
s_and_b32 s52, s52, 3
s_lshl_b32 s52, s52, 10
s_add_u32 s78, s52, 4
ds_read_b128 a[0:3], v1 offset:16384
ds_read_b128 a[8:11], v1 offset:18432
v_mfma_f32_16x16x32_bf16 v[224:227], v[132:135], a[48:51], v[224:227]
buffer_store_dword v19, v21, s[76:79], s52 offen sc1
v_mfma_f32_16x16x32_bf16 v[224:227], v[148:151], a[56:59], v[224:227]
s_add_u32 s48, s30, s61
ds_read_b128 a[16:19], v1 offset:20480
ds_read_b128 a[24:27], v1 offset:22528
v_mfma_f32_16x16x32_bf16 v[228:231], v[156:159], a[56:59], v[228:231]
s_add_u32 m0, s96, 8192
v_mfma_f32_16x16x32_bf16 v[228:231], v[140:143], a[48:51], v[228:231]
buffer_load_dwordx4 v22, s[8:11], s48 offen offset:0 sc1 lds
v_mfma_f32_16x16x32_bf16 v[228:231], v[44:47], a[40:43], v[228:231]
ds_read_b128 a[4:7], v1 offset:17408
ds_read_b128 a[12:15], v1 offset:19456
v_mfma_f32_16x16x32_bf16 v[228:231], v[36:39], a[32:35], v[228:231]
s_waitcnt lgkmcnt(6)
v_mfma_f32_16x16x32_bf16 v[236:239], v[36:39], a[36:39], v[236:239]
ds_read_b128 a[20:23], v1 offset:21504
ds_read_b128 a[28:31], v1 offset:23552
v_mfma_f32_16x16x32_bf16 v[236:239], v[44:47], a[44:47], v[236:239]
s_waitcnt vmcnt(7)
v_cmp_ne_u32 vcc, 1, v25
v_mfma_f32_16x16x32_bf16 v[236:239], v[140:143], a[52:55], v[236:239]
s_cbranch_vccnz L_e2
L_e2_back:
v_mfma_f32_16x16x32_bf16 v[236:239], v[156:159], a[60:63], v[236:239]
v_mfma_f32_16x16x32_bf16 v[232:235], v[148:151], a[60:63], v[232:235]
buffer_load_dwordx4 v22, s[8:11], s48 offen offset:1024 sc1 lds
v_mfma_f32_16x16x32_bf16 v[232:235], v[132:135], a[52:55], v[232:235]
s_lshl_b32 s44, s44, 12
v_mfma_f32_16x16x32_bf16 v[232:235], v[40:43], a[44:47], v[232:235]
buffer_load_dwordx4 v[48:51], v21, s[84:87], s44 offen offset:0 sc1
v_mfma_f32_16x16x32_bf16 v[232:235], v[32:35], a[36:39], v[232:235]
s_waitcnt lgkmcnt(4)
v_mfma_f32_16x16x32_bf16 v[224:227], v[164:167], a[0:3], v[224:227]
v_mfma_f32_16x16x32_bf16 v[224:227], v[180:183], a[8:11], v[224:227]
ds_read_b128 a[32:35], v1 offset:24576
ds_read_b128 a[40:43], v1 offset:26624
v_mfma_f32_16x16x32_bf16 v[224:227], v[128:131], a[16:19], v[224:227]
buffer_load_dwordx4 v[52:55], v21, s[84:87], s44 offen offset:1024 sc1
v_mfma_f32_16x16x32_bf16 v[224:227], v[144:147], a[24:27], v[224:227]
s_add_u32 s48, s30, s62
ds_read_b128 a[48:51], v1 offset:28672
ds_read_b128 a[56:59], v1 offset:30720
v_mfma_f32_16x16x32_bf16 v[228:231], v[152:155], a[24:27], v[228:231]
s_add_u32 m0, s96, 16384
v_mfma_f32_16x16x32_bf16 v[228:231], v[136:139], a[16:19], v[228:231]
buffer_load_dwordx4 v22, s[8:11], s48 offen offset:0 sc1 lds
v_mfma_f32_16x16x32_bf16 v[228:231], v[188:191], a[8:11], v[228:231]
ds_read_b128 a[36:39], v1 offset:25600
ds_read_b128 a[44:47], v1 offset:27648
v_mfma_f32_16x16x32_bf16 v[228:231], v[172:175], a[0:3], v[228:231]
s_waitcnt lgkmcnt(6)
v_mfma_f32_16x16x32_bf16 v[236:239], v[172:175], a[4:7], v[236:239]
ds_read_b128 a[52:55], v1 offset:29696
ds_read_b128 a[60:63], v1 offset:31744
v_mfma_f32_16x16x32_bf16 v[236:239], v[188:191], a[12:15], v[236:239]
v_mfma_f32_16x16x32_bf16 v[236:239], v[136:139], a[20:23], v[236:239]
v_mfma_f32_16x16x32_bf16 v[236:239], v[152:155], a[28:31], v[236:239]
v_mfma_f32_16x16x32_bf16 v[232:235], v[144:147], a[28:31], v[232:235]
buffer_load_dwordx4 v22, s[8:11], s48 offen offset:1024 sc1 lds
v_mfma_f32_16x16x32_bf16 v[232:235], v[128:131], a[20:23], v[232:235]
v_mfma_f32_16x16x32_bf16 v[232:235], v[180:183], a[12:15], v[232:235]
v_mfma_f32_16x16x32_bf16 v[232:235], v[164:167], a[4:7], v[232:235]
s_waitcnt lgkmcnt(4)
v_mfma_f32_16x16x32_bf16 v[224:227], v[160:163], a[32:35], v[224:227]
s_barrier
v_mfma_f32_16x16x32_bf16 v[224:227], v[176:179], a[40:43], v[224:227]
ds_read_b128 a[0:3], v1 offset:32768
ds_read_b128 a[8:11], v1 offset:34816
v_mfma_f32_16x16x32_bf16 v[224:227], a[128:131], a[48:51], v[224:227]
v_mfma_f32_16x16x32_bf16 v[224:227], a[136:139], a[56:59], v[224:227]
s_add_u32 s48, s30, s63
ds_read_b128 a[16:19], v1 offset:36864
ds_read_b128 a[24:27], v1 offset:38912
v_mfma_f32_16x16x32_bf16 v[228:231], a[140:143], a[56:59], v[228:231]
s_add_u32 m0, s96, 24576
v_mfma_f32_16x16x32_bf16 v[228:231], a[132:135], a[48:51], v[228:231]
buffer_load_dwordx4 v22, s[8:11], s48 offen offset:0 sc1 lds
v_mfma_f32_16x16x32_bf16 v[228:231], v[184:187], a[40:43], v[228:231]
ds_read_b128 a[4:7], v1 offset:33792
ds_read_b128 a[12:15], v1 offset:35840
v_mfma_f32_16x16x32_bf16 v[228:231], v[168:171], a[32:35], v[228:231]
s_waitcnt lgkmcnt(6)
v_mfma_f32_16x16x32_bf16 v[236:239], v[168:171], a[36:39], v[236:239]
ds_read_b128 a[20:23], v1 offset:37888
ds_read_b128 a[28:31], v1 offset:39936
v_mfma_f32_16x16x32_bf16 v[236:239], v[184:187], a[44:47], v[236:239]
v_mfma_f32_16x16x32_bf16 v[236:239], a[132:135], a[52:55], v[236:239]
v_mfma_f32_16x16x32_bf16 v[236:239], a[140:143], a[60:63], v[236:239]
v_mfma_f32_16x16x32_bf16 v[232:235], a[136:139], a[60:63], v[232:235]
buffer_load_dwordx4 v22, s[8:11], s48 offen offset:1024 sc1 lds
v_mfma_f32_16x16x32_bf16 v[232:235], a[128:131], a[52:55], v[232:235]
v_mfma_f32_16x16x32_bf16 v[232:235], v[176:179], a[44:47], v[232:235]
v_mfma_f32_16x16x32_bf16 v[232:235], v[160:163], a[36:39], v[232:235]
s_waitcnt lgkmcnt(4)
v_mfma_f32_16x16x32_bf16 v[224:227], a[144:147], a[0:3], v[224:227]
v_mfma_f32_16x16x32_bf16 v[224:227], a[152:155], a[8:11], v[224:227]
ds_read_b128 a[32:35], v1 offset:40960
ds_read_b128 a[40:43], v1 offset:43008
v_mfma_f32_16x16x32_bf16 v[224:227], a[160:163], a[16:19], v[224:227]
v_mfma_f32_16x16x32_bf16 v[224:227], a[168:171], a[24:27], v[224:227]
ds_read_b128 a[48:51], v1 offset:45056
ds_read_b128 a[56:59], v1 offset:47104
v_mfma_f32_16x16x32_bf16 v[228:231], a[172:175], a[24:27], v[228:231]
v_mfma_f32_16x16x32_bf16 v[228:231], a[164:167], a[16:19], v[228:231]
s_add_u32 s44, s29, 2
v_mfma_f32_16x16x32_bf16 v[228:231], a[156:159], a[8:11], v[228:231]
s_and_b32 s44, s44, 3
ds_read_b128 a[36:39], v1 offset:41984
ds_read_b128 a[44:47], v1 offset:44032
v_mfma_f32_16x16x32_bf16 v[228:231], a[148:151], a[0:3], v[228:231]
s_waitcnt lgkmcnt(6)
v_mfma_f32_16x16x32_bf16 v[236:239], a[148:151], a[4:7], v[236:239]
s_lshl_b32 s44, s44, 2
ds_read_b128 a[52:55], v1 offset:46080
ds_read_b128 a[60:63], v1 offset:48128
v_mfma_f32_16x16x32_bf16 v[236:239], a[156:159], a[12:15], v[236:239]
buffer_load_dword v25, off, s[72:75], s44 offset:16 sc1
v_mfma_f32_16x16x32_bf16 v[236:239], a[164:167], a[20:23], v[236:239]
s_add_u32 s49, s29, 3
v_cvt_pk_bf16_f32 v2, v224, v225
v_cvt_pk_bf16_f32 v3, v226, v227
v_mfma_f32_16x16x32_bf16 v[236:239], a[172:175], a[28:31], v[236:239]
s_and_b32 s49, s49, 3
v_cvt_pk_bf16_f32 v4, v228, v229
v_cvt_pk_bf16_f32 v5, v230, v231
v_mfma_f32_16x16x32_bf16 v[232:235], a[168:171], a[28:31], v[232:235]
s_lshl_b32 s49, s49, 19
v_mfma_f32_16x16x32_bf16 v[232:235], a[160:163], a[20:23], v[232:235]
buffer_store_dwordx4 v[2:5], v21, s[80:83], s49 offen offset:0 sc1
v_mfma_f32_16x16x32_bf16 v[232:235], a[152:155], a[12:15], v[232:235]
v_mfma_f32_16x16x32_bf16 v[232:235], a[144:147], a[4:7], v[232:235]
s_waitcnt lgkmcnt(4)
s_waitcnt vmcnt(13)
v_mfma_f32_16x16x32_bf16 v[240:243], a[224:227], a[32:35], v[240:243]
s_barrier
v_mfma_f32_16x16x32_bf16 v[240:243], a[232:235], a[40:43], v[240:243]
ds_read_b128 a[0:3], v1 offset:49152
ds_read_b128 a[8:11], v1 offset:51200
v_mfma_f32_16x16x32_bf16 v[240:243], a[240:243], a[48:51], v[240:243]
v_cvt_pk_bf16_f32 v6, v232, v233
v_cvt_pk_bf16_f32 v7, v234, v235
v_mfma_f32_16x16x32_bf16 v[240:243], a[248:251], a[56:59], v[240:243]
ds_read_b128 a[16:19], v1 offset:53248
ds_read_b128 a[24:27], v1 offset:55296
v_mfma_f32_16x16x32_bf16 v[244:247], a[252:255], a[56:59], v[244:247]
v_cvt_pk_bf16_f32 v8, v236, v237
v_cvt_pk_bf16_f32 v9, v238, v239
v_mfma_f32_16x16x32_bf16 v[244:247], a[244:247], a[48:51], v[244:247]
v_mfma_f32_16x16x32_bf16 v[244:247], a[236:239], a[40:43], v[244:247]
ds_read_b128 a[4:7], v1 offset:50176
ds_read_b128 a[12:15], v1 offset:52224
v_mfma_f32_16x16x32_bf16 v[244:247], a[228:231], a[32:35], v[244:247]
s_waitcnt lgkmcnt(6)
buffer_store_dwordx4 v[6:9], v21, s[80:83], s49 offen offset:1024 sc1
v_mfma_f32_16x16x32_bf16 v[252:255], a[228:231], a[36:39], v[252:255]
ds_read_b128 a[20:23], v1 offset:54272
ds_read_b128 a[28:31], v1 offset:56320
v_mfma_f32_16x16x32_bf16 v[252:255], a[236:239], a[44:47], v[252:255]
v_mfma_f32_16x16x32_bf16 v[252:255], a[244:247], a[52:55], v[252:255]
v_mfma_f32_16x16x32_bf16 v[252:255], a[252:255], a[60:63], v[252:255]
v_mfma_f32_16x16x32_bf16 v[248:251], a[248:251], a[60:63], v[248:251]
v_mfma_f32_16x16x32_bf16 v[248:251], a[240:243], a[52:55], v[248:251]
v_mfma_f32_16x16x32_bf16 v[248:251], a[232:235], a[44:47], v[248:251]
v_mfma_f32_16x16x32_bf16 v[248:251], a[224:227], a[36:39], v[248:251]
s_waitcnt lgkmcnt(4)
v_mfma_f32_16x16x32_bf16 v[240:243], v[64:67], a[0:3], v[240:243]
v_mfma_f32_16x16x32_bf16 v[240:243], v[72:75], a[8:11], v[240:243]
ds_read_b128 a[32:35], v1 offset:57344
ds_read_b128 a[40:43], v1 offset:59392
v_mfma_f32_16x16x32_bf16 v[240:243], v[80:83], a[16:19], v[240:243]
v_mfma_f32_16x16x32_bf16 v[240:243], v[88:91], a[24:27], v[240:243]
ds_read_b128 a[48:51], v1 offset:61440
ds_read_b128 a[56:59], v1 offset:63488
v_mfma_f32_16x16x32_bf16 v[244:247], v[92:95], a[24:27], v[244:247]
v_mfma_f32_16x16x32_bf16 v[244:247], v[84:87], a[16:19], v[244:247]
v_mfma_f32_16x16x32_bf16 v[244:247], v[76:79], a[8:11], v[244:247]
ds_read_b128 a[36:39], v1 offset:58368
ds_read_b128 a[44:47], v1 offset:60416
v_mfma_f32_16x16x32_bf16 v[244:247], v[68:71], a[0:3], v[244:247]
s_waitcnt lgkmcnt(6)
v_mfma_f32_16x16x32_bf16 v[252:255], v[68:71], a[4:7], v[252:255]
ds_read_b128 a[52:55], v1 offset:62464
ds_read_b128 a[60:63], v1 offset:64512
v_mfma_f32_16x16x32_bf16 v[252:255], v[76:79], a[12:15], v[252:255]
v_mfma_f32_16x16x32_bf16 v[252:255], v[84:87], a[20:23], v[252:255]
v_mfma_f32_16x16x32_bf16 v[252:255], v[92:95], a[28:31], v[252:255]
v_mfma_f32_16x16x32_bf16 v[248:251], v[88:91], a[28:31], v[248:251]
v_mfma_f32_16x16x32_bf16 v[248:251], v[80:83], a[20:23], v[248:251]
v_mfma_f32_16x16x32_bf16 v[248:251], v[72:75], a[12:15], v[248:251]
v_mfma_f32_16x16x32_bf16 v[248:251], v[64:67], a[4:7], v[248:251]
s_waitcnt lgkmcnt(4)
s_waitcnt vmcnt(9)
v_mfma_f32_16x16x32_bf16 v[240:243], v[96:99], a[32:35], v[240:243]
s_barrier
v_mfma_f32_16x16x32_bf16 v[240:243], v[104:107], a[40:43], v[240:243]
ds_read_b128 a[0:3], v22 offset:0
ds_read_b128 a[8:11], v22 offset:2048
v_mfma_f32_16x16x32_bf16 v[240:243], v[112:115], a[48:51], v[240:243]
v_mfma_f32_16x16x32_bf16 v[240:243], v[120:123], a[56:59], v[240:243]
ds_read_b128 a[16:19], v22 offset:4096
ds_read_b128 a[24:27], v22 offset:6144
v_mfma_f32_16x16x32_bf16 v[244:247], v[124:127], a[56:59], v[244:247]
v_mfma_f32_16x16x32_bf16 v[244:247], v[116:119], a[48:51], v[244:247]
v_mfma_f32_16x16x32_bf16 v[244:247], v[108:111], a[40:43], v[244:247]
ds_read_b128 a[4:7], v22 offset:1024
ds_read_b128 a[12:15], v22 offset:3072
v_mfma_f32_16x16x32_bf16 v[244:247], v[100:103], a[32:35], v[244:247]
s_waitcnt lgkmcnt(6)
v_mfma_f32_16x16x32_bf16 v[252:255], v[100:103], a[36:39], v[252:255]
ds_read_b128 a[20:23], v22 offset:5120
ds_read_b128 a[28:31], v22 offset:7168
v_mfma_f32_16x16x32_bf16 v[252:255], v[108:111], a[44:47], v[252:255]
s_waitcnt vmcnt(2)
v_cmp_ne_u32 vcc, 1, v25
v_mfma_f32_16x16x32_bf16 v[252:255], v[116:119], a[52:55], v[252:255]
s_cbranch_vccnz L_e1
L_e1_back:
v_mfma_f32_16x16x32_bf16 v[252:255], v[124:127], a[60:63], v[252:255]
v_mfma_f32_16x16x32_bf16 v[248:251], v[120:123], a[60:63], v[248:251]
v_mfma_f32_16x16x32_bf16 v[248:251], v[112:115], a[52:55], v[248:251]
s_lshl_b32 s44, s44, 12
v_mfma_f32_16x16x32_bf16 v[248:251], v[104:107], a[44:47], v[248:251]
buffer_load_dwordx4 v[56:59], v21, s[84:87], s44 offen offset:0 sc1
v_mfma_f32_16x16x32_bf16 v[248:251], v[96:99], a[36:39], v[248:251]
s_waitcnt lgkmcnt(4)
v_mfma_f32_16x16x32_bf16 v[240:243], v[32:35], a[0:3], v[240:243]
v_mfma_f32_16x16x32_bf16 v[240:243], v[40:43], a[8:11], v[240:243]
ds_read_b128 a[32:35], v22 offset:8192
ds_read_b128 a[40:43], v22 offset:10240
v_mfma_f32_16x16x32_bf16 v[240:243], v[132:135], a[16:19], v[240:243]
buffer_load_dwordx4 v[60:63], v21, s[84:87], s44 offen offset:1024 sc1
v_mfma_f32_16x16x32_bf16 v[240:243], v[148:151], a[24:27], v[240:243]
ds_read_b128 a[48:51], v22 offset:12288
ds_read_b128 a[56:59], v22 offset:14336
v_mfma_f32_16x16x32_bf16 v[244:247], v[156:159], a[24:27], v[244:247]
v_mfma_f32_16x16x32_bf16 v[244:247], v[140:143], a[16:19], v[244:247]
v_mfma_f32_16x16x32_bf16 v[244:247], v[44:47], a[8:11], v[244:247]
ds_read_b128 a[36:39], v22 offset:9216
ds_read_b128 a[44:47], v22 offset:11264
v_mfma_f32_16x16x32_bf16 v[244:247], v[36:39], a[0:3], v[244:247]
s_waitcnt lgkmcnt(6)
v_mfma_f32_16x16x32_bf16 v[252:255], v[36:39], a[4:7], v[252:255]
ds_read_b128 a[52:55], v22 offset:13312
ds_read_b128 a[60:63], v22 offset:15360
v_mfma_f32_16x16x32_bf16 v[252:255], v[44:47], a[12:15], v[252:255]
v_mfma_f32_16x16x32_bf16 v[252:255], v[140:143], a[20:23], v[252:255]
v_mfma_f32_16x16x32_bf16 v[252:255], v[156:159], a[28:31], v[252:255]
v_mfma_f32_16x16x32_bf16 v[248:251], v[148:151], a[28:31], v[248:251]
s_add_u32 s52, s29, 3
v_mfma_f32_16x16x32_bf16 v[248:251], v[132:135], a[20:23], v[248:251]
s_and_b32 s52, s52, 3
v_mfma_f32_16x16x32_bf16 v[248:251], v[40:43], a[12:15], v[248:251]
s_lshl_b32 s52, s52, 10
v_mfma_f32_16x16x32_bf16 v[248:251], v[32:35], a[4:7], v[248:251]
s_waitcnt lgkmcnt(4)
s_waitcnt vmcnt(2)
v_mfma_f32_16x16x32_bf16 v[240:243], v[164:167], a[32:35], v[240:243]
s_barrier
v_mfma_f32_16x16x32_bf16 v[240:243], v[180:183], a[40:43], v[240:243]
s_add_u32 s78, s52, 4
ds_read_b128 a[0:3], v22 offset:16384
ds_read_b128 a[8:11], v22 offset:18432
v_mfma_f32_16x16x32_bf16 v[240:243], v[128:131], a[48:51], v[240:243]
buffer_store_dword v19, v21, s[76:79], s52 offen sc1
v_mfma_f32_16x16x32_bf16 v[240:243], v[144:147], a[56:59], v[240:243]
ds_read_b128 a[16:19], v22 offset:20480
ds_read_b128 a[24:27], v22 offset:22528
v_mfma_f32_16x16x32_bf16 v[244:247], v[152:155], a[56:59], v[244:247]
s_waitcnt vmcnt(1)
v_lshlrev_b32 v224, 16, v48
v_and_b32 v225, 0xffff0000, v48
v_mfma_f32_16x16x32_bf16 v[244:247], v[136:139], a[48:51], v[244:247]
v_lshlrev_b32 v226, 16, v49
v_and_b32 v227, 0xffff0000, v49
v_mfma_f32_16x16x32_bf16 v[244:247], v[188:191], a[40:43], v[244:247]
ds_read_b128 a[4:7], v22 offset:17408
ds_read_b128 a[12:15], v22 offset:19456
v_mfma_f32_16x16x32_bf16 v[244:247], v[172:175], a[32:35], v[244:247]
s_waitcnt lgkmcnt(6)
v_lshlrev_b32 v228, 16, v50
v_and_b32 v229, 0xffff0000, v50
v_mfma_f32_16x16x32_bf16 v[252:255], v[172:175], a[36:39], v[252:255]
ds_read_b128 a[20:23], v22 offset:21504
ds_read_b128 a[28:31], v22 offset:23552
v_mfma_f32_16x16x32_bf16 v[252:255], v[188:191], a[44:47], v[252:255]
v_lshlrev_b32 v230, 16, v51
v_and_b32 v231, 0xffff0000, v51
v_mfma_f32_16x16x32_bf16 v[252:255], v[136:139], a[52:55], v[252:255]
v_lshlrev_b32 v232, 16, v52
v_and_b32 v233, 0xffff0000, v52
v_mfma_f32_16x16x32_bf16 v[252:255], v[152:155], a[60:63], v[252:255]
v_lshlrev_b32 v234, 16, v53
v_and_b32 v235, 0xffff0000, v53
v_mfma_f32_16x16x32_bf16 v[248:251], v[144:147], a[60:63], v[248:251]
v_lshlrev_b32 v236, 16, v54
v_and_b32 v237, 0xffff0000, v54
v_mfma_f32_16x16x32_bf16 v[248:251], v[128:131], a[52:55], v[248:251]
v_lshlrev_b32 v238, 16, v55
v_and_b32 v239, 0xffff0000, v55
v_mfma_f32_16x16x32_bf16 v[248:251], v[180:183], a[44:47], v[248:251]
v_lshlrev_b32 v208, 16, v56
v_and_b32 v209, 0xffff0000, v56
v_mfma_f32_16x16x32_bf16 v[248:251], v[164:167], a[36:39], v[248:251]
s_waitcnt lgkmcnt(4)
v_lshlrev_b32 v210, 16, v57
v_and_b32 v211, 0xffff0000, v57
v_mfma_f32_16x16x32_bf16 v[240:243], v[160:163], a[0:3], v[240:243]
v_lshlrev_b32 v212, 16, v58
v_and_b32 v213, 0xffff0000, v58
v_mfma_f32_16x16x32_bf16 v[240:243], v[176:179], a[8:11], v[240:243]
ds_read_b128 a[32:35], v22 offset:24576
ds_read_b128 a[40:43], v22 offset:26624
v_mfma_f32_16x16x32_bf16 v[240:243], a[128:131], a[16:19], v[240:243]
v_lshlrev_b32 v214, 16, v59
v_and_b32 v215, 0xffff0000, v59
v_mfma_f32_16x16x32_bf16 v[240:243], a[136:139], a[24:27], v[240:243]
ds_read_b128 a[48:51], v22 offset:28672
ds_read_b128 a[56:59], v22 offset:30720
v_mfma_f32_16x16x32_bf16 v[244:247], a[140:143], a[24:27], v[244:247]
v_lshlrev_b32 v216, 16, v60
v_and_b32 v217, 0xffff0000, v60
v_mfma_f32_16x16x32_bf16 v[244:247], a[132:135], a[16:19], v[244:247]
v_lshlrev_b32 v218, 16, v61
v_and_b32 v219, 0xffff0000, v61
v_mfma_f32_16x16x32_bf16 v[244:247], v[184:187], a[8:11], v[244:247]
ds_read_b128 a[36:39], v22 offset:25600
ds_read_b128 a[44:47], v22 offset:27648
v_mfma_f32_16x16x32_bf16 v[244:247], v[168:171], a[0:3], v[244:247]
s_waitcnt lgkmcnt(6)
v_lshlrev_b32 v220, 16, v62
v_and_b32 v221, 0xffff0000, v62
v_mfma_f32_16x16x32_bf16 v[252:255], v[168:171], a[4:7], v[252:255]
ds_read_b128 a[52:55], v22 offset:29696
ds_read_b128 a[60:63], v22 offset:31744
v_mfma_f32_16x16x32_bf16 v[252:255], v[184:187], a[12:15], v[252:255]
v_lshlrev_b32 v222, 16, v63
v_and_b32 v223, 0xffff0000, v63
v_mfma_f32_16x16x32_bf16 v[252:255], a[132:135], a[20:23], v[252:255]
v_add_f32 v208, v208, v224
v_add_f32 v209, v209, v225
v_mfma_f32_16x16x32_bf16 v[252:255], a[140:143], a[28:31], v[252:255]
v_add_f32 v210, v210, v226
v_add_f32 v211, v211, v227
v_mfma_f32_16x16x32_bf16 v[248:251], a[136:139], a[28:31], v[248:251]
v_add_f32 v212, v212, v228
v_add_f32 v213, v213, v229
v_mfma_f32_16x16x32_bf16 v[248:251], a[128:131], a[20:23], v[248:251]
v_add_f32 v214, v214, v230
v_add_f32 v215, v215, v231
v_mfma_f32_16x16x32_bf16 v[248:251], v[176:179], a[12:15], v[248:251]
v_add_f32 v216, v216, v232
v_add_f32 v217, v217, v233
v_mfma_f32_16x16x32_bf16 v[248:251], v[160:163], a[4:7], v[248:251]
s_waitcnt lgkmcnt(4)
v_add_f32 v218, v218, v234
v_add_f32 v219, v219, v235
v_mfma_f32_16x16x32_bf16 v[240:243], a[144:147], a[32:35], v[240:243]
v_add_f32 v220, v220, v236
v_add_f32 v221, v221, v237
v_mfma_f32_16x16x32_bf16 v[240:243], a[152:155], a[40:43], v[240:243]
s_add_u32 s44, s29, 1
v_add_f32 v222, v222, v238
v_add_f32 v223, v223, v239
v_mfma_f32_16x16x32_bf16 v[240:243], a[160:163], a[48:51], v[240:243]
s_and_b32 s44, s44, 3
v_mfma_f32_16x16x32_bf16 v[240:243], a[168:171], a[56:59], v[240:243]
s_lshl_b32 s44, s44, 2
v_mfma_f32_16x16x32_bf16 v[244:247], a[172:175], a[56:59], v[244:247]
buffer_load_dword v25, off, s[72:75], s44 offset:16 sc1
v_mfma_f32_16x16x32_bf16 v[244:247], a[164:167], a[48:51], v[244:247]
v_mfma_f32_16x16x32_bf16 v[244:247], a[156:159], a[40:43], v[244:247]
v_mfma_f32_16x16x32_bf16 v[244:247], a[148:151], a[32:35], v[244:247]
s_waitcnt lgkmcnt(0)
v_mfma_f32_16x16x32_bf16 v[252:255], a[148:151], a[36:39], v[252:255]
v_mfma_f32_16x16x32_bf16 v[252:255], a[156:159], a[44:47], v[252:255]
v_mfma_f32_16x16x32_bf16 v[252:255], a[164:167], a[52:55], v[252:255]
v_mfma_f32_16x16x32_bf16 v[252:255], a[172:175], a[60:63], v[252:255]
v_mfma_f32_16x16x32_bf16 v[248:251], a[168:171], a[60:63], v[248:251]
v_mfma_f32_16x16x32_bf16 v[248:251], a[160:163], a[52:55], v[248:251]
v_mfma_f32_16x16x32_bf16 v[248:251], a[152:155], a[44:47], v[248:251]
v_mfma_f32_16x16x32_bf16 v[248:251], a[144:147], a[36:39], v[248:251]
s_mov_b32 s45, 0
s_waitcnt vmcnt(0)
v_cmp_ne_u32 vcc, 1, v25
s_cbranch_vccz L_go2
L_poll2:
buffer_load_dword v25, off, s[72:75], s44 offset:16 sc1
s_waitcnt vmcnt(0)
v_cmp_ne_u32 vcc, 1, v25
s_cbranch_vccz L_go2
s_add_u32 s45, s45, 1
s_cmp_lt_u32 s45, 200000
s_cbranch_scc1 L_poll2
L_go2:
s_lshl_b32 s44, s44, 12
buffer_load_dwordx4 v[10:13], v21, s[84:87], s44 offen offset:0 sc1
buffer_load_dwordx4 v[14:17], v21, s[84:87], s44 offen offset:1024 sc1
s_nop 4
v_pk_add_f32 v[240:241], v[240:241], v[208:209]
v_pk_add_f32 v[242:243], v[242:243], v[210:211]
v_pk_add_f32 v[244:245], v[244:245], v[212:213]
v_pk_add_f32 v[246:247], v[246:247], v[214:215]
v_pk_add_f32 v[248:249], v[248:249], v[216:217]
v_pk_add_f32 v[250:251], v[250:251], v[218:219]
v_pk_add_f32 v[252:253], v[252:253], v[220:221]
v_pk_add_f32 v[254:255], v[254:255], v[222:223]
s_mov_b32 s52, 16384
s_waitcnt vmcnt(0)
v_lshlrev_b32 v192, 16, v10
v_and_b32 v193, 0xffff0000, v10
v_lshlrev_b32 v194, 16, v11
v_and_b32 v195, 0xffff0000, v11
v_lshlrev_b32 v196, 16, v12
v_and_b32 v197, 0xffff0000, v12
v_lshlrev_b32 v198, 16, v13
v_and_b32 v199, 0xffff0000, v13
v_lshlrev_b32 v200, 16, v14
v_and_b32 v201, 0xffff0000, v14
v_lshlrev_b32 v202, 16, v15
v_and_b32 v203, 0xffff0000, v15
v_lshlrev_b32 v204, 16, v16
v_and_b32 v205, 0xffff0000, v16
v_lshlrev_b32 v206, 16, v17
v_and_b32 v207, 0xffff0000, v17
v_pk_add_f32 v[240:241], v[240:241], v[192:193]
v_pk_add_f32 v[242:243], v[242:243], v[194:195]
v_pk_add_f32 v[244:245], v[244:245], v[196:197]
v_pk_add_f32 v[246:247], v[246:247], v[198:199]
v_pk_add_f32 v[248:249], v[248:249], v[200:201]
v_pk_add_f32 v[250:251], v[250:251], v[202:203]
v_pk_add_f32 v[252:253], v[252:253], v[204:205]
v_pk_add_f32 v[254:255], v[254:255], v[206:207]
v_cvt_pk_bf16_f32 v2, v240, v241
v_cvt_pk_bf16_f32 v3, v242, v243
v_cvt_pk_bf16_f32 v4, v244, v245
v_cvt_pk_bf16_f32 v5, v246, v247
buffer_store_dwordx4 v[2:5], v18, s[32:35], 0 offen nt
v_cvt_pk_bf16_f32 v6, v248, v249
v_cvt_pk_bf16_f32 v7, v250, v251
v_cvt_pk_bf16_f32 v8, v252, v253
v_cvt_pk_bf16_f32 v9, v254, v255
buffer_store_dwordx4 v[6:9], v18, s[32:35], s52 offen nt
L_end:
s_endpgm
L_r0a:
s_call_b64 s[50:51], L_ra1
s_branch L_r0a_back
L_r0b:
s_call_b64 s[50:51], L_rb
s_branch L_r0b_back
L_r1a:
s_call_b64 s[50:51], L_ra0
s_branch L_r1a_back
L_r1b:
s_call_b64 s[50:51], L_rb
s_branch L_r1b_back
L_r2a:
s_call_b64 s[50:51], L_ra1
s_branch L_r2a_back
L_r2b:
s_call_b64 s[50:51], L_rb
s_branch L_r2b_back
L_r3a:
s_call_b64 s[50:51], L_ra0
s_branch L_r3a_back
L_r3b:
s_call_b64 s[50:51], L_rb
s_branch L_r3b_back
L_r12a:
s_call_b64 s[50:51], L_ra1
s_branch L_r12a_back
L_r12b:
s_call_b64 s[50:51], L_rb
s_branch L_r12b_back
L_r13a:
s_call_b64 s[50:51], L_ra0
s_branch L_r13a_back
L_r13b:
s_call_b64 s[50:51], L_rb
s_branch L_r13b_back
L_r14a:
s_call_b64 s[50:51], L_ra1
s_branch L_r14a_back
L_r14b:
s_call_b64 s[50:51], L_rb
s_branch L_r14b_back
L_cw:
s_mov_b32 s45, 0
L_cw_loop:
v_and_b32 v22, 3, v0
v_lshlrev_b32 v22, 6, v22
buffer_load_dword v22, v22, s[76:79], 0 offen sc1
s_waitcnt vmcnt(0)
v_cmp_ne_u32 vcc, s52, v22
s_cbranch_vccz L_cw_back
s_add_u32 s45, s45, 1
s_cmp_lt_u32 s45, 200000
s_cbranch_scc1 L_cw_loop
s_branch L_cw_back
L_e2:
s_mov_b32 s45, 0
L_e2_loop:
buffer_load_dword v25, off, s[72:75], s44 offset:16 sc1
s_waitcnt vmcnt(0)
v_cmp_ne_u32 vcc, 1, v25
s_cbranch_vccz L_e2_back
s_add_u32 s45, s45, 1
s_cmp_lt_u32 s45, 200000
s_cbranch_scc1 L_e2_loop
s_branch L_e2_back
L_e1:
s_mov_b32 s45, 0
L_e1_loop:
buffer_load_dword v25, off, s[72:75], s44 offset:16 sc1
s_waitcnt vmcnt(0)
v_cmp_ne_u32 vcc, 1, v25
s_cbranch_vccz L_e1_back
s_add_u32 s45, s45, 1
s_cmp_lt_u32 s45, 200000
s_cbranch_scc1 L_e1_loop
s_branch L_e1_back
L_ra0:
s_nop 7
v_max3_f32 v24, v128, v129, v130
v_max3_f32 v24, v131, v132, v24
v_max3_f32 v24, v133, v134, v24
v_max3_f32 v24, v135, v160, v24
v_max3_f32 v24, v161, v162, v24
v_max3_f32 v24, v163, v164, v24
v_max3_f32 v24, v165, v166, v24
v_max_f32 v24, v167, v24
v_mov_b32 v19, v24
s_nop 1
v_permlane32_swap_b32 v24, v19
s_nop 1
v_max_f32 v24, v24, v19
v_mov_b32 v19, v24
s_nop 1
v_permlane16_swap_b32 v24, v19
s_nop 1
v_max_f32 v24, v24, v19
v_max_f32 v24, 0, v24
v_sub_f32 v32, v32, v24
v_sub_f32 v33, v33, v24
v_sub_f32 v34, v34, v24
v_sub_f32 v35, v35, v24
v_sub_f32 v128, v128, v24
v_sub_f32 v129, v129, v24
v_sub_f32 v130, v130, v24
v_sub_f32 v131, v131, v24
v_sub_f32 v132, v132, v24
v_sub_f32 v133, v133, v24
v_sub_f32 v134, v134, v24
v_sub_f32 v135, v135, v24
v_sub_f32 v160, v160, v24
v_sub_f32 v161, v161, v24
v_sub_f32 v162, v162, v24
v_sub_f32 v163, v163, v24
v_sub_f32 v164, v164, v24
v_sub_f32 v165, v165, v24
v_sub_f32 v166, v166, v24
v_sub_f32 v167, v167, v24
v_exp_f32 v24, -v24
v_max3_f32 v25, v136, v137, v138
v_max3_f32 v25, v139, v140, v25
v_max3_f32 v25, v141, v142, v25
v_max3_f32 v25, v143, v168, v25
v_max3_f32 v25, v169, v170, v25
v_max3_f32 v25, v171, v172, v25
v_max3_f32 v25, v173, v174, v25
v_max_f32 v25, v175, v25
v_mov_b32 v19, v25
s_nop 1
v_permlane32_swap_b32 v25, v19
s_nop 1
v_max_f32 v25, v25, v19
v_mov_b32 v19, v25
s_nop 1
v_permlane16_swap_b32 v25, v19
s_nop 1
v_max_f32 v25, v25, v19
v_max_f32 v25, 0, v25
v_sub_f32 v36, v36, v25
v_sub_f32 v37, v37, v25
v_sub_f32 v38, v38, v25
v_sub_f32 v39, v39, v25
v_sub_f32 v136, v136, v25
v_sub_f32 v137, v137, v25
v_sub_f32 v138, v138, v25
v_sub_f32 v139, v139, v25
v_sub_f32 v140, v140, v25
v_sub_f32 v141, v141, v25
v_sub_f32 v142, v142, v25
v_sub_f32 v143, v143, v25
v_sub_f32 v168, v168, v25
v_sub_f32 v169, v169, v25
v_sub_f32 v170, v170, v25
v_sub_f32 v171, v171, v25
v_sub_f32 v172, v172, v25
v_sub_f32 v173, v173, v25
v_sub_f32 v174, v174, v25
v_sub_f32 v175, v175, v25
v_exp_f32 v25, -v25
v_max3_f32 v26, v144, v145, v146
v_max3_f32 v26, v147, v148, v26
v_max3_f32 v26, v149, v150, v26
v_max3_f32 v26, v151, v176, v26
v_max3_f32 v26, v177, v178, v26
v_max3_f32 v26, v179, v180, v26
v_max3_f32 v26, v181, v182, v26
v_max_f32 v26, v183, v26
v_mov_b32 v19, v26
s_nop 1
v_permlane32_swap_b32 v26, v19
s_nop 1
v_max_f32 v26, v26, v19
v_mov_b32 v19, v26
s_nop 1
v_permlane16_swap_b32 v26, v19
s_nop 1
v_max_f32 v26, v26, v19
v_max_f32 v26, 0, v26
v_sub_f32 v40, v40, v26
v_sub_f32 v41, v41, v26
v_sub_f32 v42, v42, v26
v_sub_f32 v43, v43, v26
v_sub_f32 v144, v144, v26
v_sub_f32 v145, v145, v26
v_sub_f32 v146, v146, v26
v_sub_f32 v147, v147, v26
v_sub_f32 v148, v148, v26
v_sub_f32 v149, v149, v26
v_sub_f32 v150, v150, v26
v_sub_f32 v151, v151, v26
v_sub_f32 v176, v176, v26
v_sub_f32 v177, v177, v26
v_sub_f32 v178, v178, v26
v_sub_f32 v179, v179, v26
v_sub_f32 v180, v180, v26
v_sub_f32 v181, v181, v26
v_sub_f32 v182, v182, v26
v_sub_f32 v183, v183, v26
v_exp_f32 v26, -v26
v_max3_f32 v27, v152, v153, v154
v_max3_f32 v27, v155, v156, v27
v_max3_f32 v27, v157, v158, v27
v_max3_f32 v27, v159, v184, v27
v_max3_f32 v27, v185, v186, v27
v_max3_f32 v27, v187, v188, v27
v_max3_f32 v27, v189, v190, v27
v_max_f32 v27, v191, v27
v_mov_b32 v19, v27
s_nop 1
v_permlane32_swap_b32 v27, v19
s_nop 1
v_max_f32 v27, v27, v19
v_mov_b32 v19, v27
s_nop 1
v_permlane16_swap_b32 v27, v19
s_nop 1
v_max_f32 v27, v27, v19
v_max_f32 v27, 0, v27
v_sub_f32 v44, v44, v27
v_sub_f32 v45, v45, v27
v_sub_f32 v46, v46, v27
v_sub_f32 v47, v47, v27
v_sub_f32 v152, v152, v27
v_sub_f32 v153, v153, v27
v_sub_f32 v154, v154, v27
v_sub_f32 v155, v155, v27
v_sub_f32 v156, v156, v27
v_sub_f32 v157, v157, v27
v_sub_f32 v158, v158, v27
v_sub_f32 v159, v159, v27
v_sub_f32 v184, v184, v27
v_sub_f32 v185, v185, v27
v_sub_f32 v186, v186, v27
v_sub_f32 v187, v187, v27
v_sub_f32 v188, v188, v27
v_sub_f32 v189, v189, v27
v_sub_f32 v190, v190, v27
v_sub_f32 v191, v191, v27
v_exp_f32 v27, -v27
s_nop 3
s_setpc_b64 s[50:51]
L_ra1:
s_nop 7
v_max3_f32 v24, v192, v193, v194
v_max3_f32 v24, v195, v196, v24
v_max3_f32 v24, v197, v198, v24
v_max3_f32 v24, v199, v224, v24
v_max3_f32 v24, v225, v226, v24
v_max3_f32 v24, v227, v228, v24
v_max3_f32 v24, v229, v230, v24
v_max_f32 v24, v231, v24
v_mov_b32 v19, v24
s_nop 1
v_permlane32_swap_b32 v24, v19
s_nop 1
v_max_f32 v24, v24, v19
v_mov_b32 v19, v24
s_nop 1
v_permlane16_swap_b32 v24, v19
s_nop 1
v_max_f32 v24, v24, v19
v_max_f32 v24, 0, v24
v_sub_f32 v32, v32, v24
v_sub_f32 v33, v33, v24
v_sub_f32 v34, v34, v24
v_sub_f32 v35, v35, v24
v_sub_f32 v192, v192, v24
v_sub_f32 v193, v193, v24
v_sub_f32 v194, v194, v24
v_sub_f32 v195, v195, v24
v_sub_f32 v196, v196, v24
v_sub_f32 v197, v197, v24
v_sub_f32 v198, v198, v24
v_sub_f32 v199, v199, v24
v_sub_f32 v224, v224, v24
v_sub_f32 v225, v225, v24
v_sub_f32 v226, v226, v24
v_sub_f32 v227, v227, v24
v_sub_f32 v228, v228, v24
v_sub_f32 v229, v229, v24
v_sub_f32 v230, v230, v24
v_sub_f32 v231, v231, v24
v_exp_f32 v24, -v24
v_max3_f32 v25, v200, v201, v202
v_max3_f32 v25, v203, v204, v25
v_max3_f32 v25, v205, v206, v25
v_max3_f32 v25, v207, v232, v25
v_max3_f32 v25, v233, v234, v25
v_max3_f32 v25, v235, v236, v25
v_max3_f32 v25, v237, v238, v25
v_max_f32 v25, v239, v25
v_mov_b32 v19, v25
s_nop 1
v_permlane32_swap_b32 v25, v19
s_nop 1
v_max_f32 v25, v25, v19
v_mov_b32 v19, v25
s_nop 1
v_permlane16_swap_b32 v25, v19
s_nop 1
v_max_f32 v25, v25, v19
v_max_f32 v25, 0, v25
v_sub_f32 v36, v36, v25
v_sub_f32 v37, v37, v25
v_sub_f32 v38, v38, v25
v_sub_f32 v39, v39, v25
v_sub_f32 v200, v200, v25
v_sub_f32 v201, v201, v25
v_sub_f32 v202, v202, v25
v_sub_f32 v203, v203, v25
v_sub_f32 v204, v204, v25
v_sub_f32 v205, v205, v25
v_sub_f32 v206, v206, v25
v_sub_f32 v207, v207, v25
v_sub_f32 v232, v232, v25
v_sub_f32 v233, v233, v25
v_sub_f32 v234, v234, v25
v_sub_f32 v235, v235, v25
v_sub_f32 v236, v236, v25
v_sub_f32 v237, v237, v25
v_sub_f32 v238, v238, v25
v_sub_f32 v239, v239, v25
v_exp_f32 v25, -v25
v_max3_f32 v26, v208, v209, v210
v_max3_f32 v26, v211, v212, v26
v_max3_f32 v26, v213, v214, v26
v_max3_f32 v26, v215, v240, v26
v_max3_f32 v26, v241, v242, v26
v_max3_f32 v26, v243, v244, v26
v_max3_f32 v26, v245, v246, v26
v_max_f32 v26, v247, v26
v_mov_b32 v19, v26
s_nop 1
v_permlane32_swap_b32 v26, v19
s_nop 1
v_max_f32 v26, v26, v19
v_mov_b32 v19, v26
s_nop 1
v_permlane16_swap_b32 v26, v19
s_nop 1
v_max_f32 v26, v26, v19
v_max_f32 v26, 0, v26
v_sub_f32 v40, v40, v26
v_sub_f32 v41, v41, v26
v_sub_f32 v42, v42, v26
v_sub_f32 v43, v43, v26
v_sub_f32 v208, v208, v26
v_sub_f32 v209, v209, v26
v_sub_f32 v210, v210, v26
v_sub_f32 v211, v211, v26
v_sub_f32 v212, v212, v26
v_sub_f32 v213, v213, v26
v_sub_f32 v214, v214, v26
v_sub_f32 v215, v215, v26
v_sub_f32 v240, v240, v26
v_sub_f32 v241, v241, v26
v_sub_f32 v242, v242, v26
v_sub_f32 v243, v243, v26
v_sub_f32 v244, v244, v26
v_sub_f32 v245, v245, v26
v_sub_f32 v246, v246, v26
v_sub_f32 v247, v247, v26
v_exp_f32 v26, -v26
v_max3_f32 v27, v216, v217, v218
v_max3_f32 v27, v219, v220, v27
v_max3_f32 v27, v221, v222, v27
v_max3_f32 v27, v223, v248, v27
v_max3_f32 v27, v249, v250, v27
v_max3_f32 v27, v251, v252, v27
v_max3_f32 v27, v253, v254, v27
v_max_f32 v27, v255, v27
v_mov_b32 v19, v27
s_nop 1
v_permlane32_swap_b32 v27, v19
s_nop 1
v_max_f32 v27, v27, v19
v_mov_b32 v19, v27
s_nop 1
v_permlane16_swap_b32 v27, v19
s_nop 1
v_max_f32 v27, v27, v19
v_max_f32 v27, 0, v27
v_sub_f32 v44, v44, v27
v_sub_f32 v45, v45, v27
v_sub_f32 v46, v46, v27
v_sub_f32 v47, v47, v27
v_sub_f32 v216, v216, v27
v_sub_f32 v217, v217, v27
v_sub_f32 v218, v218, v27
v_sub_f32 v219, v219, v27
v_sub_f32 v220, v220, v27
v_sub_f32 v221, v221, v27
v_sub_f32 v222, v222, v27
v_sub_f32 v223, v223, v27
v_sub_f32 v248, v248, v27
v_sub_f32 v249, v249, v27
v_sub_f32 v250, v250, v27
v_sub_f32 v251, v251, v27
v_sub_f32 v252, v252, v27
v_sub_f32 v253, v253, v27
v_sub_f32 v254, v254, v27
v_sub_f32 v255, v255, v27
v_exp_f32 v27, -v27
s_nop 3
s_setpc_b64 s[50:51]
L_rb:
s_nop 15
v_mul_f32 v48, v48, v24
v_mul_f32 v49, v49, v24
v_mul_f32 v50, v50, v24
v_mul_f32 v51, v51, v24
v_accvgpr_read_b32 v19, a0
v_accvgpr_read_b32 v20, a1
v_mul_f32 v19, v19, v24
v_mul_f32 v20, v20, v24
v_accvgpr_write_b32 a0, v19
v_accvgpr_write_b32 a1, v20
v_accvgpr_read_b32 v19, a2
v_accvgpr_read_b32 v20, a3
v_mul_f32 v19, v19, v24
v_mul_f32 v20, v20, v24
v_accvgpr_write_b32 a2, v19
v_accvgpr_write_b32 a3, v20
v_accvgpr_read_b32 v19, a4
v_accvgpr_read_b32 v20, a5
v_mul_f32 v19, v19, v24
v_mul_f32 v20, v20, v24
v_accvgpr_write_b32 a4, v19
v_accvgpr_write_b32 a5, v20
v_accvgpr_read_b32 v19, a6
v_accvgpr_read_b32 v20, a7
v_mul_f32 v19, v19, v24
v_mul_f32 v20, v20, v24
v_accvgpr_write_b32 a6, v19
v_accvgpr_write_b32 a7, v20
v_accvgpr_read_b32 v19, a8
v_accvgpr_read_b32 v20, a9
v_mul_f32 v19, v19, v24
v_mul_f32 v20, v20, v24
v_accvgpr_write_b32 a8, v19
v_accvgpr_write_b32 a9, v20
v_accvgpr_read_b32 v19, a10
v_accvgpr_read_b32 v20, a11
v_mul_f32 v19, v19, v24
v_mul_f32 v20, v20, v24
v_accvgpr_write_b32 a10, v19
v_accvgpr_write_b32 a11, v20
v_accvgpr_read_b32 v19, a12
v_accvgpr_read_b32 v20, a13
v_mul_f32 v19, v19, v24
v_mul_f32 v20, v20, v24
v_accvgpr_write_b32 a12, v19
v_accvgpr_write_b32 a13, v20
v_accvgpr_read_b32 v19, a14
v_accvgpr_read_b32 v20, a15
v_mul_f32 v19, v19, v24
v_mul_f32 v20, v20, v24
v_accvgpr_write_b32 a14, v19
v_accvgpr_write_b32 a15, v20
v_accvgpr_read_b32 v19, a16
v_accvgpr_read_b32 v20, a17
v_mul_f32 v19, v19, v24
v_mul_f32 v20, v20, v24
v_accvgpr_write_b32 a16, v19
v_accvgpr_write_b32 a17, v20
v_accvgpr_read_b32 v19, a18
v_accvgpr_read_b32 v20, a19
v_mul_f32 v19, v19, v24
v_mul_f32 v20, v20, v24
v_accvgpr_write_b32 a18, v19
v_accvgpr_write_b32 a19, v20
v_accvgpr_read_b32 v19, a20
v_accvgpr_read_b32 v20, a21
v_mul_f32 v19, v19, v24
v_mul_f32 v20, v20, v24
v_accvgpr_write_b32 a20, v19
v_accvgpr_write_b32 a21, v20
v_accvgpr_read_b32 v19, a22
v_accvgpr_read_b32 v20, a23
v_mul_f32 v19, v19, v24
v_mul_f32 v20, v20, v24
v_accvgpr_write_b32 a22, v19
v_accvgpr_write_b32 a23, v20
v_accvgpr_read_b32 v19, a24
v_accvgpr_read_b32 v20, a25
v_mul_f32 v19, v19, v24
v_mul_f32 v20, v20, v24
v_accvgpr_write_b32 a24, v19
v_accvgpr_write_b32 a25, v20
v_accvgpr_read_b32 v19, a26
v_accvgpr_read_b32 v20, a27
v_mul_f32 v19, v19, v24
v_mul_f32 v20, v20, v24
v_accvgpr_write_b32 a26, v19
v_accvgpr_write_b32 a27, v20
v_accvgpr_read_b32 v19, a28
v_accvgpr_read_b32 v20, a29
v_mul_f32 v19, v19, v24
v_mul_f32 v20, v20, v24
v_accvgpr_write_b32 a28, v19
v_accvgpr_write_b32 a29, v20
v_accvgpr_read_b32 v19, a30
v_accvgpr_read_b32 v20, a31
v_mul_f32 v19, v19, v24
v_mul_f32 v20, v20, v24
v_accvgpr_write_b32 a30, v19
v_accvgpr_write_b32 a31, v20
v_mul_f32 v52, v52, v25
v_mul_f32 v53, v53, v25
v_mul_f32 v54, v54, v25
v_mul_f32 v55, v55, v25
v_accvgpr_read_b32 v19, a32
v_accvgpr_read_b32 v20, a33
v_mul_f32 v19, v19, v25
v_mul_f32 v20, v20, v25
v_accvgpr_write_b32 a32, v19
v_accvgpr_write_b32 a33, v20
v_accvgpr_read_b32 v19, a34
v_accvgpr_read_b32 v20, a35
v_mul_f32 v19, v19, v25
v_mul_f32 v20, v20, v25
v_accvgpr_write_b32 a34, v19
v_accvgpr_write_b32 a35, v20
v_accvgpr_read_b32 v19, a36
v_accvgpr_read_b32 v20, a37
v_mul_f32 v19, v19, v25
v_mul_f32 v20, v20, v25
v_accvgpr_write_b32 a36, v19
v_accvgpr_write_b32 a37, v20
v_accvgpr_read_b32 v19, a38
v_accvgpr_read_b32 v20, a39
v_mul_f32 v19, v19, v25
v_mul_f32 v20, v20, v25
v_accvgpr_write_b32 a38, v19
v_accvgpr_write_b32 a39, v20
v_accvgpr_read_b32 v19, a40
v_accvgpr_read_b32 v20, a41
v_mul_f32 v19, v19, v25
v_mul_f32 v20, v20, v25
v_accvgpr_write_b32 a40, v19
v_accvgpr_write_b32 a41, v20
v_accvgpr_read_b32 v19, a42
v_accvgpr_read_b32 v20, a43
v_mul_f32 v19, v19, v25
v_mul_f32 v20, v20, v25
v_accvgpr_write_b32 a42, v19
v_accvgpr_write_b32 a43, v20
v_accvgpr_read_b32 v19, a44
v_accvgpr_read_b32 v20, a45
v_mul_f32 v19, v19, v25
v_mul_f32 v20, v20, v25
v_accvgpr_write_b32 a44, v19
v_accvgpr_write_b32 a45, v20
v_accvgpr_read_b32 v19, a46
v_accvgpr_read_b32 v20, a47
v_mul_f32 v19, v19, v25
v_mul_f32 v20, v20, v25
v_accvgpr_write_b32 a46, v19
v_accvgpr_write_b32 a47, v20
v_accvgpr_read_b32 v19, a48
v_accvgpr_read_b32 v20, a49
v_mul_f32 v19, v19, v25
v_mul_f32 v20, v20, v25
v_accvgpr_write_b32 a48, v19
v_accvgpr_write_b32 a49, v20
v_accvgpr_read_b32 v19, a50
v_accvgpr_read_b32 v20, a51
v_mul_f32 v19, v19, v25
v_mul_f32 v20, v20, v25
v_accvgpr_write_b32 a50, v19
v_accvgpr_write_b32 a51, v20
v_accvgpr_read_b32 v19, a52
v_accvgpr_read_b32 v20, a53
v_mul_f32 v19, v19, v25
v_mul_f32 v20, v20, v25
v_accvgpr_write_b32 a52, v19
v_accvgpr_write_b32 a53, v20
v_accvgpr_read_b32 v19, a54
v_accvgpr_read_b32 v20, a55
v_mul_f32 v19, v19, v25
v_mul_f32 v20, v20, v25
v_accvgpr_write_b32 a54, v19
v_accvgpr_write_b32 a55, v20
v_accvgpr_read_b32 v19, a56
v_accvgpr_read_b32 v20, a57
v_mul_f32 v19, v19, v25
v_mul_f32 v20, v20, v25
v_accvgpr_write_b32 a56, v19
v_accvgpr_write_b32 a57, v20
v_accvgpr_read_b32 v19, a58
v_accvgpr_read_b32 v20, a59
v_mul_f32 v19, v19, v25
v_mul_f32 v20, v20, v25
v_accvgpr_write_b32 a58, v19
v_accvgpr_write_b32 a59, v20
v_accvgpr_read_b32 v19, a60
v_accvgpr_read_b32 v20, a61
v_mul_f32 v19, v19, v25
v_mul_f32 v20, v20, v25
v_accvgpr_write_b32 a60, v19
v_accvgpr_write_b32 a61, v20
v_accvgpr_read_b32 v19, a62
v_accvgpr_read_b32 v20, a63
v_mul_f32 v19, v19, v25
v_mul_f32 v20, v20, v25
v_accvgpr_write_b32 a62, v19
v_accvgpr_write_b32 a63, v20
v_mul_f32 v56, v56, v26
v_mul_f32 v57, v57, v26
v_mul_f32 v58, v58, v26
v_mul_f32 v59, v59, v26
v_accvgpr_read_b32 v19, a64
v_accvgpr_read_b32 v20, a65
v_mul_f32 v19, v19, v26
v_mul_f32 v20, v20, v26
v_accvgpr_write_b32 a64, v19
v_accvgpr_write_b32 a65, v20
v_accvgpr_read_b32 v19, a66
v_accvgpr_read_b32 v20, a67
v_mul_f32 v19, v19, v26
v_mul_f32 v20, v20, v26
v_accvgpr_write_b32 a66, v19
v_accvgpr_write_b32 a67, v20
v_accvgpr_read_b32 v19, a68
v_accvgpr_read_b32 v20, a69
v_mul_f32 v19, v19, v26
v_mul_f32 v20, v20, v26
v_accvgpr_write_b32 a68, v19
v_accvgpr_write_b32 a69, v20
v_accvgpr_read_b32 v19, a70
v_accvgpr_read_b32 v20, a71
v_mul_f32 v19, v19, v26
v_mul_f32 v20, v20, v26
v_accvgpr_write_b32 a70, v19
v_accvgpr_write_b32 a71, v20
v_accvgpr_read_b32 v19, a72
v_accvgpr_read_b32 v20, a73
v_mul_f32 v19, v19, v26
v_mul_f32 v20, v20, v26
v_accvgpr_write_b32 a72, v19
v_accvgpr_write_b32 a73, v20
v_accvgpr_read_b32 v19, a74
v_accvgpr_read_b32 v20, a75
v_mul_f32 v19, v19, v26
v_mul_f32 v20, v20, v26
v_accvgpr_write_b32 a74, v19
v_accvgpr_write_b32 a75, v20
v_accvgpr_read_b32 v19, a76
v_accvgpr_read_b32 v20, a77
v_mul_f32 v19, v19, v26
v_mul_f32 v20, v20, v26
v_accvgpr_write_b32 a76, v19
v_accvgpr_write_b32 a77, v20
v_accvgpr_read_b32 v19, a78
v_accvgpr_read_b32 v20, a79
v_mul_f32 v19, v19, v26
v_mul_f32 v20, v20, v26
v_accvgpr_write_b32 a78, v19
v_accvgpr_write_b32 a79, v20
v_accvgpr_read_b32 v19, a80
v_accvgpr_read_b32 v20, a81
v_mul_f32 v19, v19, v26
v_mul_f32 v20, v20, v26
v_accvgpr_write_b32 a80, v19
v_accvgpr_write_b32 a81, v20
v_accvgpr_read_b32 v19, a82
v_accvgpr_read_b32 v20, a83
v_mul_f32 v19, v19, v26
v_mul_f32 v20, v20, v26
v_accvgpr_write_b32 a82, v19
v_accvgpr_write_b32 a83, v20
v_accvgpr_read_b32 v19, a84
v_accvgpr_read_b32 v20, a85
v_mul_f32 v19, v19, v26
v_mul_f32 v20, v20, v26
v_accvgpr_write_b32 a84, v19
v_accvgpr_write_b32 a85, v20
v_accvgpr_read_b32 v19, a86
v_accvgpr_read_b32 v20, a87
v_mul_f32 v19, v19, v26
v_mul_f32 v20, v20, v26
v_accvgpr_write_b32 a86, v19
v_accvgpr_write_b32 a87, v20
v_accvgpr_read_b32 v19, a88
v_accvgpr_read_b32 v20, a89
v_mul_f32 v19, v19, v26
v_mul_f32 v20, v20, v26
v_accvgpr_write_b32 a88, v19
v_accvgpr_write_b32 a89, v20
v_accvgpr_read_b32 v19, a90
v_accvgpr_read_b32 v20, a91
v_mul_f32 v19, v19, v26
v_mul_f32 v20, v20, v26
v_accvgpr_write_b32 a90, v19
v_accvgpr_write_b32 a91, v20
v_accvgpr_read_b32 v19, a92
v_accvgpr_read_b32 v20, a93
v_mul_f32 v19, v19, v26
v_mul_f32 v20, v20, v26
v_accvgpr_write_b32 a92, v19
v_accvgpr_write_b32 a93, v20
v_accvgpr_read_b32 v19, a94
v_accvgpr_read_b32 v20, a95
v_mul_f32 v19, v19, v26
v_mul_f32 v20, v20, v26
v_accvgpr_write_b32 a94, v19
v_accvgpr_write_b32 a95, v20
v_mul_f32 v60, v60, v27
v_mul_f32 v61, v61, v27
v_mul_f32 v62, v62, v27
v_mul_f32 v63, v63, v27
v_accvgpr_read_b32 v19, a96
v_accvgpr_read_b32 v20, a97
v_mul_f32 v19, v19, v27
v_mul_f32 v20, v20, v27
v_accvgpr_write_b32 a96, v19
v_accvgpr_write_b32 a97, v20
v_accvgpr_read_b32 v19, a98
v_accvgpr_read_b32 v20, a99
v_mul_f32 v19, v19, v27
v_mul_f32 v20, v20, v27
v_accvgpr_write_b32 a98, v19
v_accvgpr_write_b32 a99, v20
v_accvgpr_read_b32 v19, a100
v_accvgpr_read_b32 v20, a101
v_mul_f32 v19, v19, v27
v_mul_f32 v20, v20, v27
v_accvgpr_write_b32 a100, v19
v_accvgpr_write_b32 a101, v20
v_accvgpr_read_b32 v19, a102
v_accvgpr_read_b32 v20, a103
v_mul_f32 v19, v19, v27
v_mul_f32 v20, v20, v27
v_accvgpr_write_b32 a102, v19
v_accvgpr_write_b32 a103, v20
v_accvgpr_read_b32 v19, a104
v_accvgpr_read_b32 v20, a105
v_mul_f32 v19, v19, v27
v_mul_f32 v20, v20, v27
v_accvgpr_write_b32 a104, v19
v_accvgpr_write_b32 a105, v20
v_accvgpr_read_b32 v19, a106
v_accvgpr_read_b32 v20, a107
v_mul_f32 v19, v19, v27
v_mul_f32 v20, v20, v27
v_accvgpr_write_b32 a106, v19
v_accvgpr_write_b32 a107, v20
v_accvgpr_read_b32 v19, a108
v_accvgpr_read_b32 v20, a109
v_mul_f32 v19, v19, v27
v_mul_f32 v20, v20, v27
v_accvgpr_write_b32 a108, v19
v_accvgpr_write_b32 a109, v20
v_accvgpr_read_b32 v19, a110
v_accvgpr_read_b32 v20, a111
v_mul_f32 v19, v19, v27
v_mul_f32 v20, v20, v27
v_accvgpr_write_b32 a110, v19
v_accvgpr_write_b32 a111, v20
v_accvgpr_read_b32 v19, a112
v_accvgpr_read_b32 v20, a113
v_mul_f32 v19, v19, v27
v_mul_f32 v20, v20, v27
v_accvgpr_write_b32 a112, v19
v_accvgpr_write_b32 a113, v20
v_accvgpr_read_b32 v19, a114
v_accvgpr_read_b32 v20, a115
v_mul_f32 v19, v19, v27
v_mul_f32 v20, v20, v27
v_accvgpr_write_b32 a114, v19
v_accvgpr_write_b32 a115, v20
v_accvgpr_read_b32 v19, a116
v_accvgpr_read_b32 v20, a117
v_mul_f32 v19, v19, v27
v_mul_f32 v20, v20, v27
v_accvgpr_write_b32 a116, v19
v_accvgpr_write_b32 a117, v20
v_accvgpr_read_b32 v19, a118
v_accvgpr_read_b32 v20, a119
v_mul_f32 v19, v19, v27
v_mul_f32 v20, v20, v27
v_accvgpr_write_b32 a118, v19
v_accvgpr_write_b32 a119, v20
v_accvgpr_read_b32 v19, a120
v_accvgpr_read_b32 v20, a121
v_mul_f32 v19, v19, v27
v_mul_f32 v20, v20, v27
v_accvgpr_write_b32 a120, v19
v_accvgpr_write_b32 a121, v20
v_accvgpr_read_b32 v19, a122
v_accvgpr_read_b32 v20, a123
v_mul_f32 v19, v19, v27
v_mul_f32 v20, v20, v27
v_accvgpr_write_b32 a122, v19
v_accvgpr_write_b32 a123, v20
v_accvgpr_read_b32 v19, a124
v_accvgpr_read_b32 v20, a125
v_mul_f32 v19, v19, v27
v_mul_f32 v20, v20, v27
v_accvgpr_write_b32 a124, v19
v_accvgpr_write_b32 a125, v20
v_accvgpr_read_b32 v19, a126
v_accvgpr_read_b32 v20, a127
v_mul_f32 v19, v19, v27
v_mul_f32 v20, v20, v27
v_accvgpr_write_b32 a126, v19
v_accvgpr_write_b32 a127, v20
s_nop 3
s_setpc_b64 s[50:51]
.section .rodata,"a"
.p2align 6
.amdhsa_kernel standalone__mha_block_cached__near_ridge_kernel
  .amdhsa_next_free_vgpr 512
  .amdhsa_next_free_sgpr 102
  .amdhsa_accum_offset 256
  .amdhsa_group_segment_fixed_size 0
  .amdhsa_kernarg_size 64
  .amdhsa_user_sgpr_count 2
  .amdhsa_user_sgpr_kernarg_segment_ptr 1
  .amdhsa_system_sgpr_workgroup_id_x 1
  .amdhsa_float_denorm_mode_32 3
  .amdhsa_float_denorm_mode_16_64 3
.end_amdhsa_kernel
```
